```python
import torch

def _softmax(x, axis=-1):
    return torch.softmax(x, dim=axis)

def _gelu(x):
    return torch.nn.functional.gelu(x, approximate='tanh')

def _silu(x):
    return torch.nn.functional.silu(x)

def _sigmoid(x):
    return torch.sigmoid(x)

def _layernorm(x, axis=-1, eps=1e-05):
    m = x.mean(dim=axis, keepdim=True)
    v = x.var(dim=axis, keepdim=True, unbiased=False)
    return (x - m) / torch.sqrt(v + eps)

def _scatter_add(tgt, idx, src, axis=0):
    return tgt.clone().index_add_(axis, idx, src)

def _segment_sum(src, seg, n):
    out = torch.zeros((n,) + src.shape[1:], dtype=src.dtype)
    return out.index_add_(0, seg, src)

def _pad(x, pw):
    flat = tuple((v for pair in reversed(pw) for v in pair))
    return torch.nn.functional.pad(x, flat)
kernel_name = 'adaLN_cond__ssm_conv_h3__mixer_gmlp__prompt'

def setup_inputs():

    _w = lambda a: (lambda t: t.to(torch.bfloat16) if t.is_floating_point() else t)(torch.as_tensor(a))

    def _A_setup():
        B, S, D = (1, 2048, 576)
        ks = 4
        return {'q': _w((lambda *s: torch.randn(*s, dtype=torch.bfloat16) * 0.05)(B, S, D)), 'k': _w((lambda *s: torch.randn(*s, dtype=torch.bfloat16) * 0.8)(B, S, D)), 'v': _w((lambda *s: torch.randn(*s, dtype=torch.bfloat16) * 0.8)(B, S, D)), 'shift_k': _w((lambda *s: torch.randn(*s, dtype=torch.bfloat16) * 0.8)(D, ks) * 0.5), 'ssm_k': _w((lambda *s: torch.randn(*s, dtype=torch.bfloat16) * 0.8)(D, S) * (1.0 / S ** 0.5)), 'ssm_D': _w((lambda *s: torch.randn(*s, dtype=torch.bfloat16) * 0.8)(D))}
    _A_in = _A_setup()

    def _B_setup():
        B, S, D, F = (1, 2048, 576, 4608)
        Fh = F // 2
        return {'x': _w((lambda *s: torch.randn(*s, dtype=torch.bfloat16) * 0.05)(B, S, D)), 'w_in': _w((lambda *s: torch.randn(*s, dtype=torch.bfloat16) * 0.4)(D, 2 * Fh)), 'w_sp': _w(0.01 * (lambda *s: torch.randn(*s, dtype=torch.bfloat16) * 0.4)(S, S)), 'b_sp': _w(1.0 + 0.01 * (lambda *s: torch.randn(*s, dtype=torch.bfloat16) * 0.05)(S)), 'w_out': _w((lambda *s: torch.randn(*s, dtype=torch.bfloat16) * 0.05)(Fh, D))}
    _B_in = _B_setup()
    return {'A_q': _A_in['q'], 'A_k': _A_in['k'], 'A_v': _A_in['v'], 'A_shift_k': _A_in['shift_k'], 'A_ssm_k': _A_in['ssm_k'], 'A_ssm_D': _A_in['ssm_D'], 'B_x': _B_in['x'], 'B_w_in': _B_in['w_in'], 'B_w_sp': _B_in['w_sp'], 'B_b_sp': _B_in['b_sp'], 'B_w_out': _B_in['w_out'], 'c': _w((lambda *s: torch.randn(*s, dtype=torch.bfloat16) * 0.1)(1, 576) * 8.0), 'w_mod': _w((lambda *s: torch.randn(*s, dtype=torch.bfloat16) * 0.1)(576, 6 * 576) * 576 ** (-0.5) * 8.0)}

def reference(A_q, A_k, A_v, A_shift_k, A_ssm_k, A_ssm_D, B_x, B_w_in, B_w_sp, B_b_sp, B_w_out, c, w_mod):

    def _A_ref(q, k, v, shift_k, ssm_k, ssm_D):
        B, S, D = q.shape
        ks = shift_k.shape[-1]
        k_pad = _pad(k, ((0, 0), (ks - 1, 0), (0, 0)))
        k_shift = torch.zeros_like(k)
        for t in range(ks):
            k_shift = k_shift + k_pad[:, t:t + S, :] * shift_k[:, ks - 1 - t][None, None, :]
        kv = k_shift * v
        L = 2 * S
        kv_pad = _pad(kv, ((0, 0), (0, S), (0, 0)))
        kf_pad = _pad(ssm_k, ((0, 0), (0, S)))
        kv_f = (lambda x, axes=(-2, -1): torch.fft.rfft2(x.float(), dim=axes))(kv_pad[:, None, :, :], axes=(1, 2))
        kf_f = (lambda x, axes=(-2, -1): torch.fft.rfft2(x.float(), dim=axes))(kf_pad[:, None, :], axes=(1, 2))
        kf_f = (lambda x, *d: x.permute(*d))(kf_f, 1, 2, 0)
        y_f = kv_f * kf_f[None, :, :, :]
        y = (lambda x, s, axes=(-2, -1): torch.fft.irfft2(x, s=s, dim=axes).to(torch.bfloat16))(y_f, (1, L), axes=(1, 2))[:, 0, :S, :]
        y = y + kv * ssm_D[None, None, :]
        return q * y

    def _B_ref(x, w_in, w_sp, b_sp, w_out):
        B, S, D = x.shape
        F = w_in.shape[-1]
        Fh = F // 2
        z = _gelu(torch.einsum('bsd,df->bsf', x, w_in))
        z1 = z[..., :Fh].clone()
        z2 = _layernorm(z[..., Fh:], axis=-1)
        g = torch.einsum('ts,bsf->btf', w_sp, z2) + b_sp[None, :, None]
        return torch.einsum('bsf,fd->bsd', z1 * g, w_out)
    x = A_q
    mod = (_silu(c) @ w_mod).reshape(c.shape[0], 6, 1, -1)
    sa, ca, ga, sb, cb, gb = (mod[:, 0].clone(), mod[:, 1].clone(), mod[:, 2].clone(), mod[:, 3].clone(), mod[:, 4].clone(), mod[:, 5].clone())
    h = _layernorm(x, axis=-1) * (1 + ca) + sa
    x = x + ga * _A_ref(h, A_k, A_v, A_shift_k, A_ssm_k, A_ssm_D)
    h = _layernorm(x, axis=-1) * (1 + cb) + sb
    x = x + gb * _B_ref(h, B_w_in, B_w_sp, B_b_sp, B_w_out)
    return x
```

```asm
; @launch grid=(256,1,1) block=(256,1,1) lds=157184
.amdgcn_target "amdgcn-amd-amdhsa--gfx950"
.text
.globl adaLN_cond__ssm_conv_h3__mixer_gmlp__prompt_kernel
.p2align 8
.type adaLN_cond__ssm_conv_h3__mixer_gmlp__prompt_kernel,@function
adaLN_cond__ssm_conv_h3__mixer_gmlp__prompt_kernel:
    s_cmp_ge_u32 s2, 256
    s_cbranch_scc1 L_mdone_1
    s_load_dwordx2 s[6:7], s[0:1], 104
    s_load_dwordx2 s[8:9], s[0:1], 120
    s_load_dwordx4 s[88:91], s[0:1], 64
    v_lshrrev_b32 v1, 6, v0
    v_and_b32 v2, 63, v0
    s_getpc_b64 s[4:5]
    s_lshr_b32 s3, s2, 3
    s_lshl_b32 s3, s3, 11
    v_subrev_u32 v3, 240, v0
    v_cmp_gt_u32 vcc, 16, v3
    v_lshl_add_u32 v3, v3, 7, s3
    v_min_u32 v3, 0xeab8, v3
    s_and_saveexec_b64 s[10:11], vcc
    s_cbranch_execz L_cpf_3
    global_load_dword v255, v3, s[4:5]
L_cpf_3:
    s_mov_b64 exec, -1
    v_readfirstlane_b32 s34, v1
    s_cmp_ge_u32 s2, 252
    s_cbranch_scc1 L_fidle_7
    s_cmp_ge_u32 s2, 216
    s_cbranch_scc1 L_fm_6
    s_cmp_ge_u32 s2, 144
    s_cbranch_scc1 L_frw_5
    s_load_dwordx8 s[36:43], s[0:1], 0
    s_load_dwordx4 s[76:79], s[0:1], 32
    s_lshr_b32 s80, s2, 4
    s_and_b32 s81, s2, 15
    v_lshrrev_b32 v3, 3, v0
    v_and_b32 v4, 7, v0
    v_mul_u32_u24 v5, 4608, v3
    v_lshl_add_u32 v5, v4, 4, v5
    s_mul_i32 s3, s81, 147456
    s_lshl_b32 s10, s80, 7
    s_add_u32 s3, s3, s10
    v_add_u32 v5, s3, v5
    v_subrev_u32 v6, 3456, v5
    v_lshlrev_b32 v9, 6, v4
    s_lshl_b32 s35, s80, 9
    s_and_b32 s3, s2, 7
    s_mul_i32 s3, s3, 18
    s_lshr_b32 s10, s2, 3
    s_add_u32 s82, s3, s10
    s_lshl_b32 s83, s82, 2
    s_add_u32 s83, s83, s34
    s_lshl_b32 s33, s82, 3
    s_lshl_b32 s53, s83, 12
    s_waitcnt lgkmcnt(0)
    s_load_dword s86, s[8:9], 524288
    s_mov_b32 s16, s38
    s_mov_b32 s17, s39
    s_mov_b32 s18, 0x240000
    s_mov_b32 s19, 0x00020000
    s_mov_b32 s20, s40
    s_mov_b32 s21, s41
    s_mov_b32 s22, 0x240000
    s_mov_b32 s23, 0x00020000
    s_mov_b32 s24, s42
    s_mov_b32 s25, s43
    s_mov_b32 s26, 0x1200
    s_mov_b32 s27, 0x00020000
    buffer_load_dwordx4 v[16:19], v6, s[16:19], 0 offen offset:0
    buffer_load_dwordx4 v[20:23], v6, s[16:19], 0 offen offset:1152
    buffer_load_dwordx4 v[24:27], v6, s[16:19], 0 offen offset:2304
    buffer_load_dwordx4 v[28:31], v5, s[16:19], 0 offen offset:0
    buffer_load_dwordx4 v[32:35], v5, s[16:19], 0 offen offset:1152
    buffer_load_dwordx4 v[36:39], v5, s[16:19], 0 offen offset:2304
    buffer_load_dwordx4 v[40:43], v5, s[16:19], 0 offen offset:3456
    buffer_load_dwordx4 v[76:79], v9, s[24:27], s35 offen offset:0
    buffer_load_dwordx4 v[80:83], v9, s[24:27], s35 offen offset:16
    buffer_load_dwordx4 v[84:87], v9, s[24:27], s35 offen offset:32
    buffer_load_dwordx4 v[88:91], v9, s[24:27], s35 offen offset:48
    buffer_load_dwordx4 v[44:47], v5, s[20:23], 0 offen offset:0 nt
    buffer_load_dwordx4 v[48:51], v5, s[20:23], 0 offen offset:1152 nt
    buffer_load_dwordx4 v[52:55], v5, s[20:23], 0 offen offset:2304 nt
    buffer_load_dwordx4 v[56:59], v5, s[20:23], 0 offen offset:3456 nt
    s_add_u32 s72, s76, s53
    s_addc_u32 s73, s77, 0
    s_mov_b32 s74, 4096
    s_mov_b32 s75, 0x00020000
    v_lshlrev_b32 v13, 4, v2
    v_lshrrev_b32 v7, 4, v2
    v_and_b32 v8, 15, v2
    v_add_u32 v11, v7, v8
    v_lshlrev_b32 v11, 1, v11
    v_subrev_u32 v11, 32, v11
    buffer_load_dwordx4 v[160:163], v13, s[72:75], 0 offen offset:0
    buffer_load_dwordx2 v[164:165], v13, s[72:75], 0 offen offset:16
    buffer_load_dwordx4 v[166:169], v13, s[72:75], 0 offen offset:1024
    buffer_load_dwordx2 v[170:171], v13, s[72:75], 0 offen offset:1040
    buffer_load_dwordx4 v[172:175], v13, s[72:75], 0 offen offset:2048
    buffer_load_dwordx2 v[176:177], v13, s[72:75], 0 offen offset:2064
    buffer_load_dwordx4 v[178:181], v13, s[72:75], 0 offen offset:3072
    buffer_load_dwordx2 v[182:183], v13, s[72:75], 0 offen offset:3088
    buffer_load_ushort v184, v11, s[72:75], 0 offen
    s_lshr_b32 s3, s83, 1
    s_lshl_b32 s3, s3, 2
    s_add_u32 s78, s78, s3
    s_addc_u32 s79, s79, 0
    s_load_dword s84, s[78:79], 0
    s_mov_b32 s12, s36
    s_mov_b32 s13, s37
    s_mov_b32 s14, 0x240000
    s_mov_b32 s15, 0x00020000
    v_and_b32 v15, 15, v3
    v_mul_u32_u24 v6, 1152, v15
    v_lshl_add_u32 v6, v4, 4, v6
    s_min_u32 s54, s2, 127
    s_mul_i32 s3, s54, 18432
    s_mov_b32 s55, s3
    v_mov_b32 v14, v6
    buffer_load_dwordx4 v[200:203], v14, s[12:15], s55 offen offset:0
    buffer_load_dwordx4 v[204:207], v14, s[12:15], s55 offen offset:128
    buffer_load_dwordx4 v[208:211], v14, s[12:15], s55 offen offset:256
    buffer_load_dwordx4 v[212:215], v14, s[12:15], s55 offen offset:384
    buffer_load_dwordx4 v[216:219], v14, s[12:15], s55 offen offset:512
    buffer_load_dwordx4 v[220:223], v14, s[12:15], s55 offen offset:640
    buffer_load_dwordx4 v[224:227], v14, s[12:15], s55 offen offset:768
    buffer_load_dwordx4 v[228:231], v14, s[12:15], s55 offen offset:896
    buffer_load_dwordx4 v[232:235], v14, s[12:15], s55 offen offset:1024
    v_lshlrev_b32 v15, 4, v15
    s_add_u32 s44, s8, 0x50000
    s_addc_u32 s45, s9, 0
    s_mov_b32 s46, 0x30000
    s_mov_b32 s47, 0x00020000
    s_mov_b32 s28, s8
    s_mov_b32 s29, s9
    s_mov_b32 s30, 0xa0000
    s_mov_b32 s31, 0x00020000
    s_add_u32 s36, s8, 0x340000
    s_addc_u32 s37, s9, 0
    s_mov_b32 s38, 0x240000
    s_mov_b32 s39, 0x00020000
    s_mul_i32 s32, s34, 21248
    v_lshlrev_b32 v10, 1, v4
    v_xor_b32 v10, v10, v3
    v_lshlrev_b32 v10, 3, v10
    v_lshl_add_u32 v10, v4, 11, v10
    v_xor_b32 v10, 0xf8, v10
    v_add_u32 v10, 84992, v10
    v_lshrrev_b32 v3, 4, v0
    v_and_b32 v4, 15, v0
    v_lshrrev_b32 v5, 7, v0
    v_lshlrev_b32 v12, 12, v3
    v_lshl_add_u32 v12, v4, 4, v12
    v_lshlrev_b32 v3, 8, v3
    v_add_u32 v3, 84992, v3
    v_add_u32 v6, 0, v5
    v_xor_b32 v6, v6, v4
    v_lshl_add_u32 v60, v6, 4, v3
    v_add_u32 v6, 2, v5
    v_xor_b32 v6, v6, v4
    v_lshl_add_u32 v61, v6, 4, v3
    v_add_u32 v6, 4, v5
    v_xor_b32 v6, v6, v4
    v_lshl_add_u32 v62, v6, 4, v3
    v_add_u32 v6, 6, v5
    v_xor_b32 v6, v6, v4
    v_lshl_add_u32 v63, v6, 4, v3
    s_lshl_b32 s3, s80, 18
    s_lshl_b32 s10, s81, 8
    s_xor_b32 s10, s10, 0xf00
    s_add_u32 s51, s3, s10
    s_waitcnt vmcnt(22)
    v_lshlrev_b32 v92, 16, v76
    v_and_b32 v93, 0xffff0000, v76
    v_lshlrev_b32 v94, 16, v77
    v_and_b32 v95, 0xffff0000, v77
    v_lshlrev_b32 v96, 16, v16
    v_lshlrev_b32 v97, 16, v20
    v_lshlrev_b32 v98, 16, v24
    v_lshlrev_b32 v99, 16, v28
    v_lshlrev_b32 v100, 16, v32
    v_lshlrev_b32 v101, 16, v36
    v_lshlrev_b32 v102, 16, v40
    v_pk_mul_f32 v[112:113], v[96:97], v[94:95] op_sel:[0,1] op_sel_hi:[1,1]
    v_pk_mul_f32 v[114:115], v[98:99], v[94:95] op_sel:[0,1] op_sel_hi:[1,1]
    v_pk_fma_f32 v[112:113], v[98:99], v[92:93], v[112:113] op_sel:[0,1,0] op_sel_hi:[1,1,1]
    v_pk_fma_f32 v[114:115], v[100:101], v[92:93], v[114:115] op_sel:[0,1,0] op_sel_hi:[1,1,1]
    v_fmac_f32 v112, v94, v97
    v_fmac_f32 v113, v94, v98
    v_fmac_f32 v114, v94, v99
    v_fmac_f32 v115, v94, v100
    v_fmac_f32 v112, v92, v99
    v_fmac_f32 v113, v92, v100
    v_fmac_f32 v114, v92, v101
    v_fmac_f32 v115, v92, v102
    v_lshlrev_b32 v92, 16, v78
    v_and_b32 v93, 0xffff0000, v78
    v_lshlrev_b32 v94, 16, v79
    v_and_b32 v95, 0xffff0000, v79
    v_and_b32 v96, 0xffff0000, v16
    v_and_b32 v97, 0xffff0000, v20
    v_and_b32 v98, 0xffff0000, v24
    v_and_b32 v99, 0xffff0000, v28
    v_and_b32 v100, 0xffff0000, v32
    v_and_b32 v101, 0xffff0000, v36
    v_and_b32 v102, 0xffff0000, v40
    v_pk_mul_f32 v[116:117], v[96:97], v[94:95] op_sel:[0,1] op_sel_hi:[1,1]
    v_pk_mul_f32 v[118:119], v[98:99], v[94:95] op_sel:[0,1] op_sel_hi:[1,1]
    v_pk_fma_f32 v[116:117], v[98:99], v[92:93], v[116:117] op_sel:[0,1,0] op_sel_hi:[1,1,1]
    v_pk_fma_f32 v[118:119], v[100:101], v[92:93], v[118:119] op_sel:[0,1,0] op_sel_hi:[1,1,1]
    v_fmac_f32 v116, v94, v97
    v_fmac_f32 v117, v94, v98
    v_fmac_f32 v118, v94, v99
    v_fmac_f32 v119, v94, v100
    v_fmac_f32 v116, v92, v99
    v_fmac_f32 v117, v92, v100
    v_fmac_f32 v118, v92, v101
    v_fmac_f32 v119, v92, v102
    v_lshlrev_b32 v92, 16, v80
    v_and_b32 v93, 0xffff0000, v80
    v_lshlrev_b32 v94, 16, v81
    v_and_b32 v95, 0xffff0000, v81
    v_lshlrev_b32 v96, 16, v17
    v_lshlrev_b32 v97, 16, v21
    v_lshlrev_b32 v98, 16, v25
    v_lshlrev_b32 v99, 16, v29
    v_lshlrev_b32 v100, 16, v33
    v_lshlrev_b32 v101, 16, v37
    v_lshlrev_b32 v102, 16, v41
    v_pk_mul_f32 v[120:121], v[96:97], v[94:95] op_sel:[0,1] op_sel_hi:[1,1]
    v_pk_mul_f32 v[122:123], v[98:99], v[94:95] op_sel:[0,1] op_sel_hi:[1,1]
    v_pk_fma_f32 v[120:121], v[98:99], v[92:93], v[120:121] op_sel:[0,1,0] op_sel_hi:[1,1,1]
    v_pk_fma_f32 v[122:123], v[100:101], v[92:93], v[122:123] op_sel:[0,1,0] op_sel_hi:[1,1,1]
    v_fmac_f32 v120, v94, v97
    v_fmac_f32 v121, v94, v98
    v_fmac_f32 v122, v94, v99
    v_fmac_f32 v123, v94, v100
    v_fmac_f32 v120, v92, v99
    v_fmac_f32 v121, v92, v100
    v_fmac_f32 v122, v92, v101
    v_fmac_f32 v123, v92, v102
    v_lshlrev_b32 v92, 16, v82
    v_and_b32 v93, 0xffff0000, v82
    v_lshlrev_b32 v94, 16, v83
    v_and_b32 v95, 0xffff0000, v83
    v_and_b32 v96, 0xffff0000, v17
    v_and_b32 v97, 0xffff0000, v21
    v_and_b32 v98, 0xffff0000, v25
    v_and_b32 v99, 0xffff0000, v29
    v_and_b32 v100, 0xffff0000, v33
    v_and_b32 v101, 0xffff0000, v37
    v_and_b32 v102, 0xffff0000, v41
    v_pk_mul_f32 v[124:125], v[96:97], v[94:95] op_sel:[0,1] op_sel_hi:[1,1]
    v_pk_mul_f32 v[126:127], v[98:99], v[94:95] op_sel:[0,1] op_sel_hi:[1,1]
    v_pk_fma_f32 v[124:125], v[98:99], v[92:93], v[124:125] op_sel:[0,1,0] op_sel_hi:[1,1,1]
    v_pk_fma_f32 v[126:127], v[100:101], v[92:93], v[126:127] op_sel:[0,1,0] op_sel_hi:[1,1,1]
    v_fmac_f32 v124, v94, v97
    v_fmac_f32 v125, v94, v98
    v_fmac_f32 v126, v94, v99
    v_fmac_f32 v127, v94, v100
    v_fmac_f32 v124, v92, v99
    v_fmac_f32 v125, v92, v100
    v_fmac_f32 v126, v92, v101
    v_fmac_f32 v127, v92, v102
    v_lshlrev_b32 v92, 16, v84
    v_and_b32 v93, 0xffff0000, v84
    v_lshlrev_b32 v94, 16, v85
    v_and_b32 v95, 0xffff0000, v85
    v_lshlrev_b32 v96, 16, v18
    v_lshlrev_b32 v97, 16, v22
    v_lshlrev_b32 v98, 16, v26
    v_lshlrev_b32 v99, 16, v30
    v_lshlrev_b32 v100, 16, v34
    v_lshlrev_b32 v101, 16, v38
    v_lshlrev_b32 v102, 16, v42
    v_pk_mul_f32 v[128:129], v[96:97], v[94:95] op_sel:[0,1] op_sel_hi:[1,1]
    v_pk_mul_f32 v[130:131], v[98:99], v[94:95] op_sel:[0,1] op_sel_hi:[1,1]
    v_pk_fma_f32 v[128:129], v[98:99], v[92:93], v[128:129] op_sel:[0,1,0] op_sel_hi:[1,1,1]
    v_pk_fma_f32 v[130:131], v[100:101], v[92:93], v[130:131] op_sel:[0,1,0] op_sel_hi:[1,1,1]
    v_fmac_f32 v128, v94, v97
    v_fmac_f32 v129, v94, v98
    v_fmac_f32 v130, v94, v99
    v_fmac_f32 v131, v94, v100
    v_fmac_f32 v128, v92, v99
    v_fmac_f32 v129, v92, v100
    v_fmac_f32 v130, v92, v101
    v_fmac_f32 v131, v92, v102
    v_lshlrev_b32 v92, 16, v86
    v_and_b32 v93, 0xffff0000, v86
    v_lshlrev_b32 v94, 16, v87
    v_and_b32 v95, 0xffff0000, v87
    v_and_b32 v96, 0xffff0000, v18
    v_and_b32 v97, 0xffff0000, v22
    v_and_b32 v98, 0xffff0000, v26
    v_and_b32 v99, 0xffff0000, v30
    v_and_b32 v100, 0xffff0000, v34
    v_and_b32 v101, 0xffff0000, v38
    v_and_b32 v102, 0xffff0000, v42
    v_pk_mul_f32 v[132:133], v[96:97], v[94:95] op_sel:[0,1] op_sel_hi:[1,1]
    v_pk_mul_f32 v[134:135], v[98:99], v[94:95] op_sel:[0,1] op_sel_hi:[1,1]
    v_pk_fma_f32 v[132:133], v[98:99], v[92:93], v[132:133] op_sel:[0,1,0] op_sel_hi:[1,1,1]
    v_pk_fma_f32 v[134:135], v[100:101], v[92:93], v[134:135] op_sel:[0,1,0] op_sel_hi:[1,1,1]
    v_fmac_f32 v132, v94, v97
    v_fmac_f32 v133, v94, v98
    v_fmac_f32 v134, v94, v99
    v_fmac_f32 v135, v94, v100
    v_fmac_f32 v132, v92, v99
    v_fmac_f32 v133, v92, v100
    v_fmac_f32 v134, v92, v101
    v_fmac_f32 v135, v92, v102
    v_lshlrev_b32 v92, 16, v88
    v_and_b32 v93, 0xffff0000, v88
    v_lshlrev_b32 v94, 16, v89
    v_and_b32 v95, 0xffff0000, v89
    v_lshlrev_b32 v96, 16, v19
    v_lshlrev_b32 v97, 16, v23
    v_lshlrev_b32 v98, 16, v27
    v_lshlrev_b32 v99, 16, v31
    v_lshlrev_b32 v100, 16, v35
    v_lshlrev_b32 v101, 16, v39
    v_lshlrev_b32 v102, 16, v43
    v_pk_mul_f32 v[136:137], v[96:97], v[94:95] op_sel:[0,1] op_sel_hi:[1,1]
    v_pk_mul_f32 v[138:139], v[98:99], v[94:95] op_sel:[0,1] op_sel_hi:[1,1]
    v_pk_fma_f32 v[136:137], v[98:99], v[92:93], v[136:137] op_sel:[0,1,0] op_sel_hi:[1,1,1]
    v_pk_fma_f32 v[138:139], v[100:101], v[92:93], v[138:139] op_sel:[0,1,0] op_sel_hi:[1,1,1]
    v_fmac_f32 v136, v94, v97
    v_fmac_f32 v137, v94, v98
    v_fmac_f32 v138, v94, v99
    v_fmac_f32 v139, v94, v100
    v_fmac_f32 v136, v92, v99
    v_fmac_f32 v137, v92, v100
    v_fmac_f32 v138, v92, v101
    v_fmac_f32 v139, v92, v102
    v_lshlrev_b32 v92, 16, v90
    v_and_b32 v93, 0xffff0000, v90
    v_lshlrev_b32 v94, 16, v91
    v_and_b32 v95, 0xffff0000, v91
    v_and_b32 v96, 0xffff0000, v19
    v_and_b32 v97, 0xffff0000, v23
    v_and_b32 v98, 0xffff0000, v27
    v_and_b32 v99, 0xffff0000, v31
    v_and_b32 v100, 0xffff0000, v35
    v_and_b32 v101, 0xffff0000, v39
    v_and_b32 v102, 0xffff0000, v43
    v_pk_mul_f32 v[140:141], v[96:97], v[94:95] op_sel:[0,1] op_sel_hi:[1,1]
    v_pk_mul_f32 v[142:143], v[98:99], v[94:95] op_sel:[0,1] op_sel_hi:[1,1]
    v_pk_fma_f32 v[140:141], v[98:99], v[92:93], v[140:141] op_sel:[0,1,0] op_sel_hi:[1,1,1]
    v_pk_fma_f32 v[142:143], v[100:101], v[92:93], v[142:143] op_sel:[0,1,0] op_sel_hi:[1,1,1]
    v_fmac_f32 v140, v94, v97
    v_fmac_f32 v141, v94, v98
    v_fmac_f32 v142, v94, v99
    v_fmac_f32 v143, v94, v100
    v_fmac_f32 v140, v92, v99
    v_fmac_f32 v141, v92, v100
    v_fmac_f32 v142, v92, v101
    v_fmac_f32 v143, v92, v102
    s_waitcnt vmcnt(18)
    v_lshlrev_b32 v96, 16, v44
    v_lshlrev_b32 v97, 16, v48
    v_lshlrev_b32 v98, 16, v52
    v_lshlrev_b32 v99, 16, v56
    v_pk_mul_f32 v[112:113], v[112:113], v[96:97]
    v_pk_mul_f32 v[114:115], v[114:115], v[98:99]
    v_cvt_pk_bf16_f32 v104, v115, v114
    v_cvt_pk_bf16_f32 v105, v113, v112
    ds_write_b64 v10, v[104:105] offset:0
    v_and_b32 v100, 0xffff0000, v44
    v_and_b32 v101, 0xffff0000, v48
    v_and_b32 v102, 0xffff0000, v52
    v_and_b32 v103, 0xffff0000, v56
    v_pk_mul_f32 v[116:117], v[116:117], v[100:101]
    v_pk_mul_f32 v[118:119], v[118:119], v[102:103]
    v_cvt_pk_bf16_f32 v106, v119, v118
    v_cvt_pk_bf16_f32 v107, v117, v116
    ds_write_b64 v10, v[106:107] offset:256
    v_lshlrev_b32 v96, 16, v45
    v_lshlrev_b32 v97, 16, v49
    v_lshlrev_b32 v98, 16, v53
    v_lshlrev_b32 v99, 16, v57
    v_pk_mul_f32 v[120:121], v[120:121], v[96:97]
    v_pk_mul_f32 v[122:123], v[122:123], v[98:99]
    v_cvt_pk_bf16_f32 v108, v123, v122
    v_cvt_pk_bf16_f32 v109, v121, v120
    ds_write_b64 v10, v[108:109] offset:512
    v_and_b32 v100, 0xffff0000, v45
    v_and_b32 v101, 0xffff0000, v49
    v_and_b32 v102, 0xffff0000, v53
    v_and_b32 v103, 0xffff0000, v57
    v_pk_mul_f32 v[124:125], v[124:125], v[100:101]
    v_pk_mul_f32 v[126:127], v[126:127], v[102:103]
    v_cvt_pk_bf16_f32 v110, v127, v126
    v_cvt_pk_bf16_f32 v111, v125, v124
    ds_write_b64 v10, v[110:111] offset:768
    v_lshlrev_b32 v96, 16, v46
    v_lshlrev_b32 v97, 16, v50
    v_lshlrev_b32 v98, 16, v54
    v_lshlrev_b32 v99, 16, v58
    v_pk_mul_f32 v[128:129], v[128:129], v[96:97]
    v_pk_mul_f32 v[130:131], v[130:131], v[98:99]
    v_cvt_pk_bf16_f32 v104, v131, v130
    v_cvt_pk_bf16_f32 v105, v129, v128
    ds_write_b64 v10, v[104:105] offset:1024
    v_and_b32 v100, 0xffff0000, v46
    v_and_b32 v101, 0xffff0000, v50
    v_and_b32 v102, 0xffff0000, v54
    v_and_b32 v103, 0xffff0000, v58
    v_pk_mul_f32 v[132:133], v[132:133], v[100:101]
    v_pk_mul_f32 v[134:135], v[134:135], v[102:103]
    v_cvt_pk_bf16_f32 v106, v135, v134
    v_cvt_pk_bf16_f32 v107, v133, v132
    ds_write_b64 v10, v[106:107] offset:1280
    v_lshlrev_b32 v96, 16, v47
    v_lshlrev_b32 v97, 16, v51
    v_lshlrev_b32 v98, 16, v55
    v_lshlrev_b32 v99, 16, v59
    v_pk_mul_f32 v[136:137], v[136:137], v[96:97]
    v_pk_mul_f32 v[138:139], v[138:139], v[98:99]
    v_cvt_pk_bf16_f32 v108, v139, v138
    v_cvt_pk_bf16_f32 v109, v137, v136
    ds_write_b64 v10, v[108:109] offset:1536
    v_and_b32 v100, 0xffff0000, v47
    v_and_b32 v101, 0xffff0000, v51
    v_and_b32 v102, 0xffff0000, v55
    v_and_b32 v103, 0xffff0000, v59
    v_pk_mul_f32 v[140:141], v[140:141], v[100:101]
    v_pk_mul_f32 v[142:143], v[142:143], v[102:103]
    v_cvt_pk_bf16_f32 v110, v143, v142
    v_cvt_pk_bf16_f32 v111, v141, v140
    ds_write_b64 v10, v[110:111] offset:1792
    s_waitcnt lgkmcnt(0)
    s_barrier
    ds_read_b128 v[16:19], v60 offset:0
    ds_read_b128 v[20:23], v61 offset:4096
    ds_read_b128 v[24:27], v62 offset:8192
    ds_read_b128 v[28:31], v63 offset:12288
    s_waitcnt lgkmcnt(3)
    buffer_store_dwordx4 v[16:19], v12, s[36:39], s51 offen sc1
    s_add_u32 s51, s51, 0x10000
    s_waitcnt lgkmcnt(2)
    buffer_store_dwordx4 v[20:23], v12, s[36:39], s51 offen sc1
    s_add_u32 s51, s51, 0x10000
    s_waitcnt lgkmcnt(1)
    buffer_store_dwordx4 v[24:27], v12, s[36:39], s51 offen sc1
    s_add_u32 s51, s51, 0x10000
    s_waitcnt lgkmcnt(0)
    buffer_store_dwordx4 v[28:31], v12, s[36:39], s51 offen sc1
    s_add_u32 s51, s51, 0x10000
    v_lshrrev_b32 v9, 1, v0
    v_min_u32 v9, 113, v9
    v_mul_u32_u24 v9, 1152, v9
    v_and_b32 v10, 1, v0
    v_lshl_add_u32 v9, v10, 7, v9
    s_lshr_b32 s3, s2, 3
    s_mul_i32 s3, s3, 131328
    s_and_b32 s10, s2, 7
    s_lshl_b32 s10, s10, 7
    s_add_u32 s3, s3, s10
    buffer_load_dword v58, v9, s[12:15], s3 offen
    s_mul_i32 s87, s86, 0x9e3779b1
    s_add_u32 s87, s87, 0x7f4a7c15
    s_add_u32 s24, s8, 0x100000
    s_addc_u32 s25, s9, 0
    s_mov_b32 s26, 0x240000
    s_mov_b32 s27, 0x00020000
    s_waitcnt vmcnt(1)
    s_barrier
    s_cmp_lg_u32 s34, 0
    s_cbranch_scc1 L_fl_8
    s_lshl_b32 s10, s2, 7
    s_add_u32 s10, s10, 65536
    v_lshlrev_b32 v1, 2, v2
    v_mov_b32 v6, s87
    s_mov_b32 exec_hi, 0
    buffer_store_dword v6, v1, s[44:47], s10 offen sc1
    s_mov_b64 exec, -1
L_fl_8:
    s_lshr_b32 s3, s2, 6
    s_or_b32 s3, s3, s34
    s_cmp_ge_u32 s3, 2
    s_cbranch_scc1 L_nost_9
    v_mov_b32 v36, 0x3f803f80
    v_mov_b32 v32, 0
    v_mov_b32 v33, 0
    v_mov_b32 v34, 0
    v_mov_b32 v35, 0
    v_dot2c_f32_bf16 v33, v200, v36
    v_dot2c_f32_bf16 v32, v200, v200
    v_dot2c_f32_bf16 v35, v201, v36
    v_dot2c_f32_bf16 v34, v201, v201
    v_dot2c_f32_bf16 v33, v202, v36
    v_dot2c_f32_bf16 v32, v202, v202
    v_dot2c_f32_bf16 v35, v203, v36
    v_dot2c_f32_bf16 v34, v203, v203
    v_dot2c_f32_bf16 v33, v204, v36
    v_dot2c_f32_bf16 v32, v204, v204
    v_dot2c_f32_bf16 v35, v205, v36
    v_dot2c_f32_bf16 v34, v205, v205
    v_dot2c_f32_bf16 v33, v206, v36
    v_dot2c_f32_bf16 v32, v206, v206
    v_dot2c_f32_bf16 v35, v207, v36
    v_dot2c_f32_bf16 v34, v207, v207
    v_dot2c_f32_bf16 v33, v208, v36
    v_dot2c_f32_bf16 v32, v208, v208
    v_dot2c_f32_bf16 v35, v209, v36
    v_dot2c_f32_bf16 v34, v209, v209
    v_dot2c_f32_bf16 v33, v210, v36
    v_dot2c_f32_bf16 v32, v210, v210
    v_dot2c_f32_bf16 v35, v211, v36
    v_dot2c_f32_bf16 v34, v211, v211
    v_dot2c_f32_bf16 v33, v212, v36
    v_dot2c_f32_bf16 v32, v212, v212
    v_dot2c_f32_bf16 v35, v213, v36
    v_dot2c_f32_bf16 v34, v213, v213
    v_dot2c_f32_bf16 v33, v214, v36
    v_dot2c_f32_bf16 v32, v214, v214
    v_dot2c_f32_bf16 v35, v215, v36
    v_dot2c_f32_bf16 v34, v215, v215
    v_dot2c_f32_bf16 v33, v216, v36
    v_dot2c_f32_bf16 v32, v216, v216
    v_dot2c_f32_bf16 v35, v217, v36
    v_dot2c_f32_bf16 v34, v217, v217
    v_dot2c_f32_bf16 v33, v218, v36
    v_dot2c_f32_bf16 v32, v218, v218
    v_dot2c_f32_bf16 v35, v219, v36
    v_dot2c_f32_bf16 v34, v219, v219
    v_dot2c_f32_bf16 v33, v220, v36
    v_dot2c_f32_bf16 v32, v220, v220
    v_dot2c_f32_bf16 v35, v221, v36
    v_dot2c_f32_bf16 v34, v221, v221
    v_dot2c_f32_bf16 v33, v222, v36
    v_dot2c_f32_bf16 v32, v222, v222
    v_dot2c_f32_bf16 v35, v223, v36
    v_dot2c_f32_bf16 v34, v223, v223
    v_dot2c_f32_bf16 v33, v224, v36
    v_dot2c_f32_bf16 v32, v224, v224
    v_dot2c_f32_bf16 v35, v225, v36
    v_dot2c_f32_bf16 v34, v225, v225
    v_dot2c_f32_bf16 v33, v226, v36
    v_dot2c_f32_bf16 v32, v226, v226
    v_dot2c_f32_bf16 v35, v227, v36
    v_dot2c_f32_bf16 v34, v227, v227
    v_dot2c_f32_bf16 v33, v228, v36
    v_dot2c_f32_bf16 v32, v228, v228
    v_dot2c_f32_bf16 v35, v229, v36
    v_dot2c_f32_bf16 v34, v229, v229
    v_dot2c_f32_bf16 v33, v230, v36
    v_dot2c_f32_bf16 v32, v230, v230
    v_dot2c_f32_bf16 v35, v231, v36
    v_dot2c_f32_bf16 v34, v231, v231
    v_dot2c_f32_bf16 v33, v232, v36
    v_dot2c_f32_bf16 v32, v232, v232
    v_dot2c_f32_bf16 v35, v233, v36
    v_dot2c_f32_bf16 v34, v233, v233
    v_dot2c_f32_bf16 v33, v234, v36
    v_dot2c_f32_bf16 v32, v234, v234
    v_dot2c_f32_bf16 v35, v235, v36
    v_dot2c_f32_bf16 v34, v235, v235
    s_lshl_b32 s3, s2, 8
    s_add_u32 s3, s3, 589824
    s_nop 0
    v_add_f32 v32, v32, v34
    v_add_f32 v33, v33, v35
    s_nop 1
    v_add_f32_dpp v32, v32, v32 quad_perm:[1,0,3,2] row_mask:0xf bank_mask:0xf
    v_add_f32_dpp v33, v33, v33 quad_perm:[1,0,3,2] row_mask:0xf bank_mask:0xf
    s_nop 1
    v_add_f32_dpp v32, v32, v32 quad_perm:[2,3,0,1] row_mask:0xf bank_mask:0xf
    v_add_f32_dpp v33, v33, v33 quad_perm:[2,3,0,1] row_mask:0xf bank_mask:0xf
    s_nop 1
    v_add_f32_dpp v32, v32, v32 row_half_mirror row_mask:0xf bank_mask:0xf
    v_add_f32_dpp v33, v33, v33 row_half_mirror row_mask:0xf bank_mask:0xf
    v_mul_f32 v33, 0x3ae38e39, v33
    v_mul_f32 v32, 0x3ae38e39, v32
    v_fma_f32 v32, -v33, v33, v32
    v_max_f32 v32, 0, v32
    v_add_f32 v32, 0x3727c5ac, v32
    v_rsq_f32 v32, v32
    s_mov_b32 s40, 0x01010101
    v_mul_f32 v33, v33, v32
    v_sub_f32 v33, 0, v33
    s_mov_b32 s41, 0x01010101
    s_mov_b64 exec, s[40:41]
    buffer_store_dwordx4 v[32:35], v15, s[28:31], s3 offen sc1
    s_mov_b64 exec, -1
L_nost_9:
    v_add_u32 v14, s32, v13
    v_mul_u32_u24 v11, 4160, v7
    v_lshl_add_u32 v11, v8, 1, v11
    v_add_u32 v11, s32, v11
    v_mov_b32 v56, 0
    v_mov_b32 v57, 0
    v_lshlrev_b32 v9, 3, v2
    v_add_u32 v9, s32, v9
    ds_write_b64 v9, v[56:57] offset:20736
    v_alignbit_b32 v64, v161, v160, 16
    v_mov_b32 v68, v161
    v_alignbit_b32 v72, v162, v161, 16
    v_alignbit_b32 v65, v162, v161, 16
    v_mov_b32 v69, v162
    v_alignbit_b32 v73, v163, v162, 16
    v_alignbit_b32 v66, v163, v162, 16
    v_mov_b32 v70, v163
    v_alignbit_b32 v74, v164, v163, 16
    v_alignbit_b32 v67, v164, v163, 16
    v_mov_b32 v71, v164
    v_alignbit_b32 v75, v165, v164, 16
    ds_write_b128 v14, v[160:163] offset:32
    ds_write_b128 v14, v[64:67] offset:4192
    ds_write_b128 v14, v[68:71] offset:8352
    ds_write_b128 v14, v[72:75] offset:12512
    v_alignbit_b32 v76, v167, v166, 16
    v_mov_b32 v80, v167
    v_alignbit_b32 v84, v168, v167, 16
    v_alignbit_b32 v77, v168, v167, 16
    v_mov_b32 v81, v168
    v_alignbit_b32 v85, v169, v168, 16
    v_alignbit_b32 v78, v169, v168, 16
    v_mov_b32 v82, v169
    v_alignbit_b32 v86, v170, v169, 16
    v_alignbit_b32 v79, v170, v169, 16
    v_mov_b32 v83, v170
    v_alignbit_b32 v87, v171, v170, 16
    ds_write_b128 v14, v[166:169] offset:1056
    ds_write_b128 v14, v[76:79] offset:5216
    ds_write_b128 v14, v[80:83] offset:9376
    ds_write_b128 v14, v[84:87] offset:13536
    v_alignbit_b32 v88, v173, v172, 16
    v_mov_b32 v92, v173
    v_alignbit_b32 v96, v174, v173, 16
    v_alignbit_b32 v89, v174, v173, 16
    v_mov_b32 v93, v174
    v_alignbit_b32 v97, v175, v174, 16
    v_alignbit_b32 v90, v175, v174, 16
    v_mov_b32 v94, v175
    v_alignbit_b32 v98, v176, v175, 16
    v_alignbit_b32 v91, v176, v175, 16
    v_mov_b32 v95, v176
    v_alignbit_b32 v99, v177, v176, 16
    ds_write_b128 v14, v[172:175] offset:2080
    ds_write_b128 v14, v[88:91] offset:6240
    ds_write_b128 v14, v[92:95] offset:10400
    ds_write_b128 v14, v[96:99] offset:14560
    v_alignbit_b32 v100, v179, v178, 16
    v_mov_b32 v104, v179
    v_alignbit_b32 v108, v180, v179, 16
    v_alignbit_b32 v101, v180, v179, 16
    v_mov_b32 v105, v180
    v_alignbit_b32 v109, v181, v180, 16
    v_alignbit_b32 v102, v181, v180, 16
    v_mov_b32 v106, v181
    v_alignbit_b32 v110, v182, v181, 16
    v_alignbit_b32 v103, v182, v181, 16
    v_mov_b32 v107, v182
    v_alignbit_b32 v111, v183, v182, 16
    ds_write_b128 v14, v[178:181] offset:3104
    ds_write_b128 v14, v[100:103] offset:7264
    ds_write_b128 v14, v[104:107] offset:11424
    ds_write_b128 v14, v[108:111] offset:15584
    ds_write_b16 v11, v184
    v_add_u32 v3, 1, v8
    v_and_b32 v4, 3, v3
    v_and_b32 v3, 0x1c, v3
    v_lshl_add_u32 v3, v7, 3, v3
    v_lshlrev_b32 v3, 1, v3
    v_mul_u32_u24 v4, 4160, v4
    v_add3_u32 v3, v3, v4, s32
    v_lshlrev_b32 v4, 5, v8
    v_lshl_add_u32 v5, v7, 3, v4
    v_sub_u32 v4, 17120, v4
    v_lshl_add_u32 v4, v7, 4, v4
    v_add_u32 v4, s32, v4
    v_sub_u32 v1, 17144, v5
    v_add_u32 v1, s32, v1
    v_lshlrev_b32 v60, 7, v0
    v_min_u32 v61, 5, v2
    v_and_b32 v62, 1, v61
    v_lshrrev_b32 v61, 1, v61
    v_mul_u32_u24 v61, 18, v61
    s_lshr_b32 s3, s83, 6
    s_lshl_b32 s3, s3, 1
    v_add3_u32 v61, v61, v62, s3
    v_lshlrev_b32 v61, 7, v61
    v_add_u32 v61, 83968, v61
    s_lshl_b32 s3, s84, 16
    s_and_b32 s84, s84, 0xffff0000
    s_bitcmp1_b32 s83, 0
    s_cselect_b32 s84, s84, s3
    s_mov_b32 s85, s84
    v_mul_u32_u24 v9, 1152, v2
    s_mul_i32 s48, s34, 589824
    s_add_u32 s48, s48, s33
    buffer_load_dwordx2 v[192:193], v9, s[12:15], s48 offen
    s_add_u32 s48, s48, 73728
    buffer_load_dwordx2 v[194:195], v9, s[12:15], s48 offen
    s_add_u32 s48, s48, 73728
    s_lshr_b32 s3, s2, 6
    s_or_b32 s3, s3, s34
    s_cmp_ge_u32 s3, 2
    s_cbranch_scc1 L_nofl_10
    s_lshl_b32 s10, s2, 1
    s_add_u32 s10, s10, s34
    s_lshl_b32 s10, s10, 7
    v_mov_b32 v59, v1
    s_waitcnt vmcnt(0)
    v_lshlrev_b32 v1, 2, v2
    v_mov_b32 v6, s87
    s_mov_b32 exec_hi, 0
    buffer_store_dword v6, v1, s[44:47], s10 offen sc1
    s_mov_b64 exec, -1
    v_mov_b32 v1, v59
L_nofl_10:
    v_lshlrev_b32 v9, 7, v8
    s_lshr_b32 s3, s82, 4
    s_lshl_b32 s3, s3, 11
    s_add_u32 s3, s3, 65536
    s_mov_b32 s70, 0x20000
L_poll_11:
    buffer_load_dword v6, v9, s[44:47], s3 offen sc1
    s_waitcnt vmcnt(0)
    v_cmp_ne_u32 vcc, s87, v6
    s_cbranch_vccz L_pollok_12
    s_mov_b64 exec, vcc
    s_sub_u32 s70, s70, 1
    s_cmp_eq_u32 s70, 0
    s_cbranch_scc1 L_pollok_12
    s_branch L_poll_11
L_pollok_12:
    s_mov_b64 exec, -1
    s_add_u32 m0, s32, 16640
    s_nop 0
    buffer_load_dwordx4 v13, s[36:39], s53 offen offset:0 sc1 lds
    buffer_load_dwordx4 v13, s[36:39], s53 offen offset:1024 sc1 lds
    buffer_load_dwordx4 v13, s[36:39], s53 offen offset:2048 sc1 lds
    buffer_load_dwordx4 v13, s[36:39], s53 offen offset:3072 sc1 lds
    v_mov_b32 v16, 0
    v_mov_b32 v17, 0
    v_mov_b32 v18, 0
    v_mov_b32 v19, 0
    v_mov_b32 v20, 0
    v_mov_b32 v21, 0
    v_mov_b32 v22, 0
    v_mov_b32 v23, 0
    v_mov_b32 v24, 0
    v_mov_b32 v25, 0
    v_mov_b32 v26, 0
    v_mov_b32 v27, 0
    v_mov_b32 v28, 0
    v_mov_b32 v29, 0
    v_mov_b32 v30, 0
    v_mov_b32 v31, 0
    v_mov_b32 v32, 0
    v_mov_b32 v33, 0
    v_mov_b32 v34, 0
    v_mov_b32 v35, 0
    v_mov_b32 v36, 0
    v_mov_b32 v37, 0
    v_mov_b32 v38, 0
    v_mov_b32 v39, 0
    v_mov_b32 v40, 0
    v_mov_b32 v41, 0
    v_mov_b32 v42, 0
    v_mov_b32 v43, 0
    v_mov_b32 v44, 0
    v_mov_b32 v45, 0
    v_mov_b32 v46, 0
    v_mov_b32 v47, 0
    v_mul_u32_u24 v9, 1152, v2
    v_lshlrev_b32 v10, 4, v2
    s_lshl_b32 s49, s34, 13
    s_add_u32 s49, s49, 589824
    s_add_u32 s50, s49, 4096
    s_lshl_b32 s51, s82, 4
    s_add_u32 s52, s51, 4608
    v_mov_b32 v11, 0
    v_mov_b32 v12, 13824
    s_waitcnt vmcnt(0) lgkmcnt(0)
    ds_read_b64 v[64:65], v3 offset:0
    ds_read_b64 v[66:67], v3 offset:8
    ds_read_b128 v[96:99], v4 offset:3584
    ds_read_b64 v[68:69], v3 offset:512
    ds_read_b64 v[70:71], v3 offset:520
    ds_read_b128 v[100:103], v4 offset:3072
    ds_read_b64 v[72:73], v3 offset:1024
    ds_read_b64 v[74:75], v3 offset:1032
    ds_read_b128 v[104:107], v4 offset:2560
    ds_read_b64 v[76:77], v3 offset:1536
    ds_read_b64 v[78:79], v3 offset:1544
    ds_read_b128 v[108:111], v4 offset:2048
    ds_read_b64 v[80:81], v3 offset:2048
    ds_read_b64 v[82:83], v3 offset:2056
    ds_read_b128 v[112:115], v4 offset:1536
    ds_read_b64 v[84:85], v3 offset:2560
    ds_read_b64 v[86:87], v3 offset:2568
    ds_read_b128 v[116:119], v4 offset:1024
    ds_read_b64 v[88:89], v3 offset:3072
    ds_read_b64 v[90:91], v3 offset:3080
    ds_read_b128 v[120:123], v4 offset:512
    ds_read_b64 v[92:93], v3 offset:3584
    ds_read_b64 v[94:95], v3 offset:3592
    ds_read_b128 v[124:127], v4 offset:0
    s_waitcnt lgkmcnt(0)
    v_mfma_f32_16x16x32_bf16 v[16:19], v[64:67], v[96:99], v[16:19]
    ds_read_b64 v[128:129], v3 offset:64
    v_mfma_f32_16x16x32_bf16 v[20:23], v[64:67], v[100:103], v[20:23]
    buffer_load_dwordx2 v[196:197], v9, s[12:15], s48 offen
    s_add_u32 s48, s48, 73728
    ds_read_b64 v[130:131], v3 offset:72
    v_mfma_f32_16x16x32_bf16 v[24:27], v[64:67], v[104:107], v[24:27]
    ds_read_b128 v[160:163], v4 offset:3648
    v_mfma_f32_16x16x32_bf16 v[28:31], v[64:67], v[108:111], v[28:31]
    ds_read_b64 v[132:133], v3 offset:576
    v_mfma_f32_16x16x32_bf16 v[32:35], v[64:67], v[112:115], v[32:35]
    ds_read_b64 v[134:135], v3 offset:584
    v_mfma_f32_16x16x32_bf16 v[36:39], v[64:67], v[116:119], v[36:39]
    ds_read_b128 v[164:167], v4 offset:3136
    v_mfma_f32_16x16x32_bf16 v[40:43], v[64:67], v[120:123], v[40:43]
    v_mfma_f32_16x16x32_bf16 v[44:47], v[64:67], v[124:127], v[44:47]
    ds_read_b64 v[136:137], v3 offset:1088
    v_mfma_f32_16x16x32_bf16 v[20:23], v[68:71], v[96:99], v[20:23]
    ds_read_b64 v[138:139], v3 offset:1096
    v_mfma_f32_16x16x32_bf16 v[24:27], v[68:71], v[100:103], v[24:27]
    ds_read_b128 v[168:171], v4 offset:2624
    v_mfma_f32_16x16x32_bf16 v[28:31], v[68:71], v[104:107], v[28:31]
    ds_read_b64 v[140:141], v3 offset:1600
    v_mfma_f32_16x16x32_bf16 v[32:35], v[68:71], v[108:111], v[32:35]
    ds_read_b64 v[142:143], v3 offset:1608
    v_mfma_f32_16x16x32_bf16 v[36:39], v[68:71], v[112:115], v[36:39]
    ds_read_b128 v[172:175], v4 offset:2112
    v_mfma_f32_16x16x32_bf16 v[40:43], v[68:71], v[116:119], v[40:43]
    v_mfma_f32_16x16x32_bf16 v[44:47], v[68:71], v[120:123], v[44:47]
    ds_read_b64 v[144:145], v3 offset:2112
    v_mfma_f32_16x16x32_bf16 v[24:27], v[72:75], v[96:99], v[24:27]
    ds_read_b64 v[146:147], v3 offset:2120
    v_mfma_f32_16x16x32_bf16 v[28:31], v[72:75], v[100:103], v[28:31]
    ds_read_b128 v[176:179], v4 offset:1600
    buffer_load_dwordx2 v[198:199], v9, s[12:15], s48 offen
    s_add_u32 s48, s48, 73728
    v_mfma_f32_16x16x32_bf16 v[32:35], v[72:75], v[104:107], v[32:35]
    ds_read_b64 v[148:149], v3 offset:2624
    v_mfma_f32_16x16x32_bf16 v[36:39], v[72:75], v[108:111], v[36:39]
    ds_read_b64 v[150:151], v3 offset:2632
    v_mfma_f32_16x16x32_bf16 v[40:43], v[72:75], v[112:115], v[40:43]
    ds_read_b128 v[180:183], v4 offset:1088
    v_mfma_f32_16x16x32_bf16 v[44:47], v[72:75], v[116:119], v[44:47]
    v_mfma_f32_16x16x32_bf16 v[28:31], v[76:79], v[96:99], v[28:31]
    ds_read_b64 v[152:153], v3 offset:3136
    v_mfma_f32_16x16x32_bf16 v[32:35], v[76:79], v[100:103], v[32:35]
    ds_read_b64 v[154:155], v3 offset:3144
    v_mfma_f32_16x16x32_bf16 v[36:39], v[76:79], v[104:107], v[36:39]
    ds_read_b128 v[184:187], v4 offset:576
    v_mfma_f32_16x16x32_bf16 v[40:43], v[76:79], v[108:111], v[40:43]
    ds_read_b64 v[156:157], v3 offset:3648
    v_mfma_f32_16x16x32_bf16 v[44:47], v[76:79], v[112:115], v[44:47]
    ds_read_b64 v[158:159], v3 offset:3656
    v_mfma_f32_16x16x32_bf16 v[32:35], v[80:83], v[96:99], v[32:35]
    ds_read_b128 v[188:191], v4 offset:64
    v_mfma_f32_16x16x32_bf16 v[36:39], v[80:83], v[100:103], v[36:39]
    v_mfma_f32_16x16x32_bf16 v[40:43], v[80:83], v[104:107], v[40:43]
    v_mfma_f32_16x16x32_bf16 v[44:47], v[80:83], v[108:111], v[44:47]
    v_mfma_f32_16x16x32_bf16 v[36:39], v[84:87], v[96:99], v[36:39]
    v_mfma_f32_16x16x32_bf16 v[40:43], v[84:87], v[100:103], v[40:43]
    v_mfma_f32_16x16x32_bf16 v[44:47], v[84:87], v[104:107], v[44:47]
    v_mfma_f32_16x16x32_bf16 v[40:43], v[88:91], v[96:99], v[40:43]
    v_mfma_f32_16x16x32_bf16 v[44:47], v[88:91], v[100:103], v[44:47]
    v_mfma_f32_16x16x32_bf16 v[44:47], v[92:95], v[96:99], v[44:47]
    s_waitcnt lgkmcnt(0)
    v_mfma_f32_16x16x32_bf16 v[16:19], v[128:131], v[160:163], v[16:19]
    ds_read_b64 v[64:65], v3 offset:128
    v_mfma_f32_16x16x32_bf16 v[20:23], v[128:131], v[164:167], v[20:23]
    buffer_load_dwordx2 v[200:201], v9, s[12:15], s48 offen
    s_add_u32 s48, s48, 73728
    ds_read_b64 v[66:67], v3 offset:136
    v_mfma_f32_16x16x32_bf16 v[24:27], v[128:131], v[168:171], v[24:27]
    ds_read_b128 v[96:99], v4 offset:3712
    v_mfma_f32_16x16x32_bf16 v[28:31], v[128:131], v[172:175], v[28:31]
    ds_read_b64 v[68:69], v3 offset:640
    v_mfma_f32_16x16x32_bf16 v[32:35], v[128:131], v[176:179], v[32:35]
    ds_read_b64 v[70:71], v3 offset:648
    v_mfma_f32_16x16x32_bf16 v[36:39], v[128:131], v[180:183], v[36:39]
    ds_read_b128 v[100:103], v4 offset:3200
    v_mfma_f32_16x16x32_bf16 v[40:43], v[128:131], v[184:187], v[40:43]
    v_mfma_f32_16x16x32_bf16 v[44:47], v[128:131], v[188:191], v[44:47]
    ds_read_b64 v[72:73], v3 offset:1152
    v_mfma_f32_16x16x32_bf16 v[20:23], v[132:135], v[160:163], v[20:23]
    ds_read_b64 v[74:75], v3 offset:1160
    v_mfma_f32_16x16x32_bf16 v[24:27], v[132:135], v[164:167], v[24:27]
    ds_read_b128 v[104:107], v4 offset:2688
    v_mfma_f32_16x16x32_bf16 v[28:31], v[132:135], v[168:171], v[28:31]
    ds_read_b64 v[76:77], v3 offset:1664
    v_mfma_f32_16x16x32_bf16 v[32:35], v[132:135], v[172:175], v[32:35]
    ds_read_b64 v[78:79], v3 offset:1672
    v_mfma_f32_16x16x32_bf16 v[36:39], v[132:135], v[176:179], v[36:39]
    ds_read_b128 v[108:111], v4 offset:2176
    v_mfma_f32_16x16x32_bf16 v[40:43], v[132:135], v[180:183], v[40:43]
    v_mfma_f32_16x16x32_bf16 v[44:47], v[132:135], v[184:187], v[44:47]
    ds_read_b64 v[80:81], v3 offset:2176
    v_mfma_f32_16x16x32_bf16 v[24:27], v[136:139], v[160:163], v[24:27]
    ds_read_b64 v[82:83], v3 offset:2184
    v_mfma_f32_16x16x32_bf16 v[28:31], v[136:139], v[164:167], v[28:31]
    ds_read_b128 v[112:115], v4 offset:1664
    buffer_load_dwordx2 v[202:203], v9, s[12:15], s48 offen
    s_add_u32 s48, s48, 73728
    v_mfma_f32_16x16x32_bf16 v[32:35], v[136:139], v[168:171], v[32:35]
    ds_read_b64 v[84:85], v3 offset:2688
    v_mfma_f32_16x16x32_bf16 v[36:39], v[136:139], v[172:175], v[36:39]
    ds_read_b64 v[86:87], v3 offset:2696
    v_mfma_f32_16x16x32_bf16 v[40:43], v[136:139], v[176:179], v[40:43]
    ds_read_b128 v[116:119], v4 offset:1152
    v_mfma_f32_16x16x32_bf16 v[44:47], v[136:139], v[180:183], v[44:47]
    v_mfma_f32_16x16x32_bf16 v[28:31], v[140:143], v[160:163], v[28:31]
    ds_read_b64 v[88:89], v3 offset:3200
    v_mfma_f32_16x16x32_bf16 v[32:35], v[140:143], v[164:167], v[32:35]
    ds_read_b64 v[90:91], v3 offset:3208
    v_mfma_f32_16x16x32_bf16 v[36:39], v[140:143], v[168:171], v[36:39]
    ds_read_b128 v[120:123], v4 offset:640
    v_mfma_f32_16x16x32_bf16 v[40:43], v[140:143], v[172:175], v[40:43]
    ds_read_b64 v[92:93], v3 offset:3712
    v_mfma_f32_16x16x32_bf16 v[44:47], v[140:143], v[176:179], v[44:47]
    ds_read_b64 v[94:95], v3 offset:3720
    v_mfma_f32_16x16x32_bf16 v[32:35], v[144:147], v[160:163], v[32:35]
    ds_read_b128 v[124:127], v4 offset:128
    v_mfma_f32_16x16x32_bf16 v[36:39], v[144:147], v[164:167], v[36:39]
    v_mfma_f32_16x16x32_bf16 v[40:43], v[144:147], v[168:171], v[40:43]
    v_mfma_f32_16x16x32_bf16 v[44:47], v[144:147], v[172:175], v[44:47]
    v_mfma_f32_16x16x32_bf16 v[36:39], v[148:151], v[160:163], v[36:39]
    v_mfma_f32_16x16x32_bf16 v[40:43], v[148:151], v[164:167], v[40:43]
    v_mfma_f32_16x16x32_bf16 v[44:47], v[148:151], v[168:171], v[44:47]
    v_mfma_f32_16x16x32_bf16 v[40:43], v[152:155], v[160:163], v[40:43]
    v_mfma_f32_16x16x32_bf16 v[44:47], v[152:155], v[164:167], v[44:47]
    v_mfma_f32_16x16x32_bf16 v[44:47], v[156:159], v[160:163], v[44:47]
    s_waitcnt lgkmcnt(0)
    v_mfma_f32_16x16x32_bf16 v[16:19], v[64:67], v[96:99], v[16:19]
    ds_read_b64 v[128:129], v3 offset:192
    v_mfma_f32_16x16x32_bf16 v[20:23], v[64:67], v[100:103], v[20:23]
    buffer_load_dwordx2 v[204:205], v9, s[12:15], s48 offen
    s_add_u32 s48, s48, 73728
    ds_read_b64 v[130:131], v3 offset:200
    v_mfma_f32_16x16x32_bf16 v[24:27], v[64:67], v[104:107], v[24:27]
    ds_read_b128 v[160:163], v4 offset:3776
    v_mfma_f32_16x16x32_bf16 v[28:31], v[64:67], v[108:111], v[28:31]
    ds_read_b64 v[132:133], v3 offset:704
    v_mfma_f32_16x16x32_bf16 v[32:35], v[64:67], v[112:115], v[32:35]
    ds_read_b64 v[134:135], v3 offset:712
    v_mfma_f32_16x16x32_bf16 v[36:39], v[64:67], v[116:119], v[36:39]
    ds_read_b128 v[164:167], v4 offset:3264
    v_mfma_f32_16x16x32_bf16 v[40:43], v[64:67], v[120:123], v[40:43]
    v_mfma_f32_16x16x32_bf16 v[44:47], v[64:67], v[124:127], v[44:47]
    ds_read_b64 v[136:137], v3 offset:1216
    v_mfma_f32_16x16x32_bf16 v[20:23], v[68:71], v[96:99], v[20:23]
    ds_read_b64 v[138:139], v3 offset:1224
    v_mfma_f32_16x16x32_bf16 v[24:27], v[68:71], v[100:103], v[24:27]
    ds_read_b128 v[168:171], v4 offset:2752
    v_mfma_f32_16x16x32_bf16 v[28:31], v[68:71], v[104:107], v[28:31]
    ds_read_b64 v[140:141], v3 offset:1728
    v_mfma_f32_16x16x32_bf16 v[32:35], v[68:71], v[108:111], v[32:35]
    ds_read_b64 v[142:143], v3 offset:1736
    v_mfma_f32_16x16x32_bf16 v[36:39], v[68:71], v[112:115], v[36:39]
    ds_read_b128 v[172:175], v4 offset:2240
    v_mfma_f32_16x16x32_bf16 v[40:43], v[68:71], v[116:119], v[40:43]
    v_mfma_f32_16x16x32_bf16 v[44:47], v[68:71], v[120:123], v[44:47]
    ds_read_b64 v[144:145], v3 offset:2240
    v_mfma_f32_16x16x32_bf16 v[24:27], v[72:75], v[96:99], v[24:27]
    ds_read_b64 v[146:147], v3 offset:2248
    v_mfma_f32_16x16x32_bf16 v[28:31], v[72:75], v[100:103], v[28:31]
    ds_read_b128 v[176:179], v4 offset:1728
    buffer_load_dwordx2 v[206:207], v9, s[12:15], s48 offen
    s_add_u32 s48, s48, 73728
    v_mfma_f32_16x16x32_bf16 v[32:35], v[72:75], v[104:107], v[32:35]
    ds_read_b64 v[148:149], v3 offset:2752
    v_mfma_f32_16x16x32_bf16 v[36:39], v[72:75], v[108:111], v[36:39]
    ds_read_b64 v[150:151], v3 offset:2760
    v_mfma_f32_16x16x32_bf16 v[40:43], v[72:75], v[112:115], v[40:43]
    ds_read_b128 v[180:183], v4 offset:1216
    v_mfma_f32_16x16x32_bf16 v[44:47], v[72:75], v[116:119], v[44:47]
    v_mfma_f32_16x16x32_bf16 v[28:31], v[76:79], v[96:99], v[28:31]
    ds_read_b64 v[152:153], v3 offset:3264
    v_mfma_f32_16x16x32_bf16 v[32:35], v[76:79], v[100:103], v[32:35]
    ds_read_b64 v[154:155], v3 offset:3272
    v_mfma_f32_16x16x32_bf16 v[36:39], v[76:79], v[104:107], v[36:39]
    ds_read_b128 v[184:187], v4 offset:704
    v_mfma_f32_16x16x32_bf16 v[40:43], v[76:79], v[108:111], v[40:43]
    ds_read_b64 v[156:157], v3 offset:3776
    v_mfma_f32_16x16x32_bf16 v[44:47], v[76:79], v[112:115], v[44:47]
    ds_read_b64 v[158:159], v3 offset:3784
    v_mfma_f32_16x16x32_bf16 v[32:35], v[80:83], v[96:99], v[32:35]
    ds_read_b128 v[188:191], v4 offset:192
    v_mfma_f32_16x16x32_bf16 v[36:39], v[80:83], v[100:103], v[36:39]
    v_mfma_f32_16x16x32_bf16 v[40:43], v[80:83], v[104:107], v[40:43]
    v_mfma_f32_16x16x32_bf16 v[44:47], v[80:83], v[108:111], v[44:47]
    v_mfma_f32_16x16x32_bf16 v[36:39], v[84:87], v[96:99], v[36:39]
    v_mfma_f32_16x16x32_bf16 v[40:43], v[84:87], v[100:103], v[40:43]
    v_mfma_f32_16x16x32_bf16 v[44:47], v[84:87], v[104:107], v[44:47]
    v_mfma_f32_16x16x32_bf16 v[40:43], v[88:91], v[96:99], v[40:43]
    v_mfma_f32_16x16x32_bf16 v[44:47], v[88:91], v[100:103], v[44:47]
    v_mfma_f32_16x16x32_bf16 v[44:47], v[92:95], v[96:99], v[44:47]
    s_waitcnt lgkmcnt(0)
    v_mfma_f32_16x16x32_bf16 v[16:19], v[128:131], v[160:163], v[16:19]
    ds_read_b64 v[64:65], v3 offset:256
    v_mfma_f32_16x16x32_bf16 v[20:23], v[128:131], v[164:167], v[20:23]
    buffer_load_dword v62, v60, s[44:47], 0 offen sc1
    ds_read_b64 v[66:67], v3 offset:264
    v_mfma_f32_16x16x32_bf16 v[24:27], v[128:131], v[168:171], v[24:27]
    ds_read_b128 v[96:99], v4 offset:3840
    v_mfma_f32_16x16x32_bf16 v[28:31], v[128:131], v[172:175], v[28:31]
    ds_read_b64 v[68:69], v3 offset:768
    v_mfma_f32_16x16x32_bf16 v[32:35], v[128:131], v[176:179], v[32:35]
    ds_read_b64 v[70:71], v3 offset:776
    v_mfma_f32_16x16x32_bf16 v[36:39], v[128:131], v[180:183], v[36:39]
    ds_read_b128 v[100:103], v4 offset:3328
    v_mfma_f32_16x16x32_bf16 v[40:43], v[128:131], v[184:187], v[40:43]
    v_mfma_f32_16x16x32_bf16 v[44:47], v[128:131], v[188:191], v[44:47]
    ds_read_b64 v[72:73], v3 offset:1280
    v_mfma_f32_16x16x32_bf16 v[20:23], v[132:135], v[160:163], v[20:23]
    ds_read_b64 v[74:75], v3 offset:1288
    v_mfma_f32_16x16x32_bf16 v[24:27], v[132:135], v[164:167], v[24:27]
    ds_read_b128 v[104:107], v4 offset:2816
    v_mfma_f32_16x16x32_bf16 v[28:31], v[132:135], v[168:171], v[28:31]
    ds_read_b64 v[76:77], v3 offset:1792
    v_mfma_f32_16x16x32_bf16 v[32:35], v[132:135], v[172:175], v[32:35]
    ds_read_b64 v[78:79], v3 offset:1800
    v_mfma_f32_16x16x32_bf16 v[36:39], v[132:135], v[176:179], v[36:39]
    ds_read_b128 v[108:111], v4 offset:2304
    v_mfma_f32_16x16x32_bf16 v[40:43], v[132:135], v[180:183], v[40:43]
    v_mfma_f32_16x16x32_bf16 v[44:47], v[132:135], v[184:187], v[44:47]
    ds_read_b64 v[80:81], v3 offset:2304
    v_mfma_f32_16x16x32_bf16 v[24:27], v[136:139], v[160:163], v[24:27]
    ds_read_b64 v[82:83], v3 offset:2312
    v_mfma_f32_16x16x32_bf16 v[28:31], v[136:139], v[164:167], v[28:31]
    ds_read_b128 v[112:115], v4 offset:1792
    buffer_load_dword v63, v61, s[44:47], 0 offen sc1
    v_mfma_f32_16x16x32_bf16 v[32:35], v[136:139], v[168:171], v[32:35]
    ds_read_b64 v[84:85], v3 offset:2816
    v_mfma_f32_16x16x32_bf16 v[36:39], v[136:139], v[172:175], v[36:39]
    ds_read_b64 v[86:87], v3 offset:2824
    v_mfma_f32_16x16x32_bf16 v[40:43], v[136:139], v[176:179], v[40:43]
    ds_read_b128 v[116:119], v4 offset:1280
    v_mfma_f32_16x16x32_bf16 v[44:47], v[136:139], v[180:183], v[44:47]
    v_mfma_f32_16x16x32_bf16 v[28:31], v[140:143], v[160:163], v[28:31]
    ds_read_b64 v[88:89], v3 offset:3328
    v_mfma_f32_16x16x32_bf16 v[32:35], v[140:143], v[164:167], v[32:35]
    ds_read_b64 v[90:91], v3 offset:3336
    v_mfma_f32_16x16x32_bf16 v[36:39], v[140:143], v[168:171], v[36:39]
    ds_read_b128 v[120:123], v4 offset:768
    v_mfma_f32_16x16x32_bf16 v[40:43], v[140:143], v[172:175], v[40:43]
    ds_read_b64 v[92:93], v3 offset:3840
    v_mfma_f32_16x16x32_bf16 v[44:47], v[140:143], v[176:179], v[44:47]
    ds_read_b64 v[94:95], v3 offset:3848
    v_mfma_f32_16x16x32_bf16 v[32:35], v[144:147], v[160:163], v[32:35]
    ds_read_b128 v[124:127], v4 offset:256
    v_mfma_f32_16x16x32_bf16 v[36:39], v[144:147], v[164:167], v[36:39]
    v_mfma_f32_16x16x32_bf16 v[40:43], v[144:147], v[168:171], v[40:43]
    v_mfma_f32_16x16x32_bf16 v[44:47], v[144:147], v[172:175], v[44:47]
    v_mfma_f32_16x16x32_bf16 v[36:39], v[148:151], v[160:163], v[36:39]
    v_mfma_f32_16x16x32_bf16 v[40:43], v[148:151], v[164:167], v[40:43]
    v_mfma_f32_16x16x32_bf16 v[44:47], v[148:151], v[168:171], v[44:47]
    v_mfma_f32_16x16x32_bf16 v[40:43], v[152:155], v[160:163], v[40:43]
    v_mfma_f32_16x16x32_bf16 v[44:47], v[152:155], v[164:167], v[44:47]
    v_mfma_f32_16x16x32_bf16 v[44:47], v[156:159], v[160:163], v[44:47]
    s_waitcnt lgkmcnt(0)
    v_mfma_f32_16x16x32_bf16 v[16:19], v[64:67], v[96:99], v[16:19]
    ds_read_b64 v[128:129], v3 offset:320
    v_mfma_f32_16x16x32_bf16 v[20:23], v[64:67], v[100:103], v[20:23]
    ds_read_b64 v[130:131], v3 offset:328
    v_mfma_f32_16x16x32_bf16 v[24:27], v[64:67], v[104:107], v[24:27]
    ds_read_b128 v[160:163], v4 offset:3904
    v_mfma_f32_16x16x32_bf16 v[28:31], v[64:67], v[108:111], v[28:31]
    ds_read_b64 v[132:133], v3 offset:832
    v_mfma_f32_16x16x32_bf16 v[32:35], v[64:67], v[112:115], v[32:35]
    ds_read_b64 v[134:135], v3 offset:840
    v_mfma_f32_16x16x32_bf16 v[36:39], v[64:67], v[116:119], v[36:39]
    ds_read_b128 v[164:167], v4 offset:3392
    v_mfma_f32_16x16x32_bf16 v[40:43], v[64:67], v[120:123], v[40:43]
    v_mfma_f32_16x16x32_bf16 v[44:47], v[64:67], v[124:127], v[44:47]
    ds_read_b64 v[136:137], v3 offset:1344
    v_mfma_f32_16x16x32_bf16 v[20:23], v[68:71], v[96:99], v[20:23]
    ds_read_b64 v[138:139], v3 offset:1352
    v_mfma_f32_16x16x32_bf16 v[24:27], v[68:71], v[100:103], v[24:27]
    ds_read_b128 v[168:171], v4 offset:2880
    v_mfma_f32_16x16x32_bf16 v[28:31], v[68:71], v[104:107], v[28:31]
    ds_read_b64 v[140:141], v3 offset:1856
    v_mfma_f32_16x16x32_bf16 v[32:35], v[68:71], v[108:111], v[32:35]
    ds_read_b64 v[142:143], v3 offset:1864
    v_mfma_f32_16x16x32_bf16 v[36:39], v[68:71], v[112:115], v[36:39]
    ds_read_b128 v[172:175], v4 offset:2368
    v_mfma_f32_16x16x32_bf16 v[40:43], v[68:71], v[116:119], v[40:43]
    v_mfma_f32_16x16x32_bf16 v[44:47], v[68:71], v[120:123], v[44:47]
    ds_read_b64 v[144:145], v3 offset:2368
    v_mfma_f32_16x16x32_bf16 v[24:27], v[72:75], v[96:99], v[24:27]
    ds_read_b64 v[146:147], v3 offset:2376
    v_mfma_f32_16x16x32_bf16 v[28:31], v[72:75], v[100:103], v[28:31]
    ds_read_b128 v[176:179], v4 offset:1856
    v_mfma_f32_16x16x32_bf16 v[32:35], v[72:75], v[104:107], v[32:35]
    ds_read_b64 v[148:149], v3 offset:2880
    v_mfma_f32_16x16x32_bf16 v[36:39], v[72:75], v[108:111], v[36:39]
    ds_read_b64 v[150:151], v3 offset:2888
    v_mfma_f32_16x16x32_bf16 v[40:43], v[72:75], v[112:115], v[40:43]
    ds_read_b128 v[180:183], v4 offset:1344
    v_mfma_f32_16x16x32_bf16 v[44:47], v[72:75], v[116:119], v[44:47]
    v_mfma_f32_16x16x32_bf16 v[28:31], v[76:79], v[96:99], v[28:31]
    ds_read_b64 v[152:153], v3 offset:3392
    v_mfma_f32_16x16x32_bf16 v[32:35], v[76:79], v[100:103], v[32:35]
    ds_read_b64 v[154:155], v3 offset:3400
    v_mfma_f32_16x16x32_bf16 v[36:39], v[76:79], v[104:107], v[36:39]
    ds_read_b128 v[184:187], v4 offset:832
    v_mfma_f32_16x16x32_bf16 v[40:43], v[76:79], v[108:111], v[40:43]
    ds_read_b64 v[156:157], v3 offset:3904
    v_mfma_f32_16x16x32_bf16 v[44:47], v[76:79], v[112:115], v[44:47]
    ds_read_b64 v[158:159], v3 offset:3912
    v_mfma_f32_16x16x32_bf16 v[32:35], v[80:83], v[96:99], v[32:35]
    ds_read_b128 v[188:191], v4 offset:320
    v_mfma_f32_16x16x32_bf16 v[36:39], v[80:83], v[100:103], v[36:39]
    v_mfma_f32_16x16x32_bf16 v[40:43], v[80:83], v[104:107], v[40:43]
    v_mfma_f32_16x16x32_bf16 v[44:47], v[80:83], v[108:111], v[44:47]
    v_mfma_f32_16x16x32_bf16 v[36:39], v[84:87], v[96:99], v[36:39]
    v_mfma_f32_16x16x32_bf16 v[40:43], v[84:87], v[100:103], v[40:43]
    v_mfma_f32_16x16x32_bf16 v[44:47], v[84:87], v[104:107], v[44:47]
    v_mfma_f32_16x16x32_bf16 v[40:43], v[88:91], v[96:99], v[40:43]
    v_mfma_f32_16x16x32_bf16 v[44:47], v[88:91], v[100:103], v[44:47]
    v_mfma_f32_16x16x32_bf16 v[44:47], v[92:95], v[96:99], v[44:47]
    s_waitcnt lgkmcnt(0)
    v_mfma_f32_16x16x32_bf16 v[16:19], v[128:131], v[160:163], v[16:19]
    ds_read_b64 v[64:65], v3 offset:384
    v_mfma_f32_16x16x32_bf16 v[20:23], v[128:131], v[164:167], v[20:23]
    ds_read_b64 v[66:67], v3 offset:392
    v_mfma_f32_16x16x32_bf16 v[24:27], v[128:131], v[168:171], v[24:27]
    ds_read_b128 v[96:99], v4 offset:3968
    v_mfma_f32_16x16x32_bf16 v[28:31], v[128:131], v[172:175], v[28:31]
    ds_read_b64 v[68:69], v3 offset:896
    v_mfma_f32_16x16x32_bf16 v[32:35], v[128:131], v[176:179], v[32:35]
    ds_read_b64 v[70:71], v3 offset:904
    v_mfma_f32_16x16x32_bf16 v[36:39], v[128:131], v[180:183], v[36:39]
    ds_read_b128 v[100:103], v4 offset:3456
    v_mfma_f32_16x16x32_bf16 v[40:43], v[128:131], v[184:187], v[40:43]
    v_mfma_f32_16x16x32_bf16 v[44:47], v[128:131], v[188:191], v[44:47]
    ds_read_b64 v[72:73], v3 offset:1408
    v_mfma_f32_16x16x32_bf16 v[20:23], v[132:135], v[160:163], v[20:23]
    ds_read_b64 v[74:75], v3 offset:1416
    v_mfma_f32_16x16x32_bf16 v[24:27], v[132:135], v[164:167], v[24:27]
    ds_read_b128 v[104:107], v4 offset:2944
    v_mfma_f32_16x16x32_bf16 v[28:31], v[132:135], v[168:171], v[28:31]
    ds_read_b64 v[76:77], v3 offset:1920
    v_mfma_f32_16x16x32_bf16 v[32:35], v[132:135], v[172:175], v[32:35]
    ds_read_b64 v[78:79], v3 offset:1928
    v_mfma_f32_16x16x32_bf16 v[36:39], v[132:135], v[176:179], v[36:39]
    ds_read_b128 v[108:111], v4 offset:2432
    v_mfma_f32_16x16x32_bf16 v[40:43], v[132:135], v[180:183], v[40:43]
    v_mfma_f32_16x16x32_bf16 v[44:47], v[132:135], v[184:187], v[44:47]
    ds_read_b64 v[80:81], v3 offset:2432
    v_mfma_f32_16x16x32_bf16 v[24:27], v[136:139], v[160:163], v[24:27]
    ds_read_b64 v[82:83], v3 offset:2440
    v_mfma_f32_16x16x32_bf16 v[28:31], v[136:139], v[164:167], v[28:31]
    ds_read_b128 v[112:115], v4 offset:1920
    v_mfma_f32_16x16x32_bf16 v[32:35], v[136:139], v[168:171], v[32:35]
    ds_read_b64 v[84:85], v3 offset:2944
    v_mfma_f32_16x16x32_bf16 v[36:39], v[136:139], v[172:175], v[36:39]
    ds_read_b64 v[86:87], v3 offset:2952
    v_mfma_f32_16x16x32_bf16 v[40:43], v[136:139], v[176:179], v[40:43]
    ds_read_b128 v[116:119], v4 offset:1408
    v_mfma_f32_16x16x32_bf16 v[44:47], v[136:139], v[180:183], v[44:47]
    v_mfma_f32_16x16x32_bf16 v[28:31], v[140:143], v[160:163], v[28:31]
    ds_read_b64 v[88:89], v3 offset:3456
    v_mfma_f32_16x16x32_bf16 v[32:35], v[140:143], v[164:167], v[32:35]
    ds_read_b64 v[90:91], v3 offset:3464
    v_mfma_f32_16x16x32_bf16 v[36:39], v[140:143], v[168:171], v[36:39]
    ds_read_b128 v[120:123], v4 offset:896
    v_mfma_f32_16x16x32_bf16 v[40:43], v[140:143], v[172:175], v[40:43]
    ds_read_b64 v[92:93], v3 offset:3968
    v_mfma_f32_16x16x32_bf16 v[44:47], v[140:143], v[176:179], v[44:47]
    ds_read_b64 v[94:95], v3 offset:3976
    v_mfma_f32_16x16x32_bf16 v[32:35], v[144:147], v[160:163], v[32:35]
    ds_read_b128 v[124:127], v4 offset:384
    v_mfma_f32_16x16x32_bf16 v[36:39], v[144:147], v[164:167], v[36:39]
    v_mfma_f32_16x16x32_bf16 v[40:43], v[144:147], v[168:171], v[40:43]
    v_mfma_f32_16x16x32_bf16 v[44:47], v[144:147], v[172:175], v[44:47]
    v_mfma_f32_16x16x32_bf16 v[36:39], v[148:151], v[160:163], v[36:39]
    v_mfma_f32_16x16x32_bf16 v[40:43], v[148:151], v[164:167], v[40:43]
    v_mfma_f32_16x16x32_bf16 v[44:47], v[148:151], v[168:171], v[44:47]
    v_mfma_f32_16x16x32_bf16 v[40:43], v[152:155], v[160:163], v[40:43]
    v_mfma_f32_16x16x32_bf16 v[44:47], v[152:155], v[164:167], v[44:47]
    v_mfma_f32_16x16x32_bf16 v[44:47], v[156:159], v[160:163], v[44:47]
    s_waitcnt lgkmcnt(0)
    s_waitcnt vmcnt(0)
    v_cmp_ne_u32 vcc, s87, v62
    v_cmp_ne_u32 s[40:41], s87, v63
    s_or_b64 s[40:41], vcc, s[40:41]
    s_cbranch_scc0 L_cok_13
    s_mov_b32 s70, 0x20000
L_poll_14:
    buffer_load_dword v6, v60, s[44:47], 0 offen sc1
    s_waitcnt vmcnt(0)
    v_cmp_ne_u32 vcc, s87, v6
    s_cbranch_vccz L_pollok_15
    s_mov_b64 exec, vcc
    s_sub_u32 s70, s70, 1
    s_cmp_eq_u32 s70, 0
    s_cbranch_scc1 L_pollok_15
    s_branch L_poll_14
L_pollok_15:
    s_mov_b64 exec, -1
    s_mov_b32 s70, 0x20000
L_poll_16:
    buffer_load_dword v6, v61, s[44:47], 0 offen sc1
    s_waitcnt vmcnt(0)
    v_cmp_ne_u32 vcc, s87, v6
    s_cbranch_vccz L_pollok_17
    s_mov_b64 exec, vcc
    s_sub_u32 s70, s70, 1
    s_cmp_eq_u32 s70, 0
    s_cbranch_scc1 L_pollok_17
    s_branch L_poll_16
L_pollok_17:
    s_mov_b64 exec, -1
L_cok_13:
    v_mfma_f32_16x16x32_bf16 v[16:19], v[64:67], v[96:99], v[16:19]
    ds_read_b64 v[128:129], v3 offset:448
    v_mfma_f32_16x16x32_bf16 v[20:23], v[64:67], v[100:103], v[20:23]
    buffer_load_dwordx4 v[224:227], v11, s[28:31], s51 offen sc1
    ds_read_b64 v[130:131], v3 offset:456
    v_mfma_f32_16x16x32_bf16 v[24:27], v[64:67], v[104:107], v[24:27]
    ds_read_b128 v[160:163], v4 offset:4032
    v_mfma_f32_16x16x32_bf16 v[28:31], v[64:67], v[108:111], v[28:31]
    ds_read_b64 v[132:133], v3 offset:960
    v_mfma_f32_16x16x32_bf16 v[32:35], v[64:67], v[112:115], v[32:35]
    ds_read_b64 v[134:135], v3 offset:968
    v_mfma_f32_16x16x32_bf16 v[36:39], v[64:67], v[116:119], v[36:39]
    buffer_load_dwordx4 v[228:231], v11, s[28:31], s51 offen offset:2304 sc1
    ds_read_b128 v[164:167], v4 offset:3520
    v_mfma_f32_16x16x32_bf16 v[40:43], v[64:67], v[120:123], v[40:43]
    v_mfma_f32_16x16x32_bf16 v[44:47], v[64:67], v[124:127], v[44:47]
    ds_read_b64 v[136:137], v3 offset:1472
    v_mfma_f32_16x16x32_bf16 v[20:23], v[68:71], v[96:99], v[20:23]
    ds_read_b64 v[138:139], v3 offset:1480
    v_mfma_f32_16x16x32_bf16 v[24:27], v[68:71], v[100:103], v[24:27]
    ds_read_b128 v[168:171], v4 offset:3008
    buffer_load_dwordx4 v[232:235], v11, s[28:31], s52 offen sc1
    v_mfma_f32_16x16x32_bf16 v[28:31], v[68:71], v[104:107], v[28:31]
    ds_read_b64 v[140:141], v3 offset:1984
    v_mfma_f32_16x16x32_bf16 v[32:35], v[68:71], v[108:111], v[32:35]
    ds_read_b64 v[142:143], v3 offset:1992
    v_mfma_f32_16x16x32_bf16 v[36:39], v[68:71], v[112:115], v[36:39]
    ds_read_b128 v[172:175], v4 offset:2496
    v_mfma_f32_16x16x32_bf16 v[40:43], v[68:71], v[116:119], v[40:43]
    v_mfma_f32_16x16x32_bf16 v[44:47], v[68:71], v[120:123], v[44:47]
    buffer_load_dwordx4 v[236:239], v12, s[28:31], s51 offen sc1
    ds_read_b64 v[144:145], v3 offset:2496
    v_mfma_f32_16x16x32_bf16 v[24:27], v[72:75], v[96:99], v[24:27]
    ds_read_b64 v[146:147], v3 offset:2504
    v_mfma_f32_16x16x32_bf16 v[28:31], v[72:75], v[100:103], v[28:31]
    ds_read_b128 v[176:179], v4 offset:1984
    v_mfma_f32_16x16x32_bf16 v[32:35], v[72:75], v[104:107], v[32:35]
    ds_read_b64 v[148:149], v3 offset:3008
    v_mfma_f32_16x16x32_bf16 v[36:39], v[72:75], v[108:111], v[36:39]
    ds_read_b64 v[150:151], v3 offset:3016
    buffer_load_dwordx4 v[240:243], v12, s[28:31], s51 offen offset:2304 sc1
    v_mfma_f32_16x16x32_bf16 v[40:43], v[72:75], v[112:115], v[40:43]
    ds_read_b128 v[180:183], v4 offset:1472
    v_mfma_f32_16x16x32_bf16 v[44:47], v[72:75], v[116:119], v[44:47]
    v_mfma_f32_16x16x32_bf16 v[28:31], v[76:79], v[96:99], v[28:31]
    ds_read_b64 v[152:153], v3 offset:3520
    v_mfma_f32_16x16x32_bf16 v[32:35], v[76:79], v[100:103], v[32:35]
    ds_read_b64 v[154:155], v3 offset:3528
    v_mfma_f32_16x16x32_bf16 v[36:39], v[76:79], v[104:107], v[36:39]
    buffer_load_dwordx4 v[244:247], v12, s[28:31], s52 offen sc1
    ds_read_b128 v[184:187], v4 offset:960
    v_mfma_f32_16x16x32_bf16 v[40:43], v[76:79], v[108:111], v[40:43]
    ds_read_b64 v[156:157], v3 offset:4032
    v_mfma_f32_16x16x32_bf16 v[44:47], v[76:79], v[112:115], v[44:47]
    ds_read_b64 v[158:159], v3 offset:4040
    v_mfma_f32_16x16x32_bf16 v[32:35], v[80:83], v[96:99], v[32:35]
    ds_read_b128 v[188:191], v4 offset:448
    v_mfma_f32_16x16x32_bf16 v[36:39], v[80:83], v[100:103], v[36:39]
    buffer_load_dwordx2 v[208:209], v10, s[28:31], s49 offen offset:0 sc1
    v_mfma_f32_16x16x32_bf16 v[40:43], v[80:83], v[104:107], v[40:43]
    v_mfma_f32_16x16x32_bf16 v[44:47], v[80:83], v[108:111], v[44:47]
    v_mfma_f32_16x16x32_bf16 v[36:39], v[84:87], v[96:99], v[36:39]
    v_mfma_f32_16x16x32_bf16 v[40:43], v[84:87], v[100:103], v[40:43]
    v_mfma_f32_16x16x32_bf16 v[44:47], v[84:87], v[104:107], v[44:47]
    v_mfma_f32_16x16x32_bf16 v[40:43], v[88:91], v[96:99], v[40:43]
    v_mfma_f32_16x16x32_bf16 v[44:47], v[88:91], v[100:103], v[44:47]
    v_mfma_f32_16x16x32_bf16 v[44:47], v[92:95], v[96:99], v[44:47]
    s_waitcnt lgkmcnt(0)
    v_mfma_f32_16x16x32_bf16 v[16:19], v[128:131], v[160:163], v[16:19]
    ds_read_b64 v[64:65], v1 offset:3584
    v_mfma_f32_16x16x32_bf16 v[20:23], v[128:131], v[164:167], v[20:23]
    buffer_load_dwordx2 v[210:211], v10, s[28:31], s49 offen offset:1024 sc1
    v_mfma_f32_16x16x32_bf16 v[24:27], v[128:131], v[168:171], v[24:27]
    v_mfma_f32_16x16x32_bf16 v[28:31], v[128:131], v[172:175], v[28:31]
    ds_read_b64 v[66:67], v1 offset:3072
    v_mfma_f32_16x16x32_bf16 v[32:35], v[128:131], v[176:179], v[32:35]
    v_mfma_f32_16x16x32_bf16 v[36:39], v[128:131], v[180:183], v[36:39]
    v_mfma_f32_16x16x32_bf16 v[40:43], v[128:131], v[184:187], v[40:43]
    buffer_load_dwordx2 v[212:213], v10, s[28:31], s49 offen offset:2048 sc1
    v_mfma_f32_16x16x32_bf16 v[44:47], v[128:131], v[188:191], v[44:47]
    ds_read_b64 v[68:69], v1 offset:2560
    v_mfma_f32_16x16x32_bf16 v[20:23], v[132:135], v[160:163], v[20:23]
    v_mfma_f32_16x16x32_bf16 v[24:27], v[132:135], v[164:167], v[24:27]
    v_mfma_f32_16x16x32_bf16 v[28:31], v[132:135], v[168:171], v[28:31]
    ds_read_b64 v[70:71], v1 offset:2048
    buffer_load_dwordx2 v[214:215], v10, s[28:31], s49 offen offset:3072 sc1
    v_mfma_f32_16x16x32_bf16 v[32:35], v[132:135], v[172:175], v[32:35]
    v_mfma_f32_16x16x32_bf16 v[36:39], v[132:135], v[176:179], v[36:39]
    v_mfma_f32_16x16x32_bf16 v[40:43], v[132:135], v[180:183], v[40:43]
    v_mfma_f32_16x16x32_bf16 v[44:47], v[132:135], v[184:187], v[44:47]
    ds_read_b64 v[72:73], v1 offset:1536
    v_mfma_f32_16x16x32_bf16 v[24:27], v[136:139], v[160:163], v[24:27]
    buffer_load_dwordx2 v[216:217], v10, s[28:31], s50 offen offset:0 sc1
    v_mfma_f32_16x16x32_bf16 v[28:31], v[136:139], v[164:167], v[28:31]
    v_mfma_f32_16x16x32_bf16 v[32:35], v[136:139], v[168:171], v[32:35]
    ds_read_b64 v[74:75], v1 offset:1024
    v_mfma_f32_16x16x32_bf16 v[36:39], v[136:139], v[172:175], v[36:39]
    v_mfma_f32_16x16x32_bf16 v[40:43], v[136:139], v[176:179], v[40:43]
    v_mfma_f32_16x16x32_bf16 v[44:47], v[136:139], v[180:183], v[44:47]
    buffer_load_dwordx2 v[218:219], v10, s[28:31], s50 offen offset:1024 sc1
    v_mfma_f32_16x16x32_bf16 v[28:31], v[140:143], v[160:163], v[28:31]
    ds_read_b64 v[76:77], v1 offset:512
    v_mfma_f32_16x16x32_bf16 v[32:35], v[140:143], v[164:167], v[32:35]
    v_mfma_f32_16x16x32_bf16 v[36:39], v[140:143], v[168:171], v[36:39]
    v_mfma_f32_16x16x32_bf16 v[40:43], v[140:143], v[172:175], v[40:43]
    ds_read_b64 v[78:79], v1 offset:0
    buffer_load_dwordx2 v[220:221], v10, s[28:31], s50 offen offset:2048 sc1
    v_mfma_f32_16x16x32_bf16 v[44:47], v[140:143], v[176:179], v[44:47]
    v_mfma_f32_16x16x32_bf16 v[32:35], v[144:147], v[160:163], v[32:35]
    v_mfma_f32_16x16x32_bf16 v[36:39], v[144:147], v[164:167], v[36:39]
    v_mfma_f32_16x16x32_bf16 v[40:43], v[144:147], v[168:171], v[40:43]
    v_mfma_f32_16x16x32_bf16 v[44:47], v[144:147], v[172:175], v[44:47]
    v_mfma_f32_16x16x32_bf16 v[36:39], v[148:151], v[160:163], v[36:39]
    buffer_load_dwordx2 v[222:223], v10, s[28:31], s50 offen offset:3072 sc1
    v_mfma_f32_16x16x32_bf16 v[40:43], v[148:151], v[164:167], v[40:43]
    v_mfma_f32_16x16x32_bf16 v[44:47], v[148:151], v[168:171], v[44:47]
    v_mfma_f32_16x16x32_bf16 v[40:43], v[152:155], v[160:163], v[40:43]
    v_mfma_f32_16x16x32_bf16 v[44:47], v[152:155], v[164:167], v[44:47]
    v_mfma_f32_16x16x32_bf16 v[44:47], v[156:159], v[160:163], v[44:47]
    s_mul_i32 s3, s34, 4128
    s_add_u32 s3, s3, 84992
    v_add_u32 v5, s3, v5
    v_bfe_u32 v3, v2, 2, 2
    v_mul_u32_u24 v3, 4128, v3
    v_lshl_add_u32 v3, v7, 5, v3
    v_and_b32 v4, 3, v2
    v_lshl_add_u32 v3, v4, 3, v3
    s_lshl_b32 s3, s34, 10
    s_add_u32 s3, s3, 84992
    v_add_u32 v3, s3, v3
    s_waitcnt lgkmcnt(0)
    v_and_b32 v80, 0xffff0000, v65
    v_lshlrev_b32 v81, 16, v65
    v_and_b32 v82, 0xffff0000, v64
    v_lshlrev_b32 v83, 16, v64
    v_pk_fma_f32 v[16:17], v[80:81], s[84:85], v[16:17]
    v_pk_fma_f32 v[18:19], v[82:83], s[84:85], v[18:19]
    v_cvt_pk_bf16_f32 v64, v16, v17
    v_cvt_pk_bf16_f32 v65, v18, v19
    ds_write_b64 v5, v[64:65] offset:0
    v_and_b32 v80, 0xffff0000, v67
    v_lshlrev_b32 v81, 16, v67
    v_and_b32 v82, 0xffff0000, v66
    v_lshlrev_b32 v83, 16, v66
    v_pk_fma_f32 v[20:21], v[80:81], s[84:85], v[20:21]
    v_pk_fma_f32 v[22:23], v[82:83], s[84:85], v[22:23]
    v_cvt_pk_bf16_f32 v66, v20, v21
    v_cvt_pk_bf16_f32 v67, v22, v23
    ds_write_b64 v5, v[66:67] offset:512
    v_and_b32 v80, 0xffff0000, v69
    v_lshlrev_b32 v81, 16, v69
    v_and_b32 v82, 0xffff0000, v68
    v_lshlrev_b32 v83, 16, v68
    v_pk_fma_f32 v[24:25], v[80:81], s[84:85], v[24:25]
    v_pk_fma_f32 v[26:27], v[82:83], s[84:85], v[26:27]
    v_cvt_pk_bf16_f32 v68, v24, v25
    v_cvt_pk_bf16_f32 v69, v26, v27
    ds_write_b64 v5, v[68:69] offset:1024
    v_and_b32 v80, 0xffff0000, v71
    v_lshlrev_b32 v81, 16, v71
    v_and_b32 v82, 0xffff0000, v70
    v_lshlrev_b32 v83, 16, v70
    v_pk_fma_f32 v[28:29], v[80:81], s[84:85], v[28:29]
    v_pk_fma_f32 v[30:31], v[82:83], s[84:85], v[30:31]
    v_cvt_pk_bf16_f32 v70, v28, v29
    v_cvt_pk_bf16_f32 v71, v30, v31
    ds_write_b64 v5, v[70:71] offset:1536
    v_and_b32 v80, 0xffff0000, v73
    v_lshlrev_b32 v81, 16, v73
    v_and_b32 v82, 0xffff0000, v72
    v_lshlrev_b32 v83, 16, v72
    v_pk_fma_f32 v[32:33], v[80:81], s[84:85], v[32:33]
    v_pk_fma_f32 v[34:35], v[82:83], s[84:85], v[34:35]
    v_cvt_pk_bf16_f32 v72, v32, v33
    v_cvt_pk_bf16_f32 v73, v34, v35
    ds_write_b64 v5, v[72:73] offset:2048
    v_and_b32 v80, 0xffff0000, v75
    v_lshlrev_b32 v81, 16, v75
    v_and_b32 v82, 0xffff0000, v74
    v_lshlrev_b32 v83, 16, v74
    v_pk_fma_f32 v[36:37], v[80:81], s[84:85], v[36:37]
    v_pk_fma_f32 v[38:39], v[82:83], s[84:85], v[38:39]
    v_cvt_pk_bf16_f32 v74, v36, v37
    v_cvt_pk_bf16_f32 v75, v38, v39
    ds_write_b64 v5, v[74:75] offset:2560
    v_and_b32 v80, 0xffff0000, v77
    v_lshlrev_b32 v81, 16, v77
    v_and_b32 v82, 0xffff0000, v76
    v_lshlrev_b32 v83, 16, v76
    v_pk_fma_f32 v[40:41], v[80:81], s[84:85], v[40:41]
    v_pk_fma_f32 v[42:43], v[82:83], s[84:85], v[42:43]
    v_cvt_pk_bf16_f32 v76, v40, v41
    v_cvt_pk_bf16_f32 v77, v42, v43
    ds_write_b64 v5, v[76:77] offset:3072
    v_and_b32 v80, 0xffff0000, v79
    v_lshlrev_b32 v81, 16, v79
    v_and_b32 v82, 0xffff0000, v78
    v_lshlrev_b32 v83, 16, v78
    v_pk_fma_f32 v[44:45], v[80:81], s[84:85], v[44:45]
    v_pk_fma_f32 v[46:47], v[82:83], s[84:85], v[46:47]
    v_cvt_pk_bf16_f32 v78, v44, v45
    v_cvt_pk_bf16_f32 v79, v46, v47
    ds_write_b64 v5, v[78:79] offset:3584
    v_lshrrev_b32 v6, 5, v2
    v_mul_u32_u24 v6, 36864, v6
    v_bfe_u32 v9, v2, 2, 1
    v_lshl_add_u32 v6, v9, 3, v6
    v_bfe_u32 v9, v2, 3, 2
    v_lshl_add_u32 v6, v9, 6, v6
    v_lshl_add_u32 v6, v4, 4, v6
    s_mul_i32 s3, s34, 589824
    s_lshl_b32 s10, s82, 8
    s_add_u32 s3, s3, s10
    s_waitcnt lgkmcnt(0)
    s_barrier
    ds_read_b64_tr_b16 v[16:17], v3 offset:0
    ds_read_b64_tr_b16 v[18:19], v3 offset:128
    ds_read_b64_tr_b16 v[20:21], v3 offset:256
    ds_read_b64_tr_b16 v[22:23], v3 offset:384
    ds_read_b64_tr_b16 v[24:25], v3 offset:512
    ds_read_b64_tr_b16 v[26:27], v3 offset:640
    ds_read_b64_tr_b16 v[28:29], v3 offset:768
    ds_read_b64_tr_b16 v[30:31], v3 offset:896
    s_waitcnt vmcnt(0)
    v_pk_add_f32 v[224:225], v[224:225], v[236:237]
    v_cvt_pk_bf16_f32 v225, v224, v225
    v_lshlrev_b32 v224, 16, v225
    v_and_b32 v225, 0xffff0000, v225
    v_pk_add_f32 v[226:227], v[226:227], v[238:239]
    v_cvt_pk_bf16_f32 v227, v226, v227
    v_lshlrev_b32 v226, 16, v227
    v_and_b32 v227, 0xffff0000, v227
    v_pk_add_f32 v[228:229], v[228:229], v[240:241]
    v_cvt_pk_bf16_f32 v229, v228, v229
    v_lshlrev_b32 v228, 16, v229
    v_and_b32 v229, 0xffff0000, v229
    v_pk_add_f32 v[230:231], v[230:231], v[242:243]
    v_cvt_pk_bf16_f32 v231, v230, v231
    v_lshlrev_b32 v230, 16, v231
    v_and_b32 v231, 0xffff0000, v231
    v_pk_add_f32 v[232:233], v[232:233], v[244:245]
    v_cvt_pk_bf16_f32 v233, v232, v233
    v_lshlrev_b32 v232, 16, v233
    v_and_b32 v233, 0xffff0000, v233
    v_pk_add_f32 v[234:235], v[234:235], v[246:247]
    v_cvt_pk_bf16_f32 v235, v234, v235
    v_lshlrev_b32 v234, 16, v235
    v_and_b32 v235, 0xffff0000, v235
    v_pk_add_f32 v[228:229], v[228:229], 1.0 op_sel_hi:[1,0]
    v_cvt_pk_bf16_f32 v229, v228, v229
    v_lshlrev_b32 v228, 16, v229
    v_and_b32 v229, 0xffff0000, v229
    v_pk_add_f32 v[230:231], v[230:231], 1.0 op_sel_hi:[1,0]
    v_cvt_pk_bf16_f32 v231, v230, v231
    v_lshlrev_b32 v230, 16, v231
    v_and_b32 v231, 0xffff0000, v231
    v_pk_mul_f32 v[224:225], v[224:225], v[232:233]
    v_pk_mul_f32 v[226:227], v[226:227], v[234:235]
    v_pk_mul_f32 v[228:229], v[228:229], v[232:233]
    v_pk_mul_f32 v[230:231], v[230:231], v[234:235]
    s_waitcnt lgkmcnt(0)
    v_lshlrev_b32 v32, 16, v16
    v_and_b32 v33, 0xffff0000, v16
    v_lshlrev_b32 v36, 16, v192
    v_and_b32 v37, 0xffff0000, v192
    v_lshlrev_b32 v34, 16, v17
    v_and_b32 v35, 0xffff0000, v17
    v_lshlrev_b32 v38, 16, v193
    v_and_b32 v39, 0xffff0000, v193
    v_pk_fma_f32 v[40:41], v[36:37], v[208:209], v[208:209] op_sel:[0,0,1] op_sel_hi:[1,0,1]
    v_pk_fma_f32 v[42:43], v[38:39], v[208:209], v[208:209] op_sel:[0,0,1] op_sel_hi:[1,0,1]
    v_pk_fma_f32 v[40:41], v[40:41], v[228:229], v[224:225]
    v_pk_fma_f32 v[42:43], v[42:43], v[230:231], v[226:227]
    v_pk_fma_f32 v[40:41], v[40:41], v[32:33], v[36:37]
    v_pk_fma_f32 v[42:43], v[42:43], v[34:35], v[38:39]
    v_cvt_pk_bf16_f32 v16, v40, v41
    v_cvt_pk_bf16_f32 v17, v42, v43
    buffer_store_dwordx2 v[16:17], v6, s[24:27], s3 offen sc1
    s_add_u32 s3, s3, 73728
    v_lshlrev_b32 v44, 16, v18
    v_and_b32 v45, 0xffff0000, v18
    v_lshlrev_b32 v48, 16, v194
    v_and_b32 v49, 0xffff0000, v194
    v_lshlrev_b32 v46, 16, v19
    v_and_b32 v47, 0xffff0000, v19
    v_lshlrev_b32 v50, 16, v195
    v_and_b32 v51, 0xffff0000, v195
    v_pk_fma_f32 v[52:53], v[48:49], v[210:211], v[210:211] op_sel:[0,0,1] op_sel_hi:[1,0,1]
    v_pk_fma_f32 v[54:55], v[50:51], v[210:211], v[210:211] op_sel:[0,0,1] op_sel_hi:[1,0,1]
    v_pk_fma_f32 v[52:53], v[52:53], v[228:229], v[224:225]
    v_pk_fma_f32 v[54:55], v[54:55], v[230:231], v[226:227]
    v_pk_fma_f32 v[52:53], v[52:53], v[44:45], v[48:49]
    v_pk_fma_f32 v[54:55], v[54:55], v[46:47], v[50:51]
    v_cvt_pk_bf16_f32 v18, v52, v53
    v_cvt_pk_bf16_f32 v19, v54, v55
    buffer_store_dwordx2 v[18:19], v6, s[24:27], s3 offen sc1
    s_add_u32 s3, s3, 73728
    v_lshlrev_b32 v32, 16, v20
    v_and_b32 v33, 0xffff0000, v20
    v_lshlrev_b32 v36, 16, v196
    v_and_b32 v37, 0xffff0000, v196
    v_lshlrev_b32 v34, 16, v21
    v_and_b32 v35, 0xffff0000, v21
    v_lshlrev_b32 v38, 16, v197
    v_and_b32 v39, 0xffff0000, v197
    v_pk_fma_f32 v[40:41], v[36:37], v[212:213], v[212:213] op_sel:[0,0,1] op_sel_hi:[1,0,1]
    v_pk_fma_f32 v[42:43], v[38:39], v[212:213], v[212:213] op_sel:[0,0,1] op_sel_hi:[1,0,1]
    v_pk_fma_f32 v[40:41], v[40:41], v[228:229], v[224:225]
    v_pk_fma_f32 v[42:43], v[42:43], v[230:231], v[226:227]
    v_pk_fma_f32 v[40:41], v[40:41], v[32:33], v[36:37]
    v_pk_fma_f32 v[42:43], v[42:43], v[34:35], v[38:39]
    v_cvt_pk_bf16_f32 v20, v40, v41
    v_cvt_pk_bf16_f32 v21, v42, v43
    buffer_store_dwordx2 v[20:21], v6, s[24:27], s3 offen sc1
    s_add_u32 s3, s3, 73728
    v_lshlrev_b32 v44, 16, v22
    v_and_b32 v45, 0xffff0000, v22
    v_lshlrev_b32 v48, 16, v198
    v_and_b32 v49, 0xffff0000, v198
    v_lshlrev_b32 v46, 16, v23
    v_and_b32 v47, 0xffff0000, v23
    v_lshlrev_b32 v50, 16, v199
    v_and_b32 v51, 0xffff0000, v199
    v_pk_fma_f32 v[52:53], v[48:49], v[214:215], v[214:215] op_sel:[0,0,1] op_sel_hi:[1,0,1]
    v_pk_fma_f32 v[54:55], v[50:51], v[214:215], v[214:215] op_sel:[0,0,1] op_sel_hi:[1,0,1]
    v_pk_fma_f32 v[52:53], v[52:53], v[228:229], v[224:225]
    v_pk_fma_f32 v[54:55], v[54:55], v[230:231], v[226:227]
    v_pk_fma_f32 v[52:53], v[52:53], v[44:45], v[48:49]
    v_pk_fma_f32 v[54:55], v[54:55], v[46:47], v[50:51]
    v_cvt_pk_bf16_f32 v22, v52, v53
    v_cvt_pk_bf16_f32 v23, v54, v55
    buffer_store_dwordx2 v[22:23], v6, s[24:27], s3 offen sc1
    s_add_u32 s3, s3, 73728
    v_lshlrev_b32 v32, 16, v24
    v_and_b32 v33, 0xffff0000, v24
    v_lshlrev_b32 v36, 16, v200
    v_and_b32 v37, 0xffff0000, v200
    v_lshlrev_b32 v34, 16, v25
    v_and_b32 v35, 0xffff0000, v25
    v_lshlrev_b32 v38, 16, v201
    v_and_b32 v39, 0xffff0000, v201
    v_pk_fma_f32 v[40:41], v[36:37], v[216:217], v[216:217] op_sel:[0,0,1] op_sel_hi:[1,0,1]
    v_pk_fma_f32 v[42:43], v[38:39], v[216:217], v[216:217] op_sel:[0,0,1] op_sel_hi:[1,0,1]
    v_pk_fma_f32 v[40:41], v[40:41], v[228:229], v[224:225]
    v_pk_fma_f32 v[42:43], v[42:43], v[230:231], v[226:227]
    v_pk_fma_f32 v[40:41], v[40:41], v[32:33], v[36:37]
    v_pk_fma_f32 v[42:43], v[42:43], v[34:35], v[38:39]
    v_cvt_pk_bf16_f32 v24, v40, v41
    v_cvt_pk_bf16_f32 v25, v42, v43
    buffer_store_dwordx2 v[24:25], v6, s[24:27], s3 offen sc1
    s_add_u32 s3, s3, 73728
    v_lshlrev_b32 v44, 16, v26
    v_and_b32 v45, 0xffff0000, v26
    v_lshlrev_b32 v48, 16, v202
    v_and_b32 v49, 0xffff0000, v202
    v_lshlrev_b32 v46, 16, v27
    v_and_b32 v47, 0xffff0000, v27
    v_lshlrev_b32 v50, 16, v203
    v_and_b32 v51, 0xffff0000, v203
    v_pk_fma_f32 v[52:53], v[48:49], v[218:219], v[218:219] op_sel:[0,0,1] op_sel_hi:[1,0,1]
    v_pk_fma_f32 v[54:55], v[50:51], v[218:219], v[218:219] op_sel:[0,0,1] op_sel_hi:[1,0,1]
    v_pk_fma_f32 v[52:53], v[52:53], v[228:229], v[224:225]
    v_pk_fma_f32 v[54:55], v[54:55], v[230:231], v[226:227]
    v_pk_fma_f32 v[52:53], v[52:53], v[44:45], v[48:49]
    v_pk_fma_f32 v[54:55], v[54:55], v[46:47], v[50:51]
    v_cvt_pk_bf16_f32 v26, v52, v53
    v_cvt_pk_bf16_f32 v27, v54, v55
    buffer_store_dwordx2 v[26:27], v6, s[24:27], s3 offen sc1
    s_add_u32 s3, s3, 73728
    v_lshlrev_b32 v32, 16, v28
    v_and_b32 v33, 0xffff0000, v28
    v_lshlrev_b32 v36, 16, v204
    v_and_b32 v37, 0xffff0000, v204
    v_lshlrev_b32 v34, 16, v29
    v_and_b32 v35, 0xffff0000, v29
    v_lshlrev_b32 v38, 16, v205
    v_and_b32 v39, 0xffff0000, v205
    v_pk_fma_f32 v[40:41], v[36:37], v[220:221], v[220:221] op_sel:[0,0,1] op_sel_hi:[1,0,1]
    v_pk_fma_f32 v[42:43], v[38:39], v[220:221], v[220:221] op_sel:[0,0,1] op_sel_hi:[1,0,1]
    v_pk_fma_f32 v[40:41], v[40:41], v[228:229], v[224:225]
    v_pk_fma_f32 v[42:43], v[42:43], v[230:231], v[226:227]
    v_pk_fma_f32 v[40:41], v[40:41], v[32:33], v[36:37]
    v_pk_fma_f32 v[42:43], v[42:43], v[34:35], v[38:39]
    v_cvt_pk_bf16_f32 v28, v40, v41
    v_cvt_pk_bf16_f32 v29, v42, v43
    buffer_store_dwordx2 v[28:29], v6, s[24:27], s3 offen sc1
    s_add_u32 s3, s3, 73728
    v_lshlrev_b32 v44, 16, v30
    v_and_b32 v45, 0xffff0000, v30
    v_lshlrev_b32 v48, 16, v206
    v_and_b32 v49, 0xffff0000, v206
    v_lshlrev_b32 v46, 16, v31
    v_and_b32 v47, 0xffff0000, v31
    v_lshlrev_b32 v50, 16, v207
    v_and_b32 v51, 0xffff0000, v207
    v_pk_fma_f32 v[52:53], v[48:49], v[222:223], v[222:223] op_sel:[0,0,1] op_sel_hi:[1,0,1]
    v_pk_fma_f32 v[54:55], v[50:51], v[222:223], v[222:223] op_sel:[0,0,1] op_sel_hi:[1,0,1]
    v_pk_fma_f32 v[52:53], v[52:53], v[228:229], v[224:225]
    v_pk_fma_f32 v[54:55], v[54:55], v[230:231], v[226:227]
    v_pk_fma_f32 v[52:53], v[52:53], v[44:45], v[48:49]
    v_pk_fma_f32 v[54:55], v[54:55], v[46:47], v[50:51]
    v_cvt_pk_bf16_f32 v30, v52, v53
    v_cvt_pk_bf16_f32 v31, v54, v55
    buffer_store_dwordx2 v[30:31], v6, s[24:27], s3 offen sc1
    s_and_b32 s3, s2, 7
    s_lshr_b32 s10, s2, 3
    s_and_b32 s32, s3, 1
    s_lshl_b32 s32, s32, 3
    s_and_b32 s11, s10, 7
    s_add_u32 s32, s32, s11
    s_lshr_b32 s33, s3, 1
    s_lshl_b32 s33, s33, 2
    s_lshr_b32 s11, s10, 3
    s_add_u32 s33, s33, s11
    s_add_u32 s28, s8, 0x10000
    s_addc_u32 s29, s9, 0
    s_mov_b32 s30, 0x40000
    s_mov_b32 s31, 0x00020000
    v_lshlrev_b32 v1, 2, v2
    v_mov_b32 v8, -1
    s_lshl_b32 s11, s32, 2
    s_add_u32 s11, s11, s34
    s_lshl_b32 s11, s11, 12
    s_lshl_b32 s10, s33, 8
    s_add_u32 s11, s11, s10
    buffer_store_dword v8, v1, s[28:31], s11 offen sc1
    v_min_u32 v7, 8, v2
    s_mul_i32 s10, s33, 9
    s_add_u32 s10, s10, 144
    v_add_u32 v7, s10, v7
    v_lshrrev_b32 v7, 2, v7
    v_lshlrev_b32 v7, 7, v7
    v_add_u32 v7, 116736, v7
    buffer_load_dword v59, v7, s[44:47], 0 offen sc1
    s_waitcnt vmcnt(1)
    s_barrier
    s_waitcnt vmcnt(0)
    s_cmp_lg_u32 s34, 0
    s_cbranch_scc1 L_fl_18
    s_lshl_b32 s10, s2, 7
    s_add_u32 s10, s10, 32768
    v_lshlrev_b32 v1, 2, v2
    v_mov_b32 v6, s87
    s_mov_b32 exec_hi, 0
    buffer_store_dword v6, v1, s[44:47], s10 offen sc1
    s_mov_b64 exec, -1
L_fl_18:
    v_cmp_ne_u32 vcc, s87, v59
    s_cbranch_vccnz L_mjoin_2_slow
    s_branch L_mjoin2_4
    s_branch L_mjoin_2
L_frw_5:
    s_load_dwordx2 s[4:5], s[0:1], 56
    s_load_dwordx4 s[36:39], s[0:1], 88
    s_sub_u32 s32, s2, 144
    v_lshrrev_b32 v3, 3, v0
    v_and_b32 v4, 7, v0
    v_mul_u32_u24 v5, 6912, v3
    v_lshl_add_u32 v5, v4, 4, v5
    v_lshlrev_b32 v7, 1, v3
    s_cmp_ge_u32 s32, 54
    s_cselect_b32 s52, 36, 0
    s_add_u32 s52, s52, s32
    s_and_b32 s33, s52, 1
    s_lshr_b32 s35, s52, 1
    s_waitcnt lgkmcnt(0)
    s_load_dword s86, s[8:9], 524288
    s_mov_b32 s12, s36
    s_mov_b32 s13, s37
    s_mov_b32 s14, 0x480
    s_mov_b32 s15, 0x00020000
    s_mov_b32 s16, s38
    s_mov_b32 s17, s39
    s_mov_b32 s18, 0x3cc000
    s_mov_b32 s19, 0x00020000
    s_mul_i32 s3, s33, 576
    buffer_load_ushort v16, v7, s[12:15], s3 offen offset:0
    buffer_load_ushort v17, v7, s[12:15], s3 offen offset:64
    buffer_load_ushort v18, v7, s[12:15], s3 offen offset:128
    buffer_load_ushort v19, v7, s[12:15], s3 offen offset:192
    buffer_load_ushort v20, v7, s[12:15], s3 offen offset:256
    buffer_load_ushort v21, v7, s[12:15], s3 offen offset:320
    buffer_load_ushort v22, v7, s[12:15], s3 offen offset:384
    buffer_load_ushort v23, v7, s[12:15], s3 offen offset:448
    buffer_load_ushort v24, v7, s[12:15], s3 offen offset:512
    s_lshl_b32 s3, s35, 7
    s_mul_i32 s10, s33, 1990656
    s_add_u32 s3, s3, s10
    buffer_load_dwordx4 v[28:31], v5, s[16:19], s3 offen nt
    s_add_u32 s3, s3, 221184
    buffer_load_dwordx4 v[32:35], v5, s[16:19], s3 offen nt
    s_add_u32 s3, s3, 221184
    buffer_load_dwordx4 v[36:39], v5, s[16:19], s3 offen nt
    s_add_u32 s3, s3, 221184
    buffer_load_dwordx4 v[40:43], v5, s[16:19], s3 offen nt
    s_add_u32 s3, s3, 221184
    buffer_load_dwordx4 v[44:47], v5, s[16:19], s3 offen nt
    s_add_u32 s3, s3, 221184
    buffer_load_dwordx4 v[48:51], v5, s[16:19], s3 offen nt
    s_add_u32 s3, s3, 221184
    buffer_load_dwordx4 v[52:55], v5, s[16:19], s3 offen nt
    s_add_u32 s3, s3, 221184
    buffer_load_dwordx4 v[56:59], v5, s[16:19], s3 offen nt
    s_add_u32 s3, s3, 221184
    buffer_load_dwordx4 v[60:63], v5, s[16:19], s3 offen nt
    s_mov_b32 s16, s8
    s_mov_b32 s17, s9
    s_mov_b32 s18, 0x10000
    s_mov_b32 s19, 0x00020000
    s_add_u32 s44, s8, 0x50000
    s_addc_u32 s45, s9, 0
    s_mov_b32 s46, 0x30000
    s_mov_b32 s47, 0x00020000
    s_cmp_eq_u32 s34, 0
    s_cbranch_scc1 L_gw_19
    s_mov_b32 s12, s4
    s_mov_b32 s13, s5
    s_mov_b32 s14, 0x510000
    s_mov_b32 s15, 0x00020000
    v_lshrrev_b32 v3, 3, v2
    v_mul_u32_u24 v3, 9216, v3
    v_lshl_add_u32 v3, v4, 4, v3
    s_sub_u32 s11, s34, 1
    s_mul_i32 s40, s11, 1769472
    s_lshl_b32 s10, s32, 7
    s_add_u32 s40, s40, s10
    s_mul_i32 s41, s11, 24576
    s_add_u32 m0, s41, 0
    s_nop 0
    buffer_load_dwordx4 v3, s[12:15], s40 offen nt lds
    s_add_u32 s40, s40, 73728
    s_add_u32 m0, s41, 1024
    s_nop 0
    buffer_load_dwordx4 v3, s[12:15], s40 offen nt lds
    s_add_u32 s40, s40, 73728
    s_add_u32 m0, s41, 2048
    s_nop 0
    buffer_load_dwordx4 v3, s[12:15], s40 offen nt lds
    s_add_u32 s40, s40, 73728
    s_add_u32 m0, s41, 3072
    s_nop 0
    buffer_load_dwordx4 v3, s[12:15], s40 offen nt lds
    s_add_u32 s40, s40, 73728
    s_add_u32 m0, s41, 4096
    s_nop 0
    buffer_load_dwordx4 v3, s[12:15], s40 offen nt lds
    s_add_u32 s40, s40, 73728
    s_add_u32 m0, s41, 5120
    s_nop 0
    buffer_load_dwordx4 v3, s[12:15], s40 offen nt lds
    s_add_u32 s40, s40, 73728
    s_add_u32 m0, s41, 6144
    s_nop 0
    buffer_load_dwordx4 v3, s[12:15], s40 offen nt lds
    s_add_u32 s40, s40, 73728
    s_add_u32 m0, s41, 7168
    s_nop 0
    buffer_load_dwordx4 v3, s[12:15], s40 offen nt lds
    s_add_u32 s40, s40, 73728
    s_add_u32 m0, s41, 8192
    s_nop 0
    buffer_load_dwordx4 v3, s[12:15], s40 offen nt lds
    s_add_u32 s40, s40, 73728
    s_add_u32 m0, s41, 9216
    s_nop 0
    buffer_load_dwordx4 v3, s[12:15], s40 offen nt lds
    s_add_u32 s40, s40, 73728
    s_add_u32 m0, s41, 10240
    s_nop 0
    buffer_load_dwordx4 v3, s[12:15], s40 offen nt lds
    s_add_u32 s40, s40, 73728
    s_add_u32 m0, s41, 11264
    s_nop 0
    buffer_load_dwordx4 v3, s[12:15], s40 offen nt lds
    s_add_u32 s40, s40, 73728
    s_waitcnt vmcnt(12)
    s_branch L_gw_20
L_gw_19:
    s_waitcnt vmcnt(0)
L_gw_20:
    s_mov_b32 s10, 0xbfb8aa3b
    v_lshlrev_b32 v16, 16, v16
    v_lshlrev_b32 v17, 16, v17
    v_lshlrev_b32 v18, 16, v18
    v_lshlrev_b32 v19, 16, v19
    v_lshlrev_b32 v20, 16, v20
    v_lshlrev_b32 v21, 16, v21
    v_lshlrev_b32 v22, 16, v22
    v_lshlrev_b32 v23, 16, v23
    v_lshlrev_b32 v24, 16, v24
    v_mul_f32 v64, s10, v16
    v_mul_f32 v65, s10, v17
    v_mul_f32 v66, s10, v18
    v_mul_f32 v67, s10, v19
    v_mul_f32 v68, s10, v20
    v_mul_f32 v69, s10, v21
    v_mul_f32 v70, s10, v22
    v_mul_f32 v71, s10, v23
    v_mul_f32 v72, s10, v24
    v_exp_f32 v64, v64
    v_exp_f32 v65, v65
    v_exp_f32 v66, v66
    v_exp_f32 v67, v67
    v_exp_f32 v68, v68
    v_exp_f32 v69, v69
    v_exp_f32 v70, v70
    v_exp_f32 v71, v71
    v_exp_f32 v72, v72
    v_add_f32 v64, 1.0, v64
    v_add_f32 v65, 1.0, v65
    v_add_f32 v66, 1.0, v66
    v_add_f32 v67, 1.0, v67
    v_add_f32 v68, 1.0, v68
    v_add_f32 v69, 1.0, v69
    v_add_f32 v70, 1.0, v70
    v_add_f32 v71, 1.0, v71
    v_add_f32 v72, 1.0, v72
    v_rcp_f32 v64, v64
    v_rcp_f32 v65, v65
    v_rcp_f32 v66, v66
    v_rcp_f32 v67, v67
    v_rcp_f32 v68, v68
    v_rcp_f32 v69, v69
    v_rcp_f32 v70, v70
    v_rcp_f32 v71, v71
    v_rcp_f32 v72, v72
    v_mul_f32 v64, v64, v16
    v_mul_f32 v65, v65, v17
    v_mul_f32 v66, v66, v18
    v_mul_f32 v67, v67, v19
    v_mul_f32 v68, v68, v20
    v_mul_f32 v69, v69, v21
    v_mul_f32 v70, v70, v22
    v_mul_f32 v71, v71, v23
    v_mul_f32 v72, v72, v24
    v_cvt_pk_bf16_f32 v64, v64, v64
    v_lshlrev_b32 v16, 16, v64
    v_cvt_pk_bf16_f32 v65, v65, v65
    v_lshlrev_b32 v17, 16, v65
    v_cvt_pk_bf16_f32 v66, v66, v66
    v_lshlrev_b32 v18, 16, v66
    v_cvt_pk_bf16_f32 v67, v67, v67
    v_lshlrev_b32 v19, 16, v67
    v_cvt_pk_bf16_f32 v68, v68, v68
    v_lshlrev_b32 v20, 16, v68
    v_cvt_pk_bf16_f32 v69, v69, v69
    v_lshlrev_b32 v21, 16, v69
    v_cvt_pk_bf16_f32 v70, v70, v70
    v_lshlrev_b32 v22, 16, v70
    v_cvt_pk_bf16_f32 v71, v71, v71
    v_lshlrev_b32 v23, 16, v71
    v_cvt_pk_bf16_f32 v72, v72, v72
    v_lshlrev_b32 v24, 16, v72
    v_mov_b32 v8, 0
    v_mov_b32 v9, 0
    v_mov_b32 v10, 0
    v_mov_b32 v11, 0
    v_mov_b32 v12, 0
    v_mov_b32 v13, 0
    v_mov_b32 v14, 0
    v_mov_b32 v15, 0
    v_lshlrev_b32 v7, 5, v0
    v_add_u32 v7, 86016, v7
    v_lshlrev_b32 v26, 16, v28
    v_and_b32 v27, 0xffff0000, v28
    v_fmac_f32 v8, v26, v16
    v_fmac_f32 v9, v27, v16
    v_lshlrev_b32 v26, 16, v29
    v_and_b32 v27, 0xffff0000, v29
    v_fmac_f32 v10, v26, v16
    v_fmac_f32 v11, v27, v16
    v_lshlrev_b32 v26, 16, v30
    v_and_b32 v27, 0xffff0000, v30
    v_fmac_f32 v12, v26, v16
    v_fmac_f32 v13, v27, v16
    v_lshlrev_b32 v26, 16, v31
    v_and_b32 v27, 0xffff0000, v31
    v_fmac_f32 v14, v26, v16
    v_fmac_f32 v15, v27, v16
    v_lshlrev_b32 v26, 16, v32
    v_and_b32 v27, 0xffff0000, v32
    v_fmac_f32 v8, v26, v17
    v_fmac_f32 v9, v27, v17
    v_lshlrev_b32 v26, 16, v33
    v_and_b32 v27, 0xffff0000, v33
    v_fmac_f32 v10, v26, v17
    v_fmac_f32 v11, v27, v17
    v_lshlrev_b32 v26, 16, v34
    v_and_b32 v27, 0xffff0000, v34
    v_fmac_f32 v12, v26, v17
    v_fmac_f32 v13, v27, v17
    v_lshlrev_b32 v26, 16, v35
    v_and_b32 v27, 0xffff0000, v35
    v_fmac_f32 v14, v26, v17
    v_fmac_f32 v15, v27, v17
    v_lshlrev_b32 v26, 16, v36
    v_and_b32 v27, 0xffff0000, v36
    v_fmac_f32 v8, v26, v18
    v_fmac_f32 v9, v27, v18
    v_lshlrev_b32 v26, 16, v37
    v_and_b32 v27, 0xffff0000, v37
    v_fmac_f32 v10, v26, v18
    v_fmac_f32 v11, v27, v18
    v_lshlrev_b32 v26, 16, v38
    v_and_b32 v27, 0xffff0000, v38
    v_fmac_f32 v12, v26, v18
    v_fmac_f32 v13, v27, v18
    v_lshlrev_b32 v26, 16, v39
    v_and_b32 v27, 0xffff0000, v39
    v_fmac_f32 v14, v26, v18
    v_fmac_f32 v15, v27, v18
    v_lshlrev_b32 v26, 16, v40
    v_and_b32 v27, 0xffff0000, v40
    v_fmac_f32 v8, v26, v19
    v_fmac_f32 v9, v27, v19
    v_lshlrev_b32 v26, 16, v41
    v_and_b32 v27, 0xffff0000, v41
    v_fmac_f32 v10, v26, v19
    v_fmac_f32 v11, v27, v19
    v_lshlrev_b32 v26, 16, v42
    v_and_b32 v27, 0xffff0000, v42
    v_fmac_f32 v12, v26, v19
    v_fmac_f32 v13, v27, v19
    v_lshlrev_b32 v26, 16, v43
    v_and_b32 v27, 0xffff0000, v43
    v_fmac_f32 v14, v26, v19
    v_fmac_f32 v15, v27, v19
    v_lshlrev_b32 v26, 16, v44
    v_and_b32 v27, 0xffff0000, v44
    v_fmac_f32 v8, v26, v20
    v_fmac_f32 v9, v27, v20
    v_lshlrev_b32 v26, 16, v45
    v_and_b32 v27, 0xffff0000, v45
    v_fmac_f32 v10, v26, v20
    v_fmac_f32 v11, v27, v20
    v_lshlrev_b32 v26, 16, v46
    v_and_b32 v27, 0xffff0000, v46
    v_fmac_f32 v12, v26, v20
    v_fmac_f32 v13, v27, v20
    v_lshlrev_b32 v26, 16, v47
    v_and_b32 v27, 0xffff0000, v47
    v_fmac_f32 v14, v26, v20
    v_fmac_f32 v15, v27, v20
    v_lshlrev_b32 v26, 16, v48
    v_and_b32 v27, 0xffff0000, v48
    v_fmac_f32 v8, v26, v21
    v_fmac_f32 v9, v27, v21
    v_lshlrev_b32 v26, 16, v49
    v_and_b32 v27, 0xffff0000, v49
    v_fmac_f32 v10, v26, v21
    v_fmac_f32 v11, v27, v21
    v_lshlrev_b32 v26, 16, v50
    v_and_b32 v27, 0xffff0000, v50
    v_fmac_f32 v12, v26, v21
    v_fmac_f32 v13, v27, v21
    v_lshlrev_b32 v26, 16, v51
    v_and_b32 v27, 0xffff0000, v51
    v_fmac_f32 v14, v26, v21
    v_fmac_f32 v15, v27, v21
    v_lshlrev_b32 v26, 16, v52
    v_and_b32 v27, 0xffff0000, v52
    v_fmac_f32 v8, v26, v22
    v_fmac_f32 v9, v27, v22
    v_lshlrev_b32 v26, 16, v53
    v_and_b32 v27, 0xffff0000, v53
    v_fmac_f32 v10, v26, v22
    v_fmac_f32 v11, v27, v22
    v_lshlrev_b32 v26, 16, v54
    v_and_b32 v27, 0xffff0000, v54
    v_fmac_f32 v12, v26, v22
    v_fmac_f32 v13, v27, v22
    v_lshlrev_b32 v26, 16, v55
    v_and_b32 v27, 0xffff0000, v55
    v_fmac_f32 v14, v26, v22
    v_fmac_f32 v15, v27, v22
    v_lshlrev_b32 v26, 16, v56
    v_and_b32 v27, 0xffff0000, v56
    v_fmac_f32 v8, v26, v23
    v_fmac_f32 v9, v27, v23
    v_lshlrev_b32 v26, 16, v57
    v_and_b32 v27, 0xffff0000, v57
    v_fmac_f32 v10, v26, v23
    v_fmac_f32 v11, v27, v23
    v_lshlrev_b32 v26, 16, v58
    v_and_b32 v27, 0xffff0000, v58
    v_fmac_f32 v12, v26, v23
    v_fmac_f32 v13, v27, v23
    v_lshlrev_b32 v26, 16, v59
    v_and_b32 v27, 0xffff0000, v59
    v_fmac_f32 v14, v26, v23
    v_fmac_f32 v15, v27, v23
    v_lshlrev_b32 v26, 16, v60
    v_and_b32 v27, 0xffff0000, v60
    v_fmac_f32 v8, v26, v24
    v_fmac_f32 v9, v27, v24
    v_lshlrev_b32 v26, 16, v61
    v_and_b32 v27, 0xffff0000, v61
    v_fmac_f32 v10, v26, v24
    v_fmac_f32 v11, v27, v24
    v_lshlrev_b32 v26, 16, v62
    v_and_b32 v27, 0xffff0000, v62
    v_fmac_f32 v12, v26, v24
    v_fmac_f32 v13, v27, v24
    v_lshlrev_b32 v26, 16, v63
    v_and_b32 v27, 0xffff0000, v63
    v_fmac_f32 v14, v26, v24
    v_fmac_f32 v15, v27, v24
    ds_write_b128 v7, v[8:11]
    ds_write_b128 v7, v[12:15] offset:16
    s_waitcnt lgkmcnt(0)
    s_mul_i32 s87, s86, 0x9e3779b1
    s_add_u32 s87, s87, 0x7f4a7c15
    s_barrier
    s_cmp_lg_u32 s34, 0
    s_cbranch_scc1 L_mp_21
    v_lshlrev_b32 v7, 2, v2
    v_add_u32 v6, 86016, v7
    ds_read_b32 v160, v6 offset:0
    ds_read_b32 v161, v6 offset:256
    ds_read_b32 v162, v6 offset:512
    ds_read_b32 v163, v6 offset:768
    ds_read_b32 v164, v6 offset:1024
    ds_read_b32 v165, v6 offset:1280
    ds_read_b32 v166, v6 offset:1536
    ds_read_b32 v167, v6 offset:1792
    ds_read_b32 v168, v6 offset:2048
    ds_read_b32 v169, v6 offset:2304
    ds_read_b32 v170, v6 offset:2560
    ds_read_b32 v171, v6 offset:2816
    ds_read_b32 v172, v6 offset:3072
    ds_read_b32 v173, v6 offset:3328
    ds_read_b32 v174, v6 offset:3584
    ds_read_b32 v175, v6 offset:3840
    s_waitcnt lgkmcnt(0)
    ds_read_b32 v176, v6 offset:4096
    ds_read_b32 v177, v6 offset:4352
    ds_read_b32 v178, v6 offset:4608
    ds_read_b32 v179, v6 offset:4864
    ds_read_b32 v180, v6 offset:5120
    ds_read_b32 v181, v6 offset:5376
    ds_read_b32 v182, v6 offset:5632
    ds_read_b32 v183, v6 offset:5888
    ds_read_b32 v184, v6 offset:6144
    ds_read_b32 v185, v6 offset:6400
    ds_read_b32 v186, v6 offset:6656
    ds_read_b32 v187, v6 offset:6912
    ds_read_b32 v188, v6 offset:7168
    ds_read_b32 v189, v6 offset:7424
    ds_read_b32 v190, v6 offset:7680
    ds_read_b32 v191, v6 offset:7936
    s_waitcnt lgkmcnt(0)
    v_add_f32 v160, v160, v176
    v_add_f32 v161, v161, v177
    v_add_f32 v162, v162, v178
    v_add_f32 v163, v163, v179
    v_add_f32 v164, v164, v180
    v_add_f32 v165, v165, v181
    v_add_f32 v166, v166, v182
    v_add_f32 v167, v167, v183
    v_add_f32 v168, v168, v184
    v_add_f32 v169, v169, v185
    v_add_f32 v170, v170, v186
    v_add_f32 v171, v171, v187
    v_add_f32 v172, v172, v188
    v_add_f32 v173, v173, v189
    v_add_f32 v174, v174, v190
    v_add_f32 v175, v175, v191
    v_add_f32 v160, v160, v168
    v_add_f32 v161, v161, v169
    v_add_f32 v162, v162, v170
    v_add_f32 v163, v163, v171
    v_add_f32 v164, v164, v172
    v_add_f32 v165, v165, v173
    v_add_f32 v166, v166, v174
    v_add_f32 v167, v167, v175
    v_add_f32 v160, v160, v164
    v_add_f32 v161, v161, v165
    v_add_f32 v162, v162, v166
    v_add_f32 v163, v163, v167
    v_add_f32 v160, v160, v162
    v_add_f32 v161, v161, v163
    v_add_f32 v160, v160, v161
    s_mul_i32 s3, s33, 13824
    s_lshl_b32 s10, s35, 8
    s_add_u32 s3, s3, s10
    buffer_store_dword v160, v7, s[16:19], s3 offen sc1
    s_waitcnt vmcnt(0)
    s_lshl_b32 s10, s52, 7
    s_add_u32 s10, s10, 83968
    v_lshlrev_b32 v1, 2, v2
    v_mov_b32 v6, s87
    s_mov_b32 exec_hi, 0
    buffer_store_dword v6, v1, s[44:47], s10 offen sc1
    s_mov_b64 exec, -1
    v_min_u32 v9, 35, v2
    v_lshlrev_b32 v9, 7, v9
    s_mov_b32 s3, 90880
    s_mov_b32 s70, 0x20000
L_poll_22:
    buffer_load_dword v6, v9, s[44:47], s3 offen sc1
    s_waitcnt vmcnt(0)
    v_cmp_ne_u32 vcc, s87, v6
    s_cbranch_vccz L_pollok_23
    s_mov_b64 exec, vcc
    s_sub_u32 s70, s70, 1
    s_cmp_eq_u32 s70, 0
    s_cbranch_scc1 L_pollok_23
    s_branch L_poll_22
L_pollok_23:
    s_mov_b64 exec, -1
    v_lshlrev_b32 v5, 4, v2
    v_min_u32 v9, 31, v2
    v_lshlrev_b32 v9, 4, v9
    v_add_u32 v9, 0x1000, v9
    s_mov_b32 s3, 6912
    s_mov_b32 s10, 20736
    buffer_load_dwordx4 v[16:19], v5, s[16:19], s3 offen offset:0 sc1
    buffer_load_dwordx4 v[20:23], v5, s[16:19], s10 offen offset:0 sc1
    buffer_load_dwordx4 v[24:27], v5, s[16:19], s3 offen offset:1024 sc1
    buffer_load_dwordx4 v[28:31], v5, s[16:19], s10 offen offset:1024 sc1
    buffer_load_dwordx4 v[32:35], v5, s[16:19], s3 offen offset:2048 sc1
    buffer_load_dwordx4 v[36:39], v5, s[16:19], s10 offen offset:2048 sc1
    buffer_load_dwordx4 v[40:43], v5, s[16:19], s3 offen offset:3072 sc1
    buffer_load_dwordx4 v[44:47], v5, s[16:19], s10 offen offset:3072 sc1
    buffer_load_dwordx4 v[48:51], v9, s[16:19], s3 offen offset:0 sc1
    buffer_load_dwordx4 v[52:55], v9, s[16:19], s10 offen offset:0 sc1
    v_lshrrev_b32 v10, 1, v5
    v_add_u32 v5, 73728, v5
    v_add_u32 v10, 78848, v10
    v_cmp_lt_u32 vcc, 15, v2
    v_mov_b32 v14, 1.0
    v_mov_b32 v15, 1.0
    v_cndmask_b32 v12, 0, v14, vcc
    v_cndmask_b32 v13, 0, v14, vcc
    s_waitcnt vmcnt(8)
    v_pk_add_f32 v[16:17], v[16:17], v[20:21]
    v_pk_add_f32 v[18:19], v[18:19], v[22:23]
    v_cvt_pk_bf16_f32 v20, v16, v17
    v_cvt_pk_bf16_f32 v21, v18, v19
    v_lshlrev_b32 v16, 16, v20
    v_and_b32 v17, 0xffff0000, v20
    v_lshlrev_b32 v18, 16, v21
    v_and_b32 v19, 0xffff0000, v21
    ds_write_b128 v5, v[16:19] offset:0
    ds_write_b64 v10, v[20:21] offset:0
    s_waitcnt vmcnt(6)
    v_pk_add_f32 v[24:25], v[24:25], v[28:29]
    v_pk_add_f32 v[26:27], v[26:27], v[30:31]
    v_cvt_pk_bf16_f32 v28, v24, v25
    v_cvt_pk_bf16_f32 v29, v26, v27
    v_lshlrev_b32 v24, 16, v28
    v_and_b32 v25, 0xffff0000, v28
    v_lshlrev_b32 v26, 16, v29
    v_and_b32 v27, 0xffff0000, v29
    ds_write_b128 v5, v[24:27] offset:1024
    ds_write_b64 v10, v[28:29] offset:512
    s_waitcnt vmcnt(4)
    v_pk_add_f32 v[32:33], v[32:33], v[36:37]
    v_pk_add_f32 v[34:35], v[34:35], v[38:39]
    v_cvt_pk_bf16_f32 v36, v32, v33
    v_cvt_pk_bf16_f32 v37, v34, v35
    v_lshlrev_b32 v32, 16, v36
    v_and_b32 v33, 0xffff0000, v36
    v_lshlrev_b32 v34, 16, v37
    v_and_b32 v35, 0xffff0000, v37
    v_pk_add_f32 v[32:33], v[32:33], v[12:13]
    v_pk_add_f32 v[34:35], v[34:35], v[12:13]
    v_cvt_pk_bf16_f32 v36, v32, v33
    v_cvt_pk_bf16_f32 v37, v34, v35
    v_lshlrev_b32 v32, 16, v36
    v_and_b32 v33, 0xffff0000, v36
    v_lshlrev_b32 v34, 16, v37
    v_and_b32 v35, 0xffff0000, v37
    ds_write_b128 v5, v[32:35] offset:2048
    ds_write_b64 v10, v[36:37] offset:1024
    s_waitcnt vmcnt(2)
    v_pk_add_f32 v[40:41], v[40:41], v[44:45]
    v_pk_add_f32 v[42:43], v[42:43], v[46:47]
    v_cvt_pk_bf16_f32 v44, v40, v41
    v_cvt_pk_bf16_f32 v45, v42, v43
    v_lshlrev_b32 v40, 16, v44
    v_and_b32 v41, 0xffff0000, v44
    v_lshlrev_b32 v42, 16, v45
    v_and_b32 v43, 0xffff0000, v45
    v_pk_add_f32 v[40:41], v[40:41], v[14:15]
    v_pk_add_f32 v[42:43], v[42:43], v[14:15]
    v_cvt_pk_bf16_f32 v44, v40, v41
    v_cvt_pk_bf16_f32 v45, v42, v43
    v_lshlrev_b32 v40, 16, v44
    v_and_b32 v41, 0xffff0000, v44
    v_lshlrev_b32 v42, 16, v45
    v_and_b32 v43, 0xffff0000, v45
    ds_write_b128 v5, v[40:43] offset:3072
    ds_write_b64 v10, v[44:45] offset:1536
    s_waitcnt vmcnt(0)
    v_pk_add_f32 v[48:49], v[48:49], v[52:53]
    v_pk_add_f32 v[50:51], v[50:51], v[54:55]
    v_cvt_pk_bf16_f32 v52, v48, v49
    v_cvt_pk_bf16_f32 v53, v50, v51
    v_lshlrev_b32 v48, 16, v52
    v_and_b32 v49, 0xffff0000, v52
    v_lshlrev_b32 v50, 16, v53
    v_and_b32 v51, 0xffff0000, v53
    v_pk_add_f32 v[48:49], v[48:49], v[14:15]
    v_pk_add_f32 v[50:51], v[50:51], v[14:15]
    v_cvt_pk_bf16_f32 v52, v48, v49
    v_cvt_pk_bf16_f32 v53, v50, v51
    v_lshlrev_b32 v48, 16, v52
    v_and_b32 v49, 0xffff0000, v52
    v_lshlrev_b32 v50, 16, v53
    v_and_b32 v51, 0xffff0000, v53
    ds_write_b128 v5, v[48:51] offset:4096
    ds_write_b64 v10, v[52:53] offset:2048
L_mp_21:
    s_cmp_eq_u32 s34, 0
    s_cbranch_scc1 L_rs_24
    s_mov_b32 s12, s4
    s_mov_b32 s13, s5
    s_mov_b32 s14, 0x510000
    s_mov_b32 s15, 0x00020000
    s_add_u32 m0, s41, 12288
    s_nop 0
    buffer_load_dwordx4 v3, s[12:15], s40 offen nt lds
    s_add_u32 s40, s40, 73728
    s_add_u32 m0, s41, 13312
    s_nop 0
    buffer_load_dwordx4 v3, s[12:15], s40 offen nt lds
    s_add_u32 s40, s40, 73728
    s_add_u32 m0, s41, 14336
    s_nop 0
    buffer_load_dwordx4 v3, s[12:15], s40 offen nt lds
    s_add_u32 s40, s40, 73728
    s_add_u32 m0, s41, 15360
    s_nop 0
    buffer_load_dwordx4 v3, s[12:15], s40 offen nt lds
    s_add_u32 s40, s40, 73728
    s_add_u32 m0, s41, 16384
    s_nop 0
    buffer_load_dwordx4 v3, s[12:15], s40 offen nt lds
    s_add_u32 s40, s40, 73728
    s_add_u32 m0, s41, 17408
    s_nop 0
    buffer_load_dwordx4 v3, s[12:15], s40 offen nt lds
    s_add_u32 s40, s40, 73728
    s_add_u32 m0, s41, 18432
    s_nop 0
    buffer_load_dwordx4 v3, s[12:15], s40 offen nt lds
    s_add_u32 s40, s40, 73728
    s_add_u32 m0, s41, 19456
    s_nop 0
    buffer_load_dwordx4 v3, s[12:15], s40 offen nt lds
    s_add_u32 s40, s40, 73728
    s_add_u32 m0, s41, 20480
    s_nop 0
    buffer_load_dwordx4 v3, s[12:15], s40 offen nt lds
    s_add_u32 s40, s40, 73728
    s_add_u32 m0, s41, 21504
    s_nop 0
    buffer_load_dwordx4 v3, s[12:15], s40 offen nt lds
    s_add_u32 s40, s40, 73728
    s_add_u32 m0, s41, 22528
    s_nop 0
    buffer_load_dwordx4 v3, s[12:15], s40 offen nt lds
    s_add_u32 s40, s40, 73728
    s_add_u32 m0, s41, 23552
    s_nop 0
    buffer_load_dwordx4 v3, s[12:15], s40 offen nt lds
    s_add_u32 s40, s40, 73728
L_rs_24:
    s_add_u32 s20, s8, 0x810000
    s_addc_u32 s21, s9, 0
    s_mov_b32 s22, 0x510000
    s_mov_b32 s23, 0x00020000
    s_add_u32 s24, s8, 0x7000
    s_addc_u32 s25, s9, 0
    s_mov_b32 s26, 0x4800
    s_mov_b32 s27, 0x00020000
    v_lshlrev_b32 v5, 4, v2
    v_lshrrev_b32 v7, 4, v2
    v_lshrrev_b32 v6, 2, v2
    v_lshlrev_b32 v6, 7, v6
    v_and_b32 v4, 3, v2
    v_lshl_add_u32 v6, v4, 3, v6
    s_lshl_b32 s3, s34, 5
    v_add_u32 v6, s3, v6
    v_add_u32 v8, 0x9000, v6
    v_and_b32 v9, 1, v2
    v_xor_b32 v9, 1, v9
    v_mul_u32_u24 v9, 1152, v9
    v_lshl_add_u32 v9, v7, 3, v9
    v_add_u32 v9, 78848, v9
    v_lshlrev_b32 v7, 4, v7
    v_add_u32 v7, 76032, v7
    s_waitcnt vmcnt(0) lgkmcnt(0)
    s_barrier
    s_mov_b32 s72, s88
    s_mov_b32 s73, s89
    s_mov_b32 s74, 0x800000
    s_mov_b32 s75, 0x00020000
    s_sub_u32 s3, s2, 144
    s_mul_i32 s3, s3, 32768
    s_add_u32 s3, s3, 0
    v_lshlrev_b32 v1, 7, v0
    buffer_load_dword v240, v1, s[72:75], s3 offen
    ds_read_b64_tr_b16 v[96:97], v6 offset:0
    ds_read_b64_tr_b16 v[98:99], v6 offset:2048
    ds_read_b64 v[168:169], v9 offset:0
    ds_read_b64 v[170:171], v9 offset:32
    ds_read_b64_tr_b16 v[100:101], v6 offset:4096
    ds_read_b64_tr_b16 v[102:103], v6 offset:6144
    ds_read_b64 v[172:173], v9 offset:64
    ds_read_b64 v[174:175], v9 offset:96
    ds_read_b64_tr_b16 v[104:105], v6 offset:8192
    ds_read_b64_tr_b16 v[106:107], v6 offset:10240
    ds_read_b64 v[176:177], v9 offset:128
    ds_read_b64 v[178:179], v9 offset:160
    ds_read_b64_tr_b16 v[108:109], v6 offset:12288
    ds_read_b64_tr_b16 v[110:111], v6 offset:14336
    ds_read_b64 v[180:181], v9 offset:192
    ds_read_b64 v[182:183], v9 offset:224
    s_waitcnt lgkmcnt(12)
    v_mfma_f32_16x16x32_bf16 v[12:15], v[168:171], v[96:99], 0
    ds_read_b64_tr_b16 v[112:113], v6 offset:16384
    ds_read_b64_tr_b16 v[114:115], v6 offset:18432
    ds_read_b64 v[184:185], v9 offset:256
    ds_read_b64 v[186:187], v9 offset:288
    s_waitcnt lgkmcnt(12)
    v_mfma_f32_16x16x32_bf16 v[12:15], v[172:175], v[100:103], v[12:15]
    ds_read_b64_tr_b16 v[116:117], v6 offset:20480
    ds_read_b64_tr_b16 v[118:119], v6 offset:22528
    ds_read_b64 v[188:189], v9 offset:320
    ds_read_b64 v[190:191], v9 offset:352
    s_waitcnt lgkmcnt(12)
    v_mfma_f32_16x16x32_bf16 v[12:15], v[176:179], v[104:107], v[12:15]
    ds_read_b64_tr_b16 v[120:121], v6 offset:24576
    ds_read_b64_tr_b16 v[122:123], v6 offset:26624
    ds_read_b64 v[192:193], v9 offset:384
    ds_read_b64 v[194:195], v9 offset:416
    s_waitcnt lgkmcnt(12)
    v_mfma_f32_16x16x32_bf16 v[12:15], v[180:183], v[108:111], v[12:15]
    ds_read_b64_tr_b16 v[124:125], v6 offset:28672
    ds_read_b64_tr_b16 v[126:127], v6 offset:30720
    ds_read_b64 v[196:197], v9 offset:448
    ds_read_b64 v[198:199], v9 offset:480
    s_waitcnt lgkmcnt(12)
    v_mfma_f32_16x16x32_bf16 v[12:15], v[184:187], v[112:115], v[12:15]
    ds_read_b64_tr_b16 v[128:129], v6 offset:32768
    ds_read_b64_tr_b16 v[130:131], v6 offset:34816
    ds_read_b64 v[200:201], v9 offset:512
    ds_read_b64 v[202:203], v9 offset:544
    s_waitcnt lgkmcnt(12)
    v_mfma_f32_16x16x32_bf16 v[12:15], v[188:191], v[116:119], v[12:15]
    ds_read_b64_tr_b16 v[132:133], v8 offset:0
    ds_read_b64_tr_b16 v[134:135], v8 offset:2048
    ds_read_b64 v[204:205], v9 offset:576
    ds_read_b64 v[206:207], v9 offset:608
    s_waitcnt lgkmcnt(12)
    v_mfma_f32_16x16x32_bf16 v[12:15], v[192:195], v[120:123], v[12:15]
    ds_read_b64_tr_b16 v[136:137], v8 offset:4096
    ds_read_b64_tr_b16 v[138:139], v8 offset:6144
    ds_read_b64 v[208:209], v9 offset:640
    ds_read_b64 v[210:211], v9 offset:672
    s_waitcnt lgkmcnt(12)
    v_mfma_f32_16x16x32_bf16 v[12:15], v[196:199], v[124:127], v[12:15]
    ds_read_b64_tr_b16 v[140:141], v8 offset:8192
    ds_read_b64_tr_b16 v[142:143], v8 offset:10240
    ds_read_b64 v[212:213], v9 offset:704
    ds_read_b64 v[214:215], v9 offset:736
    s_waitcnt lgkmcnt(12)
    v_mfma_f32_16x16x32_bf16 v[12:15], v[200:203], v[128:131], v[12:15]
    ds_read_b64_tr_b16 v[144:145], v8 offset:12288
    ds_read_b64_tr_b16 v[146:147], v8 offset:14336
    ds_read_b64 v[216:217], v9 offset:768
    ds_read_b64 v[218:219], v9 offset:800
    s_waitcnt lgkmcnt(12)
    v_mfma_f32_16x16x32_bf16 v[12:15], v[204:207], v[132:135], v[12:15]
    ds_read_b64_tr_b16 v[148:149], v8 offset:16384
    ds_read_b64_tr_b16 v[150:151], v8 offset:18432
    ds_read_b64 v[220:221], v9 offset:832
    ds_read_b64 v[222:223], v9 offset:864
    s_waitcnt lgkmcnt(12)
    v_mfma_f32_16x16x32_bf16 v[12:15], v[208:211], v[136:139], v[12:15]
    ds_read_b64_tr_b16 v[152:153], v8 offset:20480
    ds_read_b64_tr_b16 v[154:155], v8 offset:22528
    ds_read_b64 v[224:225], v9 offset:896
    ds_read_b64 v[226:227], v9 offset:928
    s_waitcnt lgkmcnt(12)
    v_mfma_f32_16x16x32_bf16 v[12:15], v[212:215], v[140:143], v[12:15]
    ds_read_b64_tr_b16 v[156:157], v8 offset:24576
    ds_read_b64_tr_b16 v[158:159], v8 offset:26624
    ds_read_b64 v[228:229], v9 offset:960
    ds_read_b64 v[230:231], v9 offset:992
    s_waitcnt lgkmcnt(12)
    v_mfma_f32_16x16x32_bf16 v[12:15], v[216:219], v[144:147], v[12:15]
    ds_read_b64_tr_b16 v[160:161], v8 offset:28672
    ds_read_b64_tr_b16 v[162:163], v8 offset:30720
    ds_read_b64 v[232:233], v9 offset:1024
    ds_read_b64 v[234:235], v9 offset:1056
    s_waitcnt lgkmcnt(12)
    v_mfma_f32_16x16x32_bf16 v[12:15], v[220:223], v[148:151], v[12:15]
    ds_read_b64_tr_b16 v[164:165], v8 offset:32768
    ds_read_b64_tr_b16 v[166:167], v8 offset:34816
    ds_read_b64 v[236:237], v9 offset:1088
    ds_read_b64 v[238:239], v9 offset:1120
    s_waitcnt lgkmcnt(12)
    v_mfma_f32_16x16x32_bf16 v[12:15], v[224:227], v[152:155], v[12:15]
    s_waitcnt lgkmcnt(0)
    v_mfma_f32_16x16x32_bf16 v[12:15], v[228:231], v[156:159], v[12:15]
    v_mfma_f32_16x16x32_bf16 v[12:15], v[232:235], v[160:163], v[12:15]
    v_mfma_f32_16x16x32_bf16 v[12:15], v[236:239], v[164:167], v[12:15]
    ds_read_b128 v[32:35], v7 offset:0
    ds_read_b128 v[36:39], v7 offset:64
    ds_read_b128 v[40:43], v7 offset:128
    ds_read_b128 v[44:47], v7 offset:192
    ds_read_b128 v[48:51], v7 offset:256
    ds_read_b128 v[52:55], v7 offset:320
    s_lshl_b32 s35, s32, 2
    s_add_u32 s35, s35, s34
    v_and_b32 v4, 15, v2
    v_lshlrev_b32 v4, 2, v4
    s_lshl_b32 s3, s35, 6
    s_nop 3
    v_mul_f32 v10, 0xbae38e39, v12
    v_mov_b32 v11, v10
    s_mov_b64 exec, 0xffff
    buffer_store_dword v13, v4, s[24:27], s3 offen sc1
    s_mov_b64 exec, -1
    s_cmp_ge_u32 s35, 144
    s_cselect_b32 s36, 0, 165888
    s_cselect_b32 s3, 144, 0
    s_sub_u32 s35, s35, s3
    s_mul_i32 s3, s35, 7282
    s_lshr_b32 s3, s3, 16
    s_mul_i32 s10, s3, 9
    s_sub_u32 s35, s35, s10
    s_mul_i32 s3, s3, 331776
    s_add_u32 s36, s36, s3
    s_lshl_b32 s35, s35, 10
    s_add_u32 s36, s36, s35
    ds_read_b128 v[56:59], v7 offset:384
    ds_read_b128 v[60:63], v7 offset:448
    s_waitcnt lgkmcnt(6)
    v_lshlrev_b32 v64, 16, v96
    v_and_b32 v65, 0xffff0000, v96
    v_lshlrev_b32 v66, 16, v97
    v_and_b32 v67, 0xffff0000, v97
    v_lshlrev_b32 v68, 16, v98
    v_and_b32 v69, 0xffff0000, v98
    v_lshlrev_b32 v70, 16, v99
    v_and_b32 v71, 0xffff0000, v99
    v_pk_fma_f32 v[64:65], v[64:65], v[32:33], v[10:11]
    v_pk_fma_f32 v[66:67], v[66:67], v[34:35], v[10:11]
    v_pk_fma_f32 v[68:69], v[68:69], v[36:37], v[10:11]
    v_pk_fma_f32 v[70:71], v[70:71], v[38:39], v[10:11]
    v_cvt_pk_bf16_f32 v96, v64, v65
    v_cvt_pk_bf16_f32 v97, v66, v67
    v_cvt_pk_bf16_f32 v98, v68, v69
    v_cvt_pk_bf16_f32 v99, v70, v71
    buffer_store_dwordx4 v[96:99], v5, s[20:23], s36 offen sc1
    s_add_u32 s36, s36, 9216
    ds_read_b128 v[32:35], v7 offset:512
    ds_read_b128 v[36:39], v7 offset:576
    s_waitcnt lgkmcnt(6)
    v_lshlrev_b32 v72, 16, v100
    v_and_b32 v73, 0xffff0000, v100
    v_lshlrev_b32 v74, 16, v101
    v_and_b32 v75, 0xffff0000, v101
    v_lshlrev_b32 v76, 16, v102
    v_and_b32 v77, 0xffff0000, v102
    v_lshlrev_b32 v78, 16, v103
    v_and_b32 v79, 0xffff0000, v103
    v_pk_fma_f32 v[72:73], v[72:73], v[40:41], v[10:11]
    v_pk_fma_f32 v[74:75], v[74:75], v[42:43], v[10:11]
    v_pk_fma_f32 v[76:77], v[76:77], v[44:45], v[10:11]
    v_pk_fma_f32 v[78:79], v[78:79], v[46:47], v[10:11]
    v_cvt_pk_bf16_f32 v100, v72, v73
    v_cvt_pk_bf16_f32 v101, v74, v75
    v_cvt_pk_bf16_f32 v102, v76, v77
    v_cvt_pk_bf16_f32 v103, v78, v79
    buffer_store_dwordx4 v[100:103], v5, s[20:23], s36 offen sc1
    s_add_u32 s36, s36, 9216
    ds_read_b128 v[40:43], v7 offset:640
    ds_read_b128 v[44:47], v7 offset:704
    s_waitcnt lgkmcnt(6)
    v_lshlrev_b32 v64, 16, v104
    v_and_b32 v65, 0xffff0000, v104
    v_lshlrev_b32 v66, 16, v105
    v_and_b32 v67, 0xffff0000, v105
    v_lshlrev_b32 v68, 16, v106
    v_and_b32 v69, 0xffff0000, v106
    v_lshlrev_b32 v70, 16, v107
    v_and_b32 v71, 0xffff0000, v107
    v_pk_fma_f32 v[64:65], v[64:65], v[48:49], v[10:11]
    v_pk_fma_f32 v[66:67], v[66:67], v[50:51], v[10:11]
    v_pk_fma_f32 v[68:69], v[68:69], v[52:53], v[10:11]
    v_pk_fma_f32 v[70:71], v[70:71], v[54:55], v[10:11]
    v_cvt_pk_bf16_f32 v104, v64, v65
    v_cvt_pk_bf16_f32 v105, v66, v67
    v_cvt_pk_bf16_f32 v106, v68, v69
    v_cvt_pk_bf16_f32 v107, v70, v71
    buffer_store_dwordx4 v[104:107], v5, s[20:23], s36 offen sc1
    s_add_u32 s36, s36, 9216
    ds_read_b128 v[48:51], v7 offset:768
    ds_read_b128 v[52:55], v7 offset:832
    s_waitcnt lgkmcnt(6)
    v_lshlrev_b32 v72, 16, v108
    v_and_b32 v73, 0xffff0000, v108
    v_lshlrev_b32 v74, 16, v109
    v_and_b32 v75, 0xffff0000, v109
    v_lshlrev_b32 v76, 16, v110
    v_and_b32 v77, 0xffff0000, v110
    v_lshlrev_b32 v78, 16, v111
    v_and_b32 v79, 0xffff0000, v111
    v_pk_fma_f32 v[72:73], v[72:73], v[56:57], v[10:11]
    v_pk_fma_f32 v[74:75], v[74:75], v[58:59], v[10:11]
    v_pk_fma_f32 v[76:77], v[76:77], v[60:61], v[10:11]
    v_pk_fma_f32 v[78:79], v[78:79], v[62:63], v[10:11]
    v_cvt_pk_bf16_f32 v108, v72, v73
    v_cvt_pk_bf16_f32 v109, v74, v75
    v_cvt_pk_bf16_f32 v110, v76, v77
    v_cvt_pk_bf16_f32 v111, v78, v79
    buffer_store_dwordx4 v[108:111], v5, s[20:23], s36 offen sc1
    s_add_u32 s36, s36, 9216
    ds_read_b128 v[56:59], v7 offset:896
    ds_read_b128 v[60:63], v7 offset:960
    s_waitcnt lgkmcnt(6)
    v_lshlrev_b32 v64, 16, v112
    v_and_b32 v65, 0xffff0000, v112
    v_lshlrev_b32 v66, 16, v113
    v_and_b32 v67, 0xffff0000, v113
    v_lshlrev_b32 v68, 16, v114
    v_and_b32 v69, 0xffff0000, v114
    v_lshlrev_b32 v70, 16, v115
    v_and_b32 v71, 0xffff0000, v115
    v_pk_fma_f32 v[64:65], v[64:65], v[32:33], v[10:11]
    v_pk_fma_f32 v[66:67], v[66:67], v[34:35], v[10:11]
    v_pk_fma_f32 v[68:69], v[68:69], v[36:37], v[10:11]
    v_pk_fma_f32 v[70:71], v[70:71], v[38:39], v[10:11]
    v_cvt_pk_bf16_f32 v112, v64, v65
    v_cvt_pk_bf16_f32 v113, v66, v67
    v_cvt_pk_bf16_f32 v114, v68, v69
    v_cvt_pk_bf16_f32 v115, v70, v71
    buffer_store_dwordx4 v[112:115], v5, s[20:23], s36 offen sc1
    s_add_u32 s36, s36, 9216
    ds_read_b128 v[32:35], v7 offset:1024
    ds_read_b128 v[36:39], v7 offset:1088
    s_waitcnt lgkmcnt(6)
    v_lshlrev_b32 v72, 16, v116
    v_and_b32 v73, 0xffff0000, v116
    v_lshlrev_b32 v74, 16, v117
    v_and_b32 v75, 0xffff0000, v117
    v_lshlrev_b32 v76, 16, v118
    v_and_b32 v77, 0xffff0000, v118
    v_lshlrev_b32 v78, 16, v119
    v_and_b32 v79, 0xffff0000, v119
    v_pk_fma_f32 v[72:73], v[72:73], v[40:41], v[10:11]
    v_pk_fma_f32 v[74:75], v[74:75], v[42:43], v[10:11]
    v_pk_fma_f32 v[76:77], v[76:77], v[44:45], v[10:11]
    v_pk_fma_f32 v[78:79], v[78:79], v[46:47], v[10:11]
    v_cvt_pk_bf16_f32 v116, v72, v73
    v_cvt_pk_bf16_f32 v117, v74, v75
    v_cvt_pk_bf16_f32 v118, v76, v77
    v_cvt_pk_bf16_f32 v119, v78, v79
    buffer_store_dwordx4 v[116:119], v5, s[20:23], s36 offen sc1
    s_add_u32 s36, s36, 9216
    ds_read_b128 v[40:43], v7 offset:1152
    ds_read_b128 v[44:47], v7 offset:1216
    s_waitcnt lgkmcnt(6)
    v_lshlrev_b32 v64, 16, v120
    v_and_b32 v65, 0xffff0000, v120
    v_lshlrev_b32 v66, 16, v121
    v_and_b32 v67, 0xffff0000, v121
    v_lshlrev_b32 v68, 16, v122
    v_and_b32 v69, 0xffff0000, v122
    v_lshlrev_b32 v70, 16, v123
    v_and_b32 v71, 0xffff0000, v123
    v_pk_fma_f32 v[64:65], v[64:65], v[48:49], v[10:11]
    v_pk_fma_f32 v[66:67], v[66:67], v[50:51], v[10:11]
    v_pk_fma_f32 v[68:69], v[68:69], v[52:53], v[10:11]
    v_pk_fma_f32 v[70:71], v[70:71], v[54:55], v[10:11]
    v_cvt_pk_bf16_f32 v120, v64, v65
    v_cvt_pk_bf16_f32 v121, v66, v67
    v_cvt_pk_bf16_f32 v122, v68, v69
    v_cvt_pk_bf16_f32 v123, v70, v71
    buffer_store_dwordx4 v[120:123], v5, s[20:23], s36 offen sc1
    s_add_u32 s36, s36, 9216
    ds_read_b128 v[48:51], v7 offset:1280
    ds_read_b128 v[52:55], v7 offset:1344
    s_waitcnt lgkmcnt(6)
    v_lshlrev_b32 v72, 16, v124
    v_and_b32 v73, 0xffff0000, v124
    v_lshlrev_b32 v74, 16, v125
    v_and_b32 v75, 0xffff0000, v125
    v_lshlrev_b32 v76, 16, v126
    v_and_b32 v77, 0xffff0000, v126
    v_lshlrev_b32 v78, 16, v127
    v_and_b32 v79, 0xffff0000, v127
    v_pk_fma_f32 v[72:73], v[72:73], v[56:57], v[10:11]
    v_pk_fma_f32 v[74:75], v[74:75], v[58:59], v[10:11]
    v_pk_fma_f32 v[76:77], v[76:77], v[60:61], v[10:11]
    v_pk_fma_f32 v[78:79], v[78:79], v[62:63], v[10:11]
    v_cvt_pk_bf16_f32 v124, v72, v73
    v_cvt_pk_bf16_f32 v125, v74, v75
    v_cvt_pk_bf16_f32 v126, v76, v77
    v_cvt_pk_bf16_f32 v127, v78, v79
    buffer_store_dwordx4 v[124:127], v5, s[20:23], s36 offen sc1
    s_add_u32 s36, s36, 9216
    ds_read_b128 v[56:59], v7 offset:1408
    ds_read_b128 v[60:63], v7 offset:1472
    s_waitcnt lgkmcnt(6)
    v_lshlrev_b32 v64, 16, v128
    v_and_b32 v65, 0xffff0000, v128
    v_lshlrev_b32 v66, 16, v129
    v_and_b32 v67, 0xffff0000, v129
    v_lshlrev_b32 v68, 16, v130
    v_and_b32 v69, 0xffff0000, v130
    v_lshlrev_b32 v70, 16, v131
    v_and_b32 v71, 0xffff0000, v131
    v_pk_fma_f32 v[64:65], v[64:65], v[32:33], v[10:11]
    v_pk_fma_f32 v[66:67], v[66:67], v[34:35], v[10:11]
    v_pk_fma_f32 v[68:69], v[68:69], v[36:37], v[10:11]
    v_pk_fma_f32 v[70:71], v[70:71], v[38:39], v[10:11]
    v_cvt_pk_bf16_f32 v128, v64, v65
    v_cvt_pk_bf16_f32 v129, v66, v67
    v_cvt_pk_bf16_f32 v130, v68, v69
    v_cvt_pk_bf16_f32 v131, v70, v71
    buffer_store_dwordx4 v[128:131], v5, s[20:23], s36 offen sc1
    s_add_u32 s36, s36, 9216
    ds_read_b128 v[32:35], v7 offset:1536
    ds_read_b128 v[36:39], v7 offset:1600
    s_waitcnt lgkmcnt(6)
    v_lshlrev_b32 v72, 16, v132
    v_and_b32 v73, 0xffff0000, v132
    v_lshlrev_b32 v74, 16, v133
    v_and_b32 v75, 0xffff0000, v133
    v_lshlrev_b32 v76, 16, v134
    v_and_b32 v77, 0xffff0000, v134
    v_lshlrev_b32 v78, 16, v135
    v_and_b32 v79, 0xffff0000, v135
    v_pk_fma_f32 v[72:73], v[72:73], v[40:41], v[10:11]
    v_pk_fma_f32 v[74:75], v[74:75], v[42:43], v[10:11]
    v_pk_fma_f32 v[76:77], v[76:77], v[44:45], v[10:11]
    v_pk_fma_f32 v[78:79], v[78:79], v[46:47], v[10:11]
    v_cvt_pk_bf16_f32 v132, v72, v73
    v_cvt_pk_bf16_f32 v133, v74, v75
    v_cvt_pk_bf16_f32 v134, v76, v77
    v_cvt_pk_bf16_f32 v135, v78, v79
    buffer_store_dwordx4 v[132:135], v5, s[20:23], s36 offen sc1
    s_add_u32 s36, s36, 9216
    ds_read_b128 v[40:43], v7 offset:1664
    ds_read_b128 v[44:47], v7 offset:1728
    s_waitcnt lgkmcnt(6)
    v_lshlrev_b32 v64, 16, v136
    v_and_b32 v65, 0xffff0000, v136
    v_lshlrev_b32 v66, 16, v137
    v_and_b32 v67, 0xffff0000, v137
    v_lshlrev_b32 v68, 16, v138
    v_and_b32 v69, 0xffff0000, v138
    v_lshlrev_b32 v70, 16, v139
    v_and_b32 v71, 0xffff0000, v139
    v_pk_fma_f32 v[64:65], v[64:65], v[48:49], v[10:11]
    v_pk_fma_f32 v[66:67], v[66:67], v[50:51], v[10:11]
    v_pk_fma_f32 v[68:69], v[68:69], v[52:53], v[10:11]
    v_pk_fma_f32 v[70:71], v[70:71], v[54:55], v[10:11]
    v_cvt_pk_bf16_f32 v136, v64, v65
    v_cvt_pk_bf16_f32 v137, v66, v67
    v_cvt_pk_bf16_f32 v138, v68, v69
    v_cvt_pk_bf16_f32 v139, v70, v71
    buffer_store_dwordx4 v[136:139], v5, s[20:23], s36 offen sc1
    s_add_u32 s36, s36, 9216
    ds_read_b128 v[48:51], v7 offset:1792
    ds_read_b128 v[52:55], v7 offset:1856
    s_waitcnt lgkmcnt(6)
    v_lshlrev_b32 v72, 16, v140
    v_and_b32 v73, 0xffff0000, v140
    v_lshlrev_b32 v74, 16, v141
    v_and_b32 v75, 0xffff0000, v141
    v_lshlrev_b32 v76, 16, v142
    v_and_b32 v77, 0xffff0000, v142
    v_lshlrev_b32 v78, 16, v143
    v_and_b32 v79, 0xffff0000, v143
    v_pk_fma_f32 v[72:73], v[72:73], v[56:57], v[10:11]
    v_pk_fma_f32 v[74:75], v[74:75], v[58:59], v[10:11]
    v_pk_fma_f32 v[76:77], v[76:77], v[60:61], v[10:11]
    v_pk_fma_f32 v[78:79], v[78:79], v[62:63], v[10:11]
    v_cvt_pk_bf16_f32 v140, v72, v73
    v_cvt_pk_bf16_f32 v141, v74, v75
    v_cvt_pk_bf16_f32 v142, v76, v77
    v_cvt_pk_bf16_f32 v143, v78, v79
    buffer_store_dwordx4 v[140:143], v5, s[20:23], s36 offen sc1
    s_add_u32 s36, s36, 9216
    ds_read_b128 v[56:59], v7 offset:1920
    ds_read_b128 v[60:63], v7 offset:1984
    s_waitcnt lgkmcnt(6)
    v_lshlrev_b32 v64, 16, v144
    v_and_b32 v65, 0xffff0000, v144
    v_lshlrev_b32 v66, 16, v145
    v_and_b32 v67, 0xffff0000, v145
    v_lshlrev_b32 v68, 16, v146
    v_and_b32 v69, 0xffff0000, v146
    v_lshlrev_b32 v70, 16, v147
    v_and_b32 v71, 0xffff0000, v147
    v_pk_fma_f32 v[64:65], v[64:65], v[32:33], v[10:11]
    v_pk_fma_f32 v[66:67], v[66:67], v[34:35], v[10:11]
    v_pk_fma_f32 v[68:69], v[68:69], v[36:37], v[10:11]
    v_pk_fma_f32 v[70:71], v[70:71], v[38:39], v[10:11]
    v_cvt_pk_bf16_f32 v144, v64, v65
    v_cvt_pk_bf16_f32 v145, v66, v67
    v_cvt_pk_bf16_f32 v146, v68, v69
    v_cvt_pk_bf16_f32 v147, v70, v71
    buffer_store_dwordx4 v[144:147], v5, s[20:23], s36 offen sc1
    s_add_u32 s36, s36, 9216
    ds_read_b128 v[32:35], v7 offset:2048
    ds_read_b128 v[36:39], v7 offset:2112
    s_waitcnt lgkmcnt(6)
    v_lshlrev_b32 v72, 16, v148
    v_and_b32 v73, 0xffff0000, v148
    v_lshlrev_b32 v74, 16, v149
    v_and_b32 v75, 0xffff0000, v149
    v_lshlrev_b32 v76, 16, v150
    v_and_b32 v77, 0xffff0000, v150
    v_lshlrev_b32 v78, 16, v151
    v_and_b32 v79, 0xffff0000, v151
    v_pk_fma_f32 v[72:73], v[72:73], v[40:41], v[10:11]
    v_pk_fma_f32 v[74:75], v[74:75], v[42:43], v[10:11]
    v_pk_fma_f32 v[76:77], v[76:77], v[44:45], v[10:11]
    v_pk_fma_f32 v[78:79], v[78:79], v[46:47], v[10:11]
    v_cvt_pk_bf16_f32 v148, v72, v73
    v_cvt_pk_bf16_f32 v149, v74, v75
    v_cvt_pk_bf16_f32 v150, v76, v77
    v_cvt_pk_bf16_f32 v151, v78, v79
    buffer_store_dwordx4 v[148:151], v5, s[20:23], s36 offen sc1
    s_add_u32 s36, s36, 9216
    ds_read_b128 v[40:43], v7 offset:2176
    ds_read_b128 v[44:47], v7 offset:2240
    s_waitcnt lgkmcnt(6)
    v_lshlrev_b32 v64, 16, v152
    v_and_b32 v65, 0xffff0000, v152
    v_lshlrev_b32 v66, 16, v153
    v_and_b32 v67, 0xffff0000, v153
    v_lshlrev_b32 v68, 16, v154
    v_and_b32 v69, 0xffff0000, v154
    v_lshlrev_b32 v70, 16, v155
    v_and_b32 v71, 0xffff0000, v155
    v_pk_fma_f32 v[64:65], v[64:65], v[48:49], v[10:11]
    v_pk_fma_f32 v[66:67], v[66:67], v[50:51], v[10:11]
    v_pk_fma_f32 v[68:69], v[68:69], v[52:53], v[10:11]
    v_pk_fma_f32 v[70:71], v[70:71], v[54:55], v[10:11]
    v_cvt_pk_bf16_f32 v152, v64, v65
    v_cvt_pk_bf16_f32 v153, v66, v67
    v_cvt_pk_bf16_f32 v154, v68, v69
    v_cvt_pk_bf16_f32 v155, v70, v71
    buffer_store_dwordx4 v[152:155], v5, s[20:23], s36 offen sc1
    s_add_u32 s36, s36, 9216
    s_waitcnt lgkmcnt(4)
    v_lshlrev_b32 v72, 16, v156
    v_and_b32 v73, 0xffff0000, v156
    v_lshlrev_b32 v74, 16, v157
    v_and_b32 v75, 0xffff0000, v157
    v_lshlrev_b32 v76, 16, v158
    v_and_b32 v77, 0xffff0000, v158
    v_lshlrev_b32 v78, 16, v159
    v_and_b32 v79, 0xffff0000, v159
    v_pk_fma_f32 v[72:73], v[72:73], v[56:57], v[10:11]
    v_pk_fma_f32 v[74:75], v[74:75], v[58:59], v[10:11]
    v_pk_fma_f32 v[76:77], v[76:77], v[60:61], v[10:11]
    v_pk_fma_f32 v[78:79], v[78:79], v[62:63], v[10:11]
    v_cvt_pk_bf16_f32 v156, v72, v73
    v_cvt_pk_bf16_f32 v157, v74, v75
    v_cvt_pk_bf16_f32 v158, v76, v77
    v_cvt_pk_bf16_f32 v159, v78, v79
    buffer_store_dwordx4 v[156:159], v5, s[20:23], s36 offen sc1
    s_add_u32 s36, s36, 9216
    s_waitcnt lgkmcnt(2)
    v_lshlrev_b32 v64, 16, v160
    v_and_b32 v65, 0xffff0000, v160
    v_lshlrev_b32 v66, 16, v161
    v_and_b32 v67, 0xffff0000, v161
    v_lshlrev_b32 v68, 16, v162
    v_and_b32 v69, 0xffff0000, v162
    v_lshlrev_b32 v70, 16, v163
    v_and_b32 v71, 0xffff0000, v163
    v_pk_fma_f32 v[64:65], v[64:65], v[32:33], v[10:11]
    v_pk_fma_f32 v[66:67], v[66:67], v[34:35], v[10:11]
    v_pk_fma_f32 v[68:69], v[68:69], v[36:37], v[10:11]
    v_pk_fma_f32 v[70:71], v[70:71], v[38:39], v[10:11]
    v_cvt_pk_bf16_f32 v160, v64, v65
    v_cvt_pk_bf16_f32 v161, v66, v67
    v_cvt_pk_bf16_f32 v162, v68, v69
    v_cvt_pk_bf16_f32 v163, v70, v71
    buffer_store_dwordx4 v[160:163], v5, s[20:23], s36 offen sc1
    s_add_u32 s36, s36, 9216
    s_waitcnt lgkmcnt(0)
    v_lshlrev_b32 v72, 16, v164
    v_and_b32 v73, 0xffff0000, v164
    v_lshlrev_b32 v74, 16, v165
    v_and_b32 v75, 0xffff0000, v165
    v_lshlrev_b32 v76, 16, v166
    v_and_b32 v77, 0xffff0000, v166
    v_lshlrev_b32 v78, 16, v167
    v_and_b32 v79, 0xffff0000, v167
    v_pk_fma_f32 v[72:73], v[72:73], v[40:41], v[10:11]
    v_pk_fma_f32 v[74:75], v[74:75], v[42:43], v[10:11]
    v_pk_fma_f32 v[76:77], v[76:77], v[44:45], v[10:11]
    v_pk_fma_f32 v[78:79], v[78:79], v[46:47], v[10:11]
    v_cvt_pk_bf16_f32 v164, v72, v73
    v_cvt_pk_bf16_f32 v165, v74, v75
    v_cvt_pk_bf16_f32 v166, v76, v77
    v_cvt_pk_bf16_f32 v167, v78, v79
    buffer_store_dwordx4 v[164:167], v5, s[20:23], s36 offen sc1
    s_waitcnt vmcnt(0)
    s_barrier
    s_cmp_lg_u32 s34, 0
    s_cbranch_scc1 L_fl_25
    s_lshl_b32 s10, s2, 7
    s_add_u32 s10, s10, 98304
    v_lshlrev_b32 v1, 2, v2
    v_mov_b32 v6, s87
    s_mov_b32 exec_hi, 0
    buffer_store_dword v6, v1, s[44:47], s10 offen sc1
    s_mov_b64 exec, -1
L_fl_25:
    s_branch L_mjoin_2
L_fm_6:
    s_load_dwordx2 s[76:77], s[0:1], 80
    s_load_dwordx4 s[36:39], s[0:1], 88
    s_sub_u32 s32, s2, 144
    v_lshrrev_b32 v3, 3, v0
    v_and_b32 v4, 7, v0
    v_mul_u32_u24 v5, 6912, v3
    v_lshl_add_u32 v5, v4, 4, v5
    v_lshlrev_b32 v7, 1, v3
    s_sub_u32 s52, s32, 18
    s_and_b32 s33, s52, 1
    s_lshr_b32 s35, s52, 1
    s_waitcnt lgkmcnt(0)
    s_load_dword s86, s[8:9], 524288
    s_mov_b32 s12, s36
    s_mov_b32 s13, s37
    s_mov_b32 s14, 0x480
    s_mov_b32 s15, 0x00020000
    s_mov_b32 s16, s38
    s_mov_b32 s17, s39
    s_mov_b32 s18, 0x3cc000
    s_mov_b32 s19, 0x00020000
    s_mul_i32 s3, s33, 576
    buffer_load_ushort v16, v7, s[12:15], s3 offen offset:0
    buffer_load_ushort v17, v7, s[12:15], s3 offen offset:64
    buffer_load_ushort v18, v7, s[12:15], s3 offen offset:128
    buffer_load_ushort v19, v7, s[12:15], s3 offen offset:192
    buffer_load_ushort v20, v7, s[12:15], s3 offen offset:256
    buffer_load_ushort v21, v7, s[12:15], s3 offen offset:320
    buffer_load_ushort v22, v7, s[12:15], s3 offen offset:384
    buffer_load_ushort v23, v7, s[12:15], s3 offen offset:448
    buffer_load_ushort v24, v7, s[12:15], s3 offen offset:512
    s_lshl_b32 s3, s35, 7
    s_mul_i32 s10, s33, 1990656
    s_add_u32 s3, s3, s10
    buffer_load_dwordx4 v[28:31], v5, s[16:19], s3 offen nt
    s_add_u32 s3, s3, 221184
    buffer_load_dwordx4 v[32:35], v5, s[16:19], s3 offen nt
    s_add_u32 s3, s3, 221184
    buffer_load_dwordx4 v[36:39], v5, s[16:19], s3 offen nt
    s_add_u32 s3, s3, 221184
    buffer_load_dwordx4 v[40:43], v5, s[16:19], s3 offen nt
    s_add_u32 s3, s3, 221184
    buffer_load_dwordx4 v[44:47], v5, s[16:19], s3 offen nt
    s_add_u32 s3, s3, 221184
    buffer_load_dwordx4 v[48:51], v5, s[16:19], s3 offen nt
    s_add_u32 s3, s3, 221184
    buffer_load_dwordx4 v[52:55], v5, s[16:19], s3 offen nt
    s_add_u32 s3, s3, 221184
    buffer_load_dwordx4 v[56:59], v5, s[16:19], s3 offen nt
    s_add_u32 s3, s3, 221184
    buffer_load_dwordx4 v[60:63], v5, s[16:19], s3 offen nt
    s_mov_b32 s16, s8
    s_mov_b32 s17, s9
    s_mov_b32 s18, 0x10000
    s_mov_b32 s19, 0x00020000
    s_add_u32 s44, s8, 0x50000
    s_addc_u32 s45, s9, 0
    s_mov_b32 s46, 0x30000
    s_mov_b32 s47, 0x00020000
    s_waitcnt vmcnt(9)
    s_mov_b32 s10, 0xbfb8aa3b
    v_lshlrev_b32 v16, 16, v16
    v_lshlrev_b32 v17, 16, v17
    v_lshlrev_b32 v18, 16, v18
    v_lshlrev_b32 v19, 16, v19
    v_lshlrev_b32 v20, 16, v20
    v_lshlrev_b32 v21, 16, v21
    v_lshlrev_b32 v22, 16, v22
    v_lshlrev_b32 v23, 16, v23
    v_lshlrev_b32 v24, 16, v24
    v_mul_f32 v64, s10, v16
    v_mul_f32 v65, s10, v17
    v_mul_f32 v66, s10, v18
    v_mul_f32 v67, s10, v19
    v_mul_f32 v68, s10, v20
    v_mul_f32 v69, s10, v21
    v_mul_f32 v70, s10, v22
    v_mul_f32 v71, s10, v23
    v_mul_f32 v72, s10, v24
    v_exp_f32 v64, v64
    v_exp_f32 v65, v65
    v_exp_f32 v66, v66
    v_exp_f32 v67, v67
    v_exp_f32 v68, v68
    v_exp_f32 v69, v69
    v_exp_f32 v70, v70
    v_exp_f32 v71, v71
    v_exp_f32 v72, v72
    v_add_f32 v64, 1.0, v64
    v_add_f32 v65, 1.0, v65
    v_add_f32 v66, 1.0, v66
    v_add_f32 v67, 1.0, v67
    v_add_f32 v68, 1.0, v68
    v_add_f32 v69, 1.0, v69
    v_add_f32 v70, 1.0, v70
    v_add_f32 v71, 1.0, v71
    v_add_f32 v72, 1.0, v72
    v_rcp_f32 v64, v64
    v_rcp_f32 v65, v65
    v_rcp_f32 v66, v66
    v_rcp_f32 v67, v67
    v_rcp_f32 v68, v68
    v_rcp_f32 v69, v69
    v_rcp_f32 v70, v70
    v_rcp_f32 v71, v71
    v_rcp_f32 v72, v72
    v_mul_f32 v64, v64, v16
    v_mul_f32 v65, v65, v17
    v_mul_f32 v66, v66, v18
    v_mul_f32 v67, v67, v19
    v_mul_f32 v68, v68, v20
    v_mul_f32 v69, v69, v21
    v_mul_f32 v70, v70, v22
    v_mul_f32 v71, v71, v23
    v_mul_f32 v72, v72, v24
    v_cvt_pk_bf16_f32 v64, v64, v64
    v_lshlrev_b32 v16, 16, v64
    v_cvt_pk_bf16_f32 v65, v65, v65
    v_lshlrev_b32 v17, 16, v65
    v_cvt_pk_bf16_f32 v66, v66, v66
    v_lshlrev_b32 v18, 16, v66
    v_cvt_pk_bf16_f32 v67, v67, v67
    v_lshlrev_b32 v19, 16, v67
    v_cvt_pk_bf16_f32 v68, v68, v68
    v_lshlrev_b32 v20, 16, v68
    v_cvt_pk_bf16_f32 v69, v69, v69
    v_lshlrev_b32 v21, 16, v69
    v_cvt_pk_bf16_f32 v70, v70, v70
    v_lshlrev_b32 v22, 16, v70
    v_cvt_pk_bf16_f32 v71, v71, v71
    v_lshlrev_b32 v23, 16, v71
    v_cvt_pk_bf16_f32 v72, v72, v72
    v_lshlrev_b32 v24, 16, v72
    v_mov_b32 v8, 0
    v_mov_b32 v9, 0
    v_mov_b32 v10, 0
    v_mov_b32 v11, 0
    v_mov_b32 v12, 0
    v_mov_b32 v13, 0
    v_mov_b32 v14, 0
    v_mov_b32 v15, 0
    v_lshlrev_b32 v7, 5, v0
    v_add_u32 v7, 86016, v7
    s_waitcnt vmcnt(8)
    v_lshlrev_b32 v26, 16, v28
    v_and_b32 v27, 0xffff0000, v28
    v_fmac_f32 v8, v26, v16
    v_fmac_f32 v9, v27, v16
    v_lshlrev_b32 v26, 16, v29
    v_and_b32 v27, 0xffff0000, v29
    v_fmac_f32 v10, v26, v16
    v_fmac_f32 v11, v27, v16
    v_lshlrev_b32 v26, 16, v30
    v_and_b32 v27, 0xffff0000, v30
    v_fmac_f32 v12, v26, v16
    v_fmac_f32 v13, v27, v16
    v_lshlrev_b32 v26, 16, v31
    v_and_b32 v27, 0xffff0000, v31
    v_fmac_f32 v14, v26, v16
    v_fmac_f32 v15, v27, v16
    s_waitcnt vmcnt(7)
    v_lshlrev_b32 v26, 16, v32
    v_and_b32 v27, 0xffff0000, v32
    v_fmac_f32 v8, v26, v17
    v_fmac_f32 v9, v27, v17
    v_lshlrev_b32 v26, 16, v33
    v_and_b32 v27, 0xffff0000, v33
    v_fmac_f32 v10, v26, v17
    v_fmac_f32 v11, v27, v17
    v_lshlrev_b32 v26, 16, v34
    v_and_b32 v27, 0xffff0000, v34
    v_fmac_f32 v12, v26, v17
    v_fmac_f32 v13, v27, v17
    v_lshlrev_b32 v26, 16, v35
    v_and_b32 v27, 0xffff0000, v35
    v_fmac_f32 v14, v26, v17
    v_fmac_f32 v15, v27, v17
    s_waitcnt vmcnt(6)
    v_lshlrev_b32 v26, 16, v36
    v_and_b32 v27, 0xffff0000, v36
    v_fmac_f32 v8, v26, v18
    v_fmac_f32 v9, v27, v18
    v_lshlrev_b32 v26, 16, v37
    v_and_b32 v27, 0xffff0000, v37
    v_fmac_f32 v10, v26, v18
    v_fmac_f32 v11, v27, v18
    v_lshlrev_b32 v26, 16, v38
    v_and_b32 v27, 0xffff0000, v38
    v_fmac_f32 v12, v26, v18
    v_fmac_f32 v13, v27, v18
    v_lshlrev_b32 v26, 16, v39
    v_and_b32 v27, 0xffff0000, v39
    v_fmac_f32 v14, v26, v18
    v_fmac_f32 v15, v27, v18
    s_waitcnt vmcnt(5)
    v_lshlrev_b32 v26, 16, v40
    v_and_b32 v27, 0xffff0000, v40
    v_fmac_f32 v8, v26, v19
    v_fmac_f32 v9, v27, v19
    v_lshlrev_b32 v26, 16, v41
    v_and_b32 v27, 0xffff0000, v41
    v_fmac_f32 v10, v26, v19
    v_fmac_f32 v11, v27, v19
    v_lshlrev_b32 v26, 16, v42
    v_and_b32 v27, 0xffff0000, v42
    v_fmac_f32 v12, v26, v19
    v_fmac_f32 v13, v27, v19
    v_lshlrev_b32 v26, 16, v43
    v_and_b32 v27, 0xffff0000, v43
    v_fmac_f32 v14, v26, v19
    v_fmac_f32 v15, v27, v19
    s_waitcnt vmcnt(4)
    v_lshlrev_b32 v26, 16, v44
    v_and_b32 v27, 0xffff0000, v44
    v_fmac_f32 v8, v26, v20
    v_fmac_f32 v9, v27, v20
    v_lshlrev_b32 v26, 16, v45
    v_and_b32 v27, 0xffff0000, v45
    v_fmac_f32 v10, v26, v20
    v_fmac_f32 v11, v27, v20
    v_lshlrev_b32 v26, 16, v46
    v_and_b32 v27, 0xffff0000, v46
    v_fmac_f32 v12, v26, v20
    v_fmac_f32 v13, v27, v20
    v_lshlrev_b32 v26, 16, v47
    v_and_b32 v27, 0xffff0000, v47
    v_fmac_f32 v14, v26, v20
    v_fmac_f32 v15, v27, v20
    s_waitcnt vmcnt(3)
    v_lshlrev_b32 v26, 16, v48
    v_and_b32 v27, 0xffff0000, v48
    v_fmac_f32 v8, v26, v21
    v_fmac_f32 v9, v27, v21
    v_lshlrev_b32 v26, 16, v49
    v_and_b32 v27, 0xffff0000, v49
    v_fmac_f32 v10, v26, v21
    v_fmac_f32 v11, v27, v21
    v_lshlrev_b32 v26, 16, v50
    v_and_b32 v27, 0xffff0000, v50
    v_fmac_f32 v12, v26, v21
    v_fmac_f32 v13, v27, v21
    v_lshlrev_b32 v26, 16, v51
    v_and_b32 v27, 0xffff0000, v51
    v_fmac_f32 v14, v26, v21
    v_fmac_f32 v15, v27, v21
    s_waitcnt vmcnt(2)
    v_lshlrev_b32 v26, 16, v52
    v_and_b32 v27, 0xffff0000, v52
    v_fmac_f32 v8, v26, v22
    v_fmac_f32 v9, v27, v22
    v_lshlrev_b32 v26, 16, v53
    v_and_b32 v27, 0xffff0000, v53
    v_fmac_f32 v10, v26, v22
    v_fmac_f32 v11, v27, v22
    v_lshlrev_b32 v26, 16, v54
    v_and_b32 v27, 0xffff0000, v54
    v_fmac_f32 v12, v26, v22
    v_fmac_f32 v13, v27, v22
    v_lshlrev_b32 v26, 16, v55
    v_and_b32 v27, 0xffff0000, v55
    v_fmac_f32 v14, v26, v22
    v_fmac_f32 v15, v27, v22
    s_waitcnt vmcnt(1)
    v_lshlrev_b32 v26, 16, v56
    v_and_b32 v27, 0xffff0000, v56
    v_fmac_f32 v8, v26, v23
    v_fmac_f32 v9, v27, v23
    v_lshlrev_b32 v26, 16, v57
    v_and_b32 v27, 0xffff0000, v57
    v_fmac_f32 v10, v26, v23
    v_fmac_f32 v11, v27, v23
    v_lshlrev_b32 v26, 16, v58
    v_and_b32 v27, 0xffff0000, v58
    v_fmac_f32 v12, v26, v23
    v_fmac_f32 v13, v27, v23
    v_lshlrev_b32 v26, 16, v59
    v_and_b32 v27, 0xffff0000, v59
    v_fmac_f32 v14, v26, v23
    v_fmac_f32 v15, v27, v23
    s_waitcnt vmcnt(0)
    v_lshlrev_b32 v26, 16, v60
    v_and_b32 v27, 0xffff0000, v60
    v_fmac_f32 v8, v26, v24
    v_fmac_f32 v9, v27, v24
    v_lshlrev_b32 v26, 16, v61
    v_and_b32 v27, 0xffff0000, v61
    v_fmac_f32 v10, v26, v24
    v_fmac_f32 v11, v27, v24
    v_lshlrev_b32 v26, 16, v62
    v_and_b32 v27, 0xffff0000, v62
    v_fmac_f32 v12, v26, v24
    v_fmac_f32 v13, v27, v24
    v_lshlrev_b32 v26, 16, v63
    v_and_b32 v27, 0xffff0000, v63
    v_fmac_f32 v14, v26, v24
    v_fmac_f32 v15, v27, v24
    ds_write_b128 v7, v[8:11]
    ds_write_b128 v7, v[12:15] offset:16
    s_waitcnt lgkmcnt(0)
    s_mul_i32 s87, s86, 0x9e3779b1
    s_add_u32 s87, s87, 0x7f4a7c15
    s_barrier
    s_cmp_lg_u32 s34, 0
    s_cbranch_scc1 L_mp_26
    v_lshlrev_b32 v7, 2, v2
    v_add_u32 v6, 86016, v7
    ds_read_b32 v160, v6 offset:0
    ds_read_b32 v161, v6 offset:256
    ds_read_b32 v162, v6 offset:512
    ds_read_b32 v163, v6 offset:768
    ds_read_b32 v164, v6 offset:1024
    ds_read_b32 v165, v6 offset:1280
    ds_read_b32 v166, v6 offset:1536
    ds_read_b32 v167, v6 offset:1792
    ds_read_b32 v168, v6 offset:2048
    ds_read_b32 v169, v6 offset:2304
    ds_read_b32 v170, v6 offset:2560
    ds_read_b32 v171, v6 offset:2816
    ds_read_b32 v172, v6 offset:3072
    ds_read_b32 v173, v6 offset:3328
    ds_read_b32 v174, v6 offset:3584
    ds_read_b32 v175, v6 offset:3840
    s_waitcnt lgkmcnt(0)
    ds_read_b32 v176, v6 offset:4096
    ds_read_b32 v177, v6 offset:4352
    ds_read_b32 v178, v6 offset:4608
    ds_read_b32 v179, v6 offset:4864
    ds_read_b32 v180, v6 offset:5120
    ds_read_b32 v181, v6 offset:5376
    ds_read_b32 v182, v6 offset:5632
    ds_read_b32 v183, v6 offset:5888
    ds_read_b32 v184, v6 offset:6144
    ds_read_b32 v185, v6 offset:6400
    ds_read_b32 v186, v6 offset:6656
    ds_read_b32 v187, v6 offset:6912
    ds_read_b32 v188, v6 offset:7168
    ds_read_b32 v189, v6 offset:7424
    ds_read_b32 v190, v6 offset:7680
    ds_read_b32 v191, v6 offset:7936
    s_waitcnt lgkmcnt(0)
    v_add_f32 v160, v160, v176
    v_add_f32 v161, v161, v177
    v_add_f32 v162, v162, v178
    v_add_f32 v163, v163, v179
    v_add_f32 v164, v164, v180
    v_add_f32 v165, v165, v181
    v_add_f32 v166, v166, v182
    v_add_f32 v167, v167, v183
    v_add_f32 v168, v168, v184
    v_add_f32 v169, v169, v185
    v_add_f32 v170, v170, v186
    v_add_f32 v171, v171, v187
    v_add_f32 v172, v172, v188
    v_add_f32 v173, v173, v189
    v_add_f32 v174, v174, v190
    v_add_f32 v175, v175, v191
    v_add_f32 v160, v160, v168
    v_add_f32 v161, v161, v169
    v_add_f32 v162, v162, v170
    v_add_f32 v163, v163, v171
    v_add_f32 v164, v164, v172
    v_add_f32 v165, v165, v173
    v_add_f32 v166, v166, v174
    v_add_f32 v167, v167, v175
    v_add_f32 v160, v160, v164
    v_add_f32 v161, v161, v165
    v_add_f32 v162, v162, v166
    v_add_f32 v163, v163, v167
    v_add_f32 v160, v160, v162
    v_add_f32 v161, v161, v163
    v_add_f32 v160, v160, v161
    s_mul_i32 s3, s33, 13824
    s_lshl_b32 s10, s35, 8
    s_add_u32 s3, s3, s10
    buffer_store_dword v160, v7, s[16:19], s3 offen sc1
    s_waitcnt vmcnt(0)
    s_lshl_b32 s10, s52, 7
    s_add_u32 s10, s10, 83968
    v_lshlrev_b32 v1, 2, v2
    v_mov_b32 v6, s87
    s_mov_b32 exec_hi, 0
    buffer_store_dword v6, v1, s[44:47], s10 offen sc1
    s_mov_b64 exec, -1
L_mp_26:
    s_barrier
    s_sub_u32 s32, s2, 216
    s_mov_b32 s12, s76
    s_mov_b32 s13, s77
    s_mov_b32 s14, 0x288000
    s_mov_b32 s15, 0x00020000
    s_add_u32 s20, s8, 0x580000
    s_addc_u32 s21, s9, 0
    s_mov_b32 s22, 0x288000
    s_mov_b32 s23, 0x00020000
    v_lshlrev_b32 v5, 4, v2
    s_mul_i32 s10, s34, 18432
    s_mul_i32 s3, s32, 73728
    s_add_u32 s3, s3, s10
    s_add_u32 m0, s10, 0
    s_nop 0
    buffer_load_dwordx4 v5, s[12:15], s3 offen offset:0 nt lds
    buffer_load_dwordx4 v5, s[12:15], s3 offen offset:1024 nt lds
    buffer_load_dwordx4 v5, s[12:15], s3 offen offset:2048 nt lds
    buffer_load_dwordx4 v5, s[12:15], s3 offen offset:3072 nt lds
    s_add_u32 m0, s10, 4096
    s_add_u32 s3, s3, 4096
    buffer_load_dwordx4 v5, s[12:15], s3 offen offset:0 nt lds
    buffer_load_dwordx4 v5, s[12:15], s3 offen offset:1024 nt lds
    buffer_load_dwordx4 v5, s[12:15], s3 offen offset:2048 nt lds
    buffer_load_dwordx4 v5, s[12:15], s3 offen offset:3072 nt lds
    s_add_u32 m0, s10, 8192
    s_add_u32 s3, s3, 4096
    buffer_load_dwordx4 v5, s[12:15], s3 offen offset:0 nt lds
    buffer_load_dwordx4 v5, s[12:15], s3 offen offset:1024 nt lds
    buffer_load_dwordx4 v5, s[12:15], s3 offen offset:2048 nt lds
    buffer_load_dwordx4 v5, s[12:15], s3 offen offset:3072 nt lds
    s_add_u32 m0, s10, 12288
    s_add_u32 s3, s3, 4096
    buffer_load_dwordx4 v5, s[12:15], s3 offen offset:0 nt lds
    buffer_load_dwordx4 v5, s[12:15], s3 offen offset:1024 nt lds
    buffer_load_dwordx4 v5, s[12:15], s3 offen offset:2048 nt lds
    buffer_load_dwordx4 v5, s[12:15], s3 offen offset:3072 nt lds
    s_add_u32 m0, s10, 16384
    s_add_u32 s3, s3, 4096
    buffer_load_dwordx4 v5, s[12:15], s3 offen offset:0 nt lds
    buffer_load_dwordx4 v5, s[12:15], s3 offen offset:1024 nt lds
    s_mov_b32 s72, s88
    s_mov_b32 s73, s89
    s_mov_b32 s74, 0x800000
    s_mov_b32 s75, 0x00020000
    s_sub_u32 s3, s2, 216
    s_mul_i32 s3, s3, 65536
    s_add_u32 s3, s3, 2359296
    v_lshlrev_b32 v1, 7, v0
    buffer_load_dword v240, v1, s[72:75], s3 offen
    s_add_u32 s3, s3, 32768
    buffer_load_dword v241, v1, s[72:75], s3 offen
    v_lshrrev_b32 v7, 2, v2
    v_mul_u32_u24 v7, 1152, v7
    v_and_b32 v4, 3, v2
    v_lshl_add_u32 v7, v4, 3, v7
    s_lshr_b32 s35, s34, 1
    s_and_b32 s36, s34, 1
    s_mul_i32 s3, s35, 36864
    s_mul_i32 s10, s36, 576
    s_add_u32 s3, s3, s10
    s_add_u32 s3, s3, 0
    v_add_u32 v7, s3, v7
    s_mul_i32 s36, s36, 1327104
    s_lshl_b32 s3, s32, 1
    s_add_u32 s3, s3, s35
    s_lshl_b32 s3, s3, 10
    s_add_u32 s36, s36, s3
    s_waitcnt vmcnt(2)
    s_barrier
    ds_read_b64_tr_b16 v[16:17], v7 offset:0
    ds_read_b64_tr_b16 v[18:19], v7 offset:18432
    ds_read_b64_tr_b16 v[20:21], v7 offset:32
    ds_read_b64_tr_b16 v[22:23], v7 offset:18464
    ds_read_b64_tr_b16 v[24:25], v7 offset:64
    ds_read_b64_tr_b16 v[26:27], v7 offset:18496
    ds_read_b64_tr_b16 v[28:29], v7 offset:96
    ds_read_b64_tr_b16 v[30:31], v7 offset:18528
    ds_read_b64_tr_b16 v[32:33], v7 offset:128
    ds_read_b64_tr_b16 v[34:35], v7 offset:18560
    ds_read_b64_tr_b16 v[36:37], v7 offset:160
    ds_read_b64_tr_b16 v[38:39], v7 offset:18592
    s_waitcnt lgkmcnt(0)
    buffer_store_dwordx4 v[16:19], v5, s[20:23], s36 offen sc1
    s_add_u32 s36, s36, 73728
    buffer_store_dwordx4 v[20:23], v5, s[20:23], s36 offen sc1
    s_add_u32 s36, s36, 73728
    buffer_store_dwordx4 v[24:27], v5, s[20:23], s36 offen sc1
    s_add_u32 s36, s36, 73728
    buffer_store_dwordx4 v[28:31], v5, s[20:23], s36 offen sc1
    s_add_u32 s36, s36, 73728
    buffer_store_dwordx4 v[32:35], v5, s[20:23], s36 offen sc1
    s_add_u32 s36, s36, 73728
    buffer_store_dwordx4 v[36:39], v5, s[20:23], s36 offen sc1
    s_add_u32 s36, s36, 73728
    ds_read_b64_tr_b16 v[40:41], v7 offset:192
    ds_read_b64_tr_b16 v[42:43], v7 offset:18624
    ds_read_b64_tr_b16 v[44:45], v7 offset:224
    ds_read_b64_tr_b16 v[46:47], v7 offset:18656
    ds_read_b64_tr_b16 v[48:49], v7 offset:256
    ds_read_b64_tr_b16 v[50:51], v7 offset:18688
    ds_read_b64_tr_b16 v[52:53], v7 offset:288
    ds_read_b64_tr_b16 v[54:55], v7 offset:18720
    ds_read_b64_tr_b16 v[56:57], v7 offset:320
    ds_read_b64_tr_b16 v[58:59], v7 offset:18752
    ds_read_b64_tr_b16 v[60:61], v7 offset:352
    ds_read_b64_tr_b16 v[62:63], v7 offset:18784
    s_waitcnt lgkmcnt(0)
    buffer_store_dwordx4 v[40:43], v5, s[20:23], s36 offen sc1
    s_add_u32 s36, s36, 73728
    buffer_store_dwordx4 v[44:47], v5, s[20:23], s36 offen sc1
    s_add_u32 s36, s36, 73728
    buffer_store_dwordx4 v[48:51], v5, s[20:23], s36 offen sc1
    s_add_u32 s36, s36, 73728
    buffer_store_dwordx4 v[52:55], v5, s[20:23], s36 offen sc1
    s_add_u32 s36, s36, 73728
    buffer_store_dwordx4 v[56:59], v5, s[20:23], s36 offen sc1
    s_add_u32 s36, s36, 73728
    buffer_store_dwordx4 v[60:63], v5, s[20:23], s36 offen sc1
    s_add_u32 s36, s36, 73728
    ds_read_b64_tr_b16 v[64:65], v7 offset:384
    ds_read_b64_tr_b16 v[66:67], v7 offset:18816
    ds_read_b64_tr_b16 v[68:69], v7 offset:416
    ds_read_b64_tr_b16 v[70:71], v7 offset:18848
    ds_read_b64_tr_b16 v[72:73], v7 offset:448
    ds_read_b64_tr_b16 v[74:75], v7 offset:18880
    ds_read_b64_tr_b16 v[76:77], v7 offset:480
    ds_read_b64_tr_b16 v[78:79], v7 offset:18912
    ds_read_b64_tr_b16 v[80:81], v7 offset:512
    ds_read_b64_tr_b16 v[82:83], v7 offset:18944
    ds_read_b64_tr_b16 v[84:85], v7 offset:544
    ds_read_b64_tr_b16 v[86:87], v7 offset:18976
    s_waitcnt lgkmcnt(0)
    buffer_store_dwordx4 v[64:67], v5, s[20:23], s36 offen sc1
    s_add_u32 s36, s36, 73728
    buffer_store_dwordx4 v[68:71], v5, s[20:23], s36 offen sc1
    s_add_u32 s36, s36, 73728
    buffer_store_dwordx4 v[72:75], v5, s[20:23], s36 offen sc1
    s_add_u32 s36, s36, 73728
    buffer_store_dwordx4 v[76:79], v5, s[20:23], s36 offen sc1
    s_add_u32 s36, s36, 73728
    buffer_store_dwordx4 v[80:83], v5, s[20:23], s36 offen sc1
    s_add_u32 s36, s36, 73728
    buffer_store_dwordx4 v[84:87], v5, s[20:23], s36 offen sc1
    s_branch L_mjoin_2
L_fidle_7:
    s_waitcnt lgkmcnt(0)
    s_load_dword s86, s[8:9], 524288
    s_waitcnt lgkmcnt(0)
    s_mul_i32 s87, s86, 0x9e3779b1
    s_add_u32 s87, s87, 0x7f4a7c15
    s_mov_b32 s72, s88
    s_mov_b32 s73, s89
    s_mov_b32 s74, 0x800000
    s_mov_b32 s75, 0x00020000
    s_sub_u32 s3, s2, 252
    s_mul_i32 s3, s3, 262144
    s_add_u32 s3, s3, 7340032
    v_lshlrev_b32 v1, 7, v0
    buffer_load_dword v240, v1, s[72:75], s3 offen
    s_add_u32 s3, s3, 32768
    buffer_load_dword v241, v1, s[72:75], s3 offen
    s_add_u32 s3, s3, 32768
    buffer_load_dword v242, v1, s[72:75], s3 offen
    s_add_u32 s3, s3, 32768
    buffer_load_dword v243, v1, s[72:75], s3 offen
    s_add_u32 s3, s3, 32768
    buffer_load_dword v244, v1, s[72:75], s3 offen
    s_add_u32 s3, s3, 32768
    buffer_load_dword v245, v1, s[72:75], s3 offen
    s_add_u32 s3, s3, 32768
    buffer_load_dword v246, v1, s[72:75], s3 offen
    s_add_u32 s3, s3, 32768
    buffer_load_dword v247, v1, s[72:75], s3 offen
L_mjoin_2:
    s_and_b32 s3, s2, 7
    s_lshr_b32 s10, s2, 3
    s_and_b32 s32, s3, 1
    s_lshl_b32 s32, s32, 3
    s_and_b32 s11, s10, 7
    s_add_u32 s32, s32, s11
    s_lshr_b32 s33, s3, 1
    s_lshl_b32 s33, s33, 2
    s_lshr_b32 s11, s10, 3
    s_add_u32 s33, s33, s11
    s_add_u32 s44, s8, 0x50000
    s_addc_u32 s45, s9, 0
    s_mov_b32 s46, 0x30000
    s_mov_b32 s47, 0x00020000
    s_add_u32 s28, s8, 0x10000
    s_addc_u32 s29, s9, 0
    s_mov_b32 s30, 0x40000
    s_mov_b32 s31, 0x00020000
    v_lshlrev_b32 v1, 2, v2
    v_mov_b32 v8, -1
    s_lshl_b32 s11, s32, 2
    s_add_u32 s11, s11, s34
    s_lshl_b32 s11, s11, 12
    s_lshl_b32 s10, s33, 8
    s_add_u32 s11, s11, s10
    buffer_store_dword v8, v1, s[28:31], s11 offen sc1
    s_waitcnt vmcnt(0) lgkmcnt(0)
    s_barrier
    s_cmp_lg_u32 s34, 0
    s_cbranch_scc1 L_fl_27
    s_lshl_b32 s10, s2, 7
    s_add_u32 s10, s10, 32768
    v_lshlrev_b32 v1, 2, v2
    v_mov_b32 v6, s87
    s_mov_b32 exec_hi, 0
    buffer_store_dword v6, v1, s[44:47], s10 offen sc1
    s_mov_b64 exec, -1
L_fl_27:
    s_cmp_lt_u32 s2, 216
    s_cbranch_scc1 L_jt_28
    s_mov_b32 s72, s88
    s_mov_b32 s73, s89
    s_mov_b32 s74, 0x800000
    s_mov_b32 s75, 0x00020000
    s_sub_u32 s3, s2, 216
    s_mul_i32 s3, s3, 65536
    s_add_u32 s3, s3, 4718592
    v_lshlrev_b32 v1, 7, v0
    buffer_load_dword v240, v1, s[72:75], s3 offen
    s_add_u32 s3, s3, 32768
    buffer_load_dword v241, v1, s[72:75], s3 offen
L_jt_28:
    v_min_u32 v7, 8, v2
    s_mul_i32 s10, s33, 9
    s_add_u32 s10, s10, 144
    v_add_u32 v7, s10, v7
    v_lshrrev_b32 v7, 2, v7
    v_lshlrev_b32 v7, 7, v7
    v_add_u32 v7, 116736, v7
L_mjoin_2_slow:
    s_mov_b32 s70, 0x20000
L_poll_29:
    buffer_load_dword v6, v7, s[44:47], 0 offen sc1
    s_waitcnt vmcnt(0)
    v_cmp_ne_u32 vcc, s87, v6
    s_cbranch_vccz L_pollok_30
    s_mov_b64 exec, vcc
    s_sub_u32 s70, s70, 1
    s_cmp_eq_u32 s70, 0
    s_cbranch_scc1 L_pollok_30
    s_branch L_poll_29
L_pollok_30:
    s_mov_b64 exec, -1
L_mjoin2_4:
    s_add_u32 s12, s8, 0x810000
    s_addc_u32 s13, s9, 0
    s_mov_b32 s14, 0x510000
    s_mov_b32 s15, 0x00020000
    v_lshlrev_b32 v3, 4, v2
    v_add_u32 v4, 0x1000, v3
    v_add_u32 v5, 0x2000, v3
    s_mul_i32 s38, s34, 9216
    s_mul_i32 s35, s33, 331776
    s_add_u32 s35, s35, s38
    s_add_u32 m0, s38, 0x0
    s_nop 0
    buffer_load_dwordx4 v3, s[12:15], s35 offen offset:0 sc1 lds
    buffer_load_dwordx4 v3, s[12:15], s35 offen offset:1024 sc1 lds
    buffer_load_dwordx4 v3, s[12:15], s35 offen offset:2048 sc1 lds
    buffer_load_dwordx4 v3, s[12:15], s35 offen offset:3072 sc1 lds
    s_add_u32 m0, s38, 0x1000
    s_nop 0
    buffer_load_dwordx4 v4, s[12:15], s35 offen offset:0 sc1 lds
    buffer_load_dwordx4 v4, s[12:15], s35 offen offset:1024 sc1 lds
    buffer_load_dwordx4 v4, s[12:15], s35 offen offset:2048 sc1 lds
    buffer_load_dwordx4 v4, s[12:15], s35 offen offset:3072 sc1 lds
    s_add_u32 m0, s38, 0x2000
    s_nop 0
    buffer_load_dwordx4 v5, s[12:15], s35 offen offset:0 sc1 lds
    s_add_u32 s35, s35, 36864
    s_add_u32 m0, s38, 0x9000
    s_nop 0
    buffer_load_dwordx4 v3, s[12:15], s35 offen offset:0 sc1 lds
    buffer_load_dwordx4 v3, s[12:15], s35 offen offset:1024 sc1 lds
    buffer_load_dwordx4 v3, s[12:15], s35 offen offset:2048 sc1 lds
    buffer_load_dwordx4 v3, s[12:15], s35 offen offset:3072 sc1 lds
    s_add_u32 m0, s38, 0xa000
    s_nop 0
    buffer_load_dwordx4 v4, s[12:15], s35 offen offset:0 sc1 lds
    buffer_load_dwordx4 v4, s[12:15], s35 offen offset:1024 sc1 lds
    buffer_load_dwordx4 v4, s[12:15], s35 offen offset:2048 sc1 lds
    buffer_load_dwordx4 v4, s[12:15], s35 offen offset:3072 sc1 lds
    s_add_u32 m0, s38, 0xb000
    s_nop 0
    buffer_load_dwordx4 v5, s[12:15], s35 offen offset:0 sc1 lds
    s_add_u32 s35, s35, 36864
    s_getpc_b64 s[4:5]
    s_lshr_b32 s3, s2, 3
    s_lshl_b32 s3, s3, 2
    s_add_u32 s3, s3, s34
    s_mul_i32 s3, s3, 256
    v_min_u32 v1, 1, v2
    v_lshl_add_u32 v1, v1, 7, s3
    v_min_u32 v1, 0x93dc, v1
    global_load_dword v8, v1, s[4:5]
    v_lshlrev_b32 v7, 7, v0
    s_mov_b32 s3, 32768
    s_mov_b32 s70, 0x20000
L_poll_31:
    buffer_load_dword v6, v7, s[44:47], s3 offen sc1
    s_waitcnt vmcnt(0)
    v_cmp_ne_u32 vcc, s87, v6
    s_cbranch_vccz L_pollok_32
    s_mov_b64 exec, vcc
    s_sub_u32 s70, s70, 1
    s_cmp_eq_u32 s70, 0
    s_cbranch_scc1 L_pollok_32
    s_branch L_poll_31
L_pollok_32:
    s_mov_b64 exec, -1
    s_barrier
    s_add_u32 s3, s2, s34
    s_cmp_lg_u32 s3, 0
    s_cbranch_scc1 L_ep_33
    s_add_u32 s16, s8, 0x80000
    s_addc_u32 s17, s9, 0
    s_mov_b32 s18, 0x40
    s_mov_b32 s19, 0x00020000
    s_add_u32 s3, s86, 1
    v_mov_b32 v6, s3
    v_mov_b32 v1, 0
    s_mov_b64 exec, 1
    buffer_store_dword v6, v1, s[16:19], 0 offen sc1
    s_mov_b64 exec, -1
L_ep_33:
    s_add_u32 s76, s8, 0x580000
    s_addc_u32 s77, s9, 0
    s_mov_b32 s78, 0x288000
    s_mov_b32 s79, 0x00020000
    s_bfe_u32 s3, s33, 0x20001
    s_mul_i32 s80, s3, 9
    s_and_b32 s3, s33, 1
    s_mul_i32 s3, s3, 5
    s_add_u32 s80, s80, s3
    s_mul_i32 s3, s80, 72
    s_mul_i32 s10, s34, 18
    s_add_u32 s3, s3, s10
    s_lshl_b32 s81, s3, 10
    s_add_u32 s82, s81, 73728
    s_add_u32 s83, s81, 147456
    s_add_u32 s84, s81, 221184
    s_add_u32 s85, s81, 294912
    s_sub_u32 s3, s81, 73728
    s_bitcmp1_b32 s33, 0
    s_cselect_b32 s85, s3, s85
    s_mov_b32 s55, 0
    s_mov_b32 s54, 0
    s_add_u32 s16, s8, 0x100000
    s_addc_u32 s17, s9, 0
    s_mov_b32 s18, 0x240000
    s_mov_b32 s19, 0x00020000
    s_add_u32 s24, s8, 0xd20000
    s_addc_u32 s25, s9, 0
    s_mov_b32 s26, 0x900000
    s_mov_b32 s27, 0x00020000
    s_add_u32 s28, s8, 0x10000
    s_addc_u32 s29, s9, 0
    s_mov_b32 s30, 0x40000
    s_mov_b32 s31, 0x00020000
    s_add_u32 s44, s8, 0x7000
    s_addc_u32 s45, s9, 0
    s_mov_b32 s46, 0x4800
    s_mov_b32 s47, 0x00020000
    s_lshl_b32 s3, s32, 2
    s_add_u32 s36, s3, s34
    s_mul_i32 s39, s36, 36864
    buffer_load_dwordx4 v[120:123], v3, s[16:19], s39 offen offset:0 sc1
    buffer_load_dwordx4 v[124:127], v3, s[16:19], s39 offen offset:1024 sc1
    buffer_load_dwordx4 v[128:131], v3, s[16:19], s39 offen offset:2048 sc1
    buffer_load_dwordx4 v[132:135], v3, s[16:19], s39 offen offset:3072 sc1
    buffer_load_dwordx4 v[136:139], v4, s[16:19], s39 offen offset:0 sc1
    buffer_load_dwordx4 v[140:143], v4, s[16:19], s39 offen offset:1024 sc1
    buffer_load_dwordx4 v[144:147], v4, s[16:19], s39 offen offset:2048 sc1
    buffer_load_dwordx4 v[148:151], v4, s[16:19], s39 offen offset:3072 sc1
    s_add_u32 s39, s39, 8192
    buffer_load_dwordx4 v[152:155], v3, s[16:19], s39 offen offset:0 sc1
    buffer_load_dwordx4 v[156:159], v3, s[16:19], s39 offen offset:1024 sc1
    buffer_load_dwordx4 v[160:163], v3, s[16:19], s39 offen offset:2048 sc1
    buffer_load_dwordx4 v[164:167], v3, s[16:19], s39 offen offset:3072 sc1
    buffer_load_dwordx4 v[168:171], v4, s[16:19], s39 offen offset:0 sc1
    buffer_load_dwordx4 v[172:175], v4, s[16:19], s39 offen offset:1024 sc1
    v_and_b32 v6, 15, v2
    v_lshlrev_b32 v7, 2, v6
    s_mul_i32 s37, s33, 576
    s_add_u32 s49, s37, 9216
    s_lshl_b32 s42, s34, 10
    s_add_u32 s42, s42, 147968
    v_add_u32 v21, s42, v7
    v_add_u32 v8, 0x0, v3
    v_add_u32 v9, 0x9000, v3
    v_add_u32 v10, 0x12000, v3
    v_add_u32 v11, 0x1b000, v3
    v_mov_b32 v24, 0xc0135761
    v_mov_b32 v25, 0xc0135761
    v_mov_b32 v26, 0xbdd2d3e8
    v_mov_b32 v27, 0xbdd2d3e8
    v_mov_b32 v28, 0x3f803f80
    v_mov_b32 v29, 0x3f803f80
    v_mov_b32 v30, 0x3f803f80
    v_mov_b32 v31, 0x3f803f80
    ds_read_b128 v[176:179], v8 offset:0
    ds_read_b128 v[180:183], v8 offset:1024
    ds_read_b128 v[184:187], v8 offset:2048
    ds_read_b128 v[188:191], v8 offset:3072
    ds_read_b128 v[192:195], v8 offset:4096
    ds_read_b128 v[196:199], v8 offset:5120
    ds_read_b128 v[200:203], v8 offset:6144
    ds_read_b128 v[204:207], v8 offset:7168
    ds_read_b128 v[208:211], v8 offset:8192
    s_waitcnt vmcnt(12)
    v_accvgpr_write_b32 a0, v120
    v_accvgpr_write_b32 a1, v121
    v_accvgpr_write_b32 a2, v124
    v_accvgpr_write_b32 a3, v125
    v_accvgpr_write_b32 a4, v122
    v_accvgpr_write_b32 a5, v123
    v_accvgpr_write_b32 a6, v126
    v_accvgpr_write_b32 a7, v127
    s_nop 0
    s_waitcnt vmcnt(10) lgkmcnt(0)
    v_mfma_f32_16x16x32_bf16 v[104:107], a[0:3], a[0:3], 0
    ds_read_b128 v[212:215], v8 offset:9216
    v_accvgpr_write_b32 a8, v128
    v_mfma_f32_16x16x32_bf16 v[112:115], a[0:3], v[28:31], 0
    ds_read_b128 v[216:219], v8 offset:10240
    v_mfma_f32_16x16x32_bf16 v[108:111], a[4:7], a[4:7], 0
    ds_read_b128 v[220:223], v8 offset:11264
    buffer_load_dwordx4 v[120:123], v4, s[16:19], s39 offen offset:2048 sc1
    v_mfma_f32_16x16x32_bf16 v[116:119], a[4:7], v[28:31], 0
    v_mfma_f32_16x16x32_bf16 v[32:35], a[0:3], v[176:179], 0
    ds_read_b128 v[224:227], v8 offset:12288
    v_accvgpr_write_b32 a9, v129
    v_mfma_f32_16x16x32_bf16 v[36:39], a[4:7], v[176:179], 0
    ds_read_b128 v[228:231], v8 offset:13312
    v_mfma_f32_16x16x32_bf16 v[40:43], a[0:3], v[180:183], 0
    ds_read_b128 v[232:235], v8 offset:14336
    v_accvgpr_write_b32 a10, v132
    v_mfma_f32_16x16x32_bf16 v[44:47], a[4:7], v[180:183], 0
    v_mfma_f32_16x16x32_bf16 v[48:51], a[0:3], v[184:187], 0
    ds_read_b128 v[236:239], v8 offset:15360
    buffer_load_dwordx4 v[124:127], v4, s[16:19], s39 offen offset:3072 sc1
    s_add_u32 s39, s39, 8192
    v_mfma_f32_16x16x32_bf16 v[52:55], a[4:7], v[184:187], 0
    ds_read_b128 v[240:243], v8 offset:16384
    v_mfma_f32_16x16x32_bf16 v[56:59], a[0:3], v[188:191], 0
    ds_read_b128 v[244:247], v8 offset:17408
    v_accvgpr_write_b32 a11, v133
    v_mfma_f32_16x16x32_bf16 v[60:63], a[4:7], v[188:191], 0
    v_accvgpr_write_b32 a12, v130
    v_mfma_f32_16x16x32_bf16 v[64:67], a[0:3], v[192:195], 0
    s_add_u32 m0, s38, 0x12000
    v_mfma_f32_16x16x32_bf16 v[68:71], a[4:7], v[192:195], 0
    buffer_load_dwordx4 v3, s[12:15], s35 offen offset:0 sc1 lds
    v_mfma_f32_16x16x32_bf16 v[72:75], a[0:3], v[196:199], 0
    v_mfma_f32_16x16x32_bf16 v[76:79], a[4:7], v[196:199], 0
    v_accvgpr_write_b32 a13, v131
    v_mfma_f32_16x16x32_bf16 v[80:83], a[0:3], v[200:203], 0
    v_mfma_f32_16x16x32_bf16 v[84:87], a[4:7], v[200:203], 0
    v_accvgpr_write_b32 a14, v134
    v_mfma_f32_16x16x32_bf16 v[88:91], a[0:3], v[204:207], 0
    v_mfma_f32_16x16x32_bf16 v[92:95], a[4:7], v[204:207], 0
    buffer_load_dwordx4 v3, s[12:15], s35 offen offset:1024 sc1 lds
    v_mfma_f32_16x16x32_bf16 v[96:99], a[0:3], v[208:211], 0
    v_mfma_f32_16x16x32_bf16 v[100:103], a[4:7], v[208:211], 0
    v_accvgpr_write_b32 a15, v135
    s_waitcnt vmcnt(12) lgkmcnt(0)
    v_mfma_f32_16x16x32_bf16 v[104:107], a[8:11], a[8:11], v[104:107]
    ds_read_b128 v[176:179], v8 offset:18432
    v_accvgpr_write_b32 a16, v136
    v_mfma_f32_16x16x32_bf16 v[112:115], a[8:11], v[28:31], v[112:115]
    ds_read_b128 v[180:183], v8 offset:19456
    v_mfma_f32_16x16x32_bf16 v[108:111], a[12:15], a[12:15], v[108:111]
    ds_read_b128 v[184:187], v8 offset:20480
    buffer_load_dwordx4 v[128:131], v3, s[16:19], s39 offen offset:0 sc1
    v_mfma_f32_16x16x32_bf16 v[116:119], a[12:15], v[28:31], v[116:119]
    v_mfma_f32_16x16x32_bf16 v[32:35], a[8:11], v[212:215], v[32:35]
    ds_read_b128 v[188:191], v8 offset:21504
    v_accvgpr_write_b32 a17, v137
    v_mfma_f32_16x16x32_bf16 v[36:39], a[12:15], v[212:215], v[36:39]
    ds_read_b128 v[192:195], v8 offset:22528
    v_mfma_f32_16x16x32_bf16 v[40:43], a[8:11], v[216:219], v[40:43]
    ds_read_b128 v[196:199], v8 offset:23552
    v_accvgpr_write_b32 a18, v140
    v_mfma_f32_16x16x32_bf16 v[44:47], a[12:15], v[216:219], v[44:47]
    v_mfma_f32_16x16x32_bf16 v[48:51], a[8:11], v[220:223], v[48:51]
    ds_read_b128 v[200:203], v8 offset:24576
    buffer_load_dwordx4 v[132:135], v3, s[16:19], s39 offen offset:1024 sc1
    v_mfma_f32_16x16x32_bf16 v[52:55], a[12:15], v[220:223], v[52:55]
    ds_read_b128 v[204:207], v8 offset:25600
    v_mfma_f32_16x16x32_bf16 v[56:59], a[8:11], v[224:227], v[56:59]
    ds_read_b128 v[208:211], v8 offset:26624
    v_accvgpr_write_b32 a19, v141
    v_mfma_f32_16x16x32_bf16 v[60:63], a[12:15], v[224:227], v[60:63]
    v_accvgpr_write_b32 a20, v138
    v_mfma_f32_16x16x32_bf16 v[64:67], a[8:11], v[228:231], v[64:67]
    v_mfma_f32_16x16x32_bf16 v[68:71], a[12:15], v[228:231], v[68:71]
    buffer_load_dwordx4 v3, s[12:15], s35 offen offset:2048 sc1 lds
    v_mfma_f32_16x16x32_bf16 v[72:75], a[8:11], v[232:235], v[72:75]
    v_mfma_f32_16x16x32_bf16 v[76:79], a[12:15], v[232:235], v[76:79]
    v_accvgpr_write_b32 a21, v139
    v_mfma_f32_16x16x32_bf16 v[80:83], a[8:11], v[236:239], v[80:83]
    v_mfma_f32_16x16x32_bf16 v[84:87], a[12:15], v[236:239], v[84:87]
    v_accvgpr_write_b32 a22, v142
    v_mfma_f32_16x16x32_bf16 v[88:91], a[8:11], v[240:243], v[88:91]
    v_mfma_f32_16x16x32_bf16 v[92:95], a[12:15], v[240:243], v[92:95]
    buffer_load_dwordx4 v3, s[12:15], s35 offen offset:3072 sc1 lds
    v_mfma_f32_16x16x32_bf16 v[96:99], a[8:11], v[244:247], v[96:99]
    v_mfma_f32_16x16x32_bf16 v[100:103], a[12:15], v[244:247], v[100:103]
    v_accvgpr_write_b32 a23, v143
    s_waitcnt vmcnt(14) lgkmcnt(0)
    v_mfma_f32_16x16x32_bf16 v[104:107], a[16:19], a[16:19], v[104:107]
    ds_read_b128 v[212:215], v8 offset:27648
    v_accvgpr_write_b32 a24, v144
    v_mfma_f32_16x16x32_bf16 v[112:115], a[16:19], v[28:31], v[112:115]
    ds_read_b128 v[216:219], v8 offset:28672
    v_mfma_f32_16x16x32_bf16 v[108:111], a[20:23], a[20:23], v[108:111]
    ds_read_b128 v[220:223], v8 offset:29696
    buffer_load_dwordx4 v[136:139], v3, s[16:19], s39 offen offset:2048 sc1
    v_mfma_f32_16x16x32_bf16 v[116:119], a[20:23], v[28:31], v[116:119]
    v_mfma_f32_16x16x32_bf16 v[32:35], a[16:19], v[176:179], v[32:35]
    ds_read_b128 v[224:227], v8 offset:30720
    v_accvgpr_write_b32 a25, v145
    v_mfma_f32_16x16x32_bf16 v[36:39], a[20:23], v[176:179], v[36:39]
    ds_read_b128 v[228:231], v8 offset:31744
    v_mfma_f32_16x16x32_bf16 v[40:43], a[16:19], v[180:183], v[40:43]
    ds_read_b128 v[232:235], v8 offset:32768
    v_accvgpr_write_b32 a26, v148
    v_mfma_f32_16x16x32_bf16 v[44:47], a[20:23], v[180:183], v[44:47]
    v_mfma_f32_16x16x32_bf16 v[48:51], a[16:19], v[184:187], v[48:51]
    ds_read_b128 v[236:239], v8 offset:33792
    buffer_load_dwordx4 v[140:143], v3, s[16:19], s39 offen offset:3072 sc1
    v_mfma_f32_16x16x32_bf16 v[52:55], a[20:23], v[184:187], v[52:55]
    ds_read_b128 v[240:243], v8 offset:34816
    v_mfma_f32_16x16x32_bf16 v[56:59], a[16:19], v[188:191], v[56:59]
    ds_read_b128 v[244:247], v8 offset:35840
    v_accvgpr_write_b32 a27, v149
    v_mfma_f32_16x16x32_bf16 v[60:63], a[20:23], v[188:191], v[60:63]
    v_accvgpr_write_b32 a28, v146
    v_mfma_f32_16x16x32_bf16 v[64:67], a[16:19], v[192:195], v[64:67]
    s_add_u32 m0, s38, 0x13000
    v_mfma_f32_16x16x32_bf16 v[68:71], a[20:23], v[192:195], v[68:71]
    buffer_load_dwordx4 v4, s[12:15], s35 offen offset:0 sc1 lds
    v_mfma_f32_16x16x32_bf16 v[72:75], a[16:19], v[196:199], v[72:75]
    v_mfma_f32_16x16x32_bf16 v[76:79], a[20:23], v[196:199], v[76:79]
    v_accvgpr_write_b32 a29, v147
    v_mfma_f32_16x16x32_bf16 v[80:83], a[16:19], v[200:203], v[80:83]
    v_mfma_f32_16x16x32_bf16 v[84:87], a[20:23], v[200:203], v[84:87]
    v_accvgpr_write_b32 a30, v150
    v_mfma_f32_16x16x32_bf16 v[88:91], a[16:19], v[204:207], v[88:91]
    v_mfma_f32_16x16x32_bf16 v[92:95], a[20:23], v[204:207], v[92:95]
    buffer_load_dwordx4 v4, s[12:15], s35 offen offset:1024 sc1 lds
    v_mfma_f32_16x16x32_bf16 v[96:99], a[16:19], v[208:211], v[96:99]
    v_mfma_f32_16x16x32_bf16 v[100:103], a[20:23], v[208:211], v[100:103]
    v_accvgpr_write_b32 a31, v151
    s_waitcnt vmcnt(16) lgkmcnt(0)
    s_barrier
    v_mfma_f32_16x16x32_bf16 v[104:107], a[24:27], a[24:27], v[104:107]
    ds_read_b128 v[176:179], v9 offset:0
    v_accvgpr_write_b32 a32, v152
    v_mfma_f32_16x16x32_bf16 v[112:115], a[24:27], v[28:31], v[112:115]
    ds_read_b128 v[180:183], v9 offset:1024
    v_mfma_f32_16x16x32_bf16 v[108:111], a[28:31], a[28:31], v[108:111]
    ds_read_b128 v[184:187], v9 offset:2048
    buffer_load_dwordx4 v[144:147], v4, s[16:19], s39 offen offset:0 sc1
    v_mfma_f32_16x16x32_bf16 v[116:119], a[28:31], v[28:31], v[116:119]
    v_mfma_f32_16x16x32_bf16 v[32:35], a[24:27], v[212:215], v[32:35]
    ds_read_b128 v[188:191], v9 offset:3072
    v_accvgpr_write_b32 a33, v153
    v_mfma_f32_16x16x32_bf16 v[36:39], a[28:31], v[212:215], v[36:39]
    ds_read_b128 v[192:195], v9 offset:4096
    v_mfma_f32_16x16x32_bf16 v[40:43], a[24:27], v[216:219], v[40:43]
    ds_read_b128 v[196:199], v9 offset:5120
    v_accvgpr_write_b32 a34, v156
    v_mfma_f32_16x16x32_bf16 v[44:47], a[28:31], v[216:219], v[44:47]
    v_mfma_f32_16x16x32_bf16 v[48:51], a[24:27], v[220:223], v[48:51]
    ds_read_b128 v[200:203], v9 offset:6144
    buffer_load_dwordx4 v[148:151], v4, s[16:19], s39 offen offset:1024 sc1
    v_mfma_f32_16x16x32_bf16 v[52:55], a[28:31], v[220:223], v[52:55]
    ds_read_b128 v[204:207], v9 offset:7168
    v_mfma_f32_16x16x32_bf16 v[56:59], a[24:27], v[224:227], v[56:59]
    ds_read_b128 v[208:211], v9 offset:8192
    v_accvgpr_write_b32 a35, v157
    v_mfma_f32_16x16x32_bf16 v[60:63], a[28:31], v[224:227], v[60:63]
    v_accvgpr_write_b32 a36, v154
    v_mfma_f32_16x16x32_bf16 v[64:67], a[24:27], v[228:231], v[64:67]
    v_mfma_f32_16x16x32_bf16 v[68:71], a[28:31], v[228:231], v[68:71]
    buffer_load_dwordx4 v4, s[12:15], s35 offen offset:2048 sc1 lds
    v_mfma_f32_16x16x32_bf16 v[72:75], a[24:27], v[232:235], v[72:75]
    v_mfma_f32_16x16x32_bf16 v[76:79], a[28:31], v[232:235], v[76:79]
    v_accvgpr_write_b32 a37, v155
    v_mfma_f32_16x16x32_bf16 v[80:83], a[24:27], v[236:239], v[80:83]
    v_mfma_f32_16x16x32_bf16 v[84:87], a[28:31], v[236:239], v[84:87]
    v_accvgpr_write_b32 a38, v158
    v_mfma_f32_16x16x32_bf16 v[88:91], a[24:27], v[240:243], v[88:91]
    v_mfma_f32_16x16x32_bf16 v[92:95], a[28:31], v[240:243], v[92:95]
    buffer_load_dwordx4 v4, s[12:15], s35 offen offset:3072 sc1 lds
    v_mfma_f32_16x16x32_bf16 v[96:99], a[24:27], v[244:247], v[96:99]
    v_mfma_f32_16x16x32_bf16 v[100:103], a[28:31], v[244:247], v[100:103]
    v_accvgpr_write_b32 a39, v159
    s_waitcnt vmcnt(18) lgkmcnt(0)
    v_mfma_f32_16x16x32_bf16 v[104:107], a[32:35], a[32:35], v[104:107]
    ds_read_b128 v[212:215], v9 offset:9216
    v_accvgpr_write_b32 a40, v160
    v_mfma_f32_16x16x32_bf16 v[112:115], a[32:35], v[28:31], v[112:115]
    ds_read_b128 v[216:219], v9 offset:10240
    v_mfma_f32_16x16x32_bf16 v[108:111], a[36:39], a[36:39], v[108:111]
    ds_read_b128 v[220:223], v9 offset:11264
    buffer_load_dwordx4 v[152:155], v4, s[16:19], s39 offen offset:2048 sc1
    v_mfma_f32_16x16x32_bf16 v[116:119], a[36:39], v[28:31], v[116:119]
    v_mfma_f32_16x16x32_bf16 v[32:35], a[32:35], v[176:179], v[32:35]
    ds_read_b128 v[224:227], v9 offset:12288
    v_accvgpr_write_b32 a41, v161
    v_mfma_f32_16x16x32_bf16 v[36:39], a[36:39], v[176:179], v[36:39]
    ds_read_b128 v[228:231], v9 offset:13312
    v_mfma_f32_16x16x32_bf16 v[40:43], a[32:35], v[180:183], v[40:43]
    ds_read_b128 v[232:235], v9 offset:14336
    v_accvgpr_write_b32 a42, v164
    v_mfma_f32_16x16x32_bf16 v[44:47], a[36:39], v[180:183], v[44:47]
    v_mfma_f32_16x16x32_bf16 v[48:51], a[32:35], v[184:187], v[48:51]
    ds_read_b128 v[236:239], v9 offset:15360
    buffer_load_dwordx4 v[156:159], v4, s[16:19], s39 offen offset:3072 sc1
    s_add_u32 s39, s39, 8192
    v_mfma_f32_16x16x32_bf16 v[52:55], a[36:39], v[184:187], v[52:55]
    ds_read_b128 v[240:243], v9 offset:16384
    v_mfma_f32_16x16x32_bf16 v[56:59], a[32:35], v[188:191], v[56:59]
    ds_read_b128 v[244:247], v9 offset:17408
    v_accvgpr_write_b32 a43, v165
    v_mfma_f32_16x16x32_bf16 v[60:63], a[36:39], v[188:191], v[60:63]
    v_accvgpr_write_b32 a44, v162
    v_mfma_f32_16x16x32_bf16 v[64:67], a[32:35], v[192:195], v[64:67]
    s_add_u32 m0, s38, 0x14000
    v_mfma_f32_16x16x32_bf16 v[68:71], a[36:39], v[192:195], v[68:71]
    buffer_load_dwordx4 v5, s[12:15], s35 offen offset:0 sc1 lds
    s_add_u32 s35, s35, 36864
    v_mfma_f32_16x16x32_bf16 v[72:75], a[32:35], v[196:199], v[72:75]
    v_mfma_f32_16x16x32_bf16 v[76:79], a[36:39], v[196:199], v[76:79]
    v_accvgpr_write_b32 a45, v163
    v_mfma_f32_16x16x32_bf16 v[80:83], a[32:35], v[200:203], v[80:83]
    v_mfma_f32_16x16x32_bf16 v[84:87], a[36:39], v[200:203], v[84:87]
    v_accvgpr_write_b32 a46, v166
    v_mfma_f32_16x16x32_bf16 v[88:91], a[32:35], v[204:207], v[88:91]
    s_add_u32 m0, s38, 0x1b000
    v_mfma_f32_16x16x32_bf16 v[92:95], a[36:39], v[204:207], v[92:95]
    buffer_load_dwordx4 v3, s[12:15], s35 offen offset:0 sc1 lds
    v_mfma_f32_16x16x32_bf16 v[96:99], a[32:35], v[208:211], v[96:99]
    v_mfma_f32_16x16x32_bf16 v[100:103], a[36:39], v[208:211], v[100:103]
    v_accvgpr_write_b32 a47, v167
    s_waitcnt vmcnt(20) lgkmcnt(0)
    v_mfma_f32_16x16x32_bf16 v[104:107], a[40:43], a[40:43], v[104:107]
    ds_read_b128 v[176:179], v9 offset:18432
    v_accvgpr_write_b32 a48, v168
    v_mfma_f32_16x16x32_bf16 v[112:115], a[40:43], v[28:31], v[112:115]
    ds_read_b128 v[180:183], v9 offset:19456
    v_mfma_f32_16x16x32_bf16 v[108:111], a[44:47], a[44:47], v[108:111]
    ds_read_b128 v[184:187], v9 offset:20480
    buffer_load_dwordx4 v[160:163], v3, s[16:19], s39 offen offset:0 sc1
    v_mfma_f32_16x16x32_bf16 v[116:119], a[44:47], v[28:31], v[116:119]
    v_mfma_f32_16x16x32_bf16 v[32:35], a[40:43], v[212:215], v[32:35]
    ds_read_b128 v[188:191], v9 offset:21504
    v_accvgpr_write_b32 a49, v169
    v_mfma_f32_16x16x32_bf16 v[36:39], a[44:47], v[212:215], v[36:39]
    ds_read_b128 v[192:195], v9 offset:22528
    v_mfma_f32_16x16x32_bf16 v[40:43], a[40:43], v[216:219], v[40:43]
    ds_read_b128 v[196:199], v9 offset:23552
    v_accvgpr_write_b32 a50, v172
    v_mfma_f32_16x16x32_bf16 v[44:47], a[44:47], v[216:219], v[44:47]
    v_mfma_f32_16x16x32_bf16 v[48:51], a[40:43], v[220:223], v[48:51]
    ds_read_b128 v[200:203], v9 offset:24576
    buffer_load_dwordx4 v[164:167], v3, s[16:19], s39 offen offset:1024 sc1
    v_mfma_f32_16x16x32_bf16 v[52:55], a[44:47], v[220:223], v[52:55]
    ds_read_b128 v[204:207], v9 offset:25600
    v_mfma_f32_16x16x32_bf16 v[56:59], a[40:43], v[224:227], v[56:59]
    ds_read_b128 v[208:211], v9 offset:26624
    v_accvgpr_write_b32 a51, v173
    v_mfma_f32_16x16x32_bf16 v[60:63], a[44:47], v[224:227], v[60:63]
    v_accvgpr_write_b32 a52, v170
    v_mfma_f32_16x16x32_bf16 v[64:67], a[40:43], v[228:231], v[64:67]
    v_mfma_f32_16x16x32_bf16 v[68:71], a[44:47], v[228:231], v[68:71]
    buffer_load_dwordx4 v3, s[12:15], s35 offen offset:1024 sc1 lds
    v_mfma_f32_16x16x32_bf16 v[72:75], a[40:43], v[232:235], v[72:75]
    v_mfma_f32_16x16x32_bf16 v[76:79], a[44:47], v[232:235], v[76:79]
    v_accvgpr_write_b32 a53, v171
    v_mfma_f32_16x16x32_bf16 v[80:83], a[40:43], v[236:239], v[80:83]
    v_mfma_f32_16x16x32_bf16 v[84:87], a[44:47], v[236:239], v[84:87]
    v_accvgpr_write_b32 a54, v174
    v_mfma_f32_16x16x32_bf16 v[88:91], a[40:43], v[240:243], v[88:91]
    v_mfma_f32_16x16x32_bf16 v[92:95], a[44:47], v[240:243], v[92:95]
    buffer_load_dwordx4 v3, s[12:15], s35 offen offset:2048 sc1 lds
    v_mfma_f32_16x16x32_bf16 v[96:99], a[40:43], v[244:247], v[96:99]
    v_mfma_f32_16x16x32_bf16 v[100:103], a[44:47], v[244:247], v[100:103]
    v_accvgpr_write_b32 a55, v175
    s_waitcnt vmcnt(22) lgkmcnt(0)
    v_mfma_f32_16x16x32_bf16 v[104:107], a[48:51], a[48:51], v[104:107]
    ds_read_b128 v[212:215], v9 offset:27648
    v_accvgpr_write_b32 a56, v120
    v_mfma_f32_16x16x32_bf16 v[112:115], a[48:51], v[28:31], v[112:115]
    ds_read_b128 v[216:219], v9 offset:28672
    v_mfma_f32_16x16x32_bf16 v[108:111], a[52:55], a[52:55], v[108:111]
    ds_read_b128 v[220:223], v9 offset:29696
    buffer_load_dwordx4 v[168:171], v3, s[16:19], s39 offen offset:2048 sc1
    v_mfma_f32_16x16x32_bf16 v[116:119], a[52:55], v[28:31], v[116:119]
    v_mfma_f32_16x16x32_bf16 v[32:35], a[48:51], v[176:179], v[32:35]
    ds_read_b128 v[224:227], v9 offset:30720
    v_accvgpr_write_b32 a57, v121
    v_mfma_f32_16x16x32_bf16 v[36:39], a[52:55], v[176:179], v[36:39]
    ds_read_b128 v[228:231], v9 offset:31744
    v_mfma_f32_16x16x32_bf16 v[40:43], a[48:51], v[180:183], v[40:43]
    ds_read_b128 v[232:235], v9 offset:32768
    v_accvgpr_write_b32 a58, v124
    v_mfma_f32_16x16x32_bf16 v[44:47], a[52:55], v[180:183], v[44:47]
    v_mfma_f32_16x16x32_bf16 v[48:51], a[48:51], v[184:187], v[48:51]
    ds_read_b128 v[236:239], v9 offset:33792
    buffer_load_dwordx4 v[172:175], v3, s[16:19], s39 offen offset:3072 sc1
    v_mfma_f32_16x16x32_bf16 v[52:55], a[52:55], v[184:187], v[52:55]
    ds_read_b128 v[240:243], v9 offset:34816
    v_mfma_f32_16x16x32_bf16 v[56:59], a[48:51], v[188:191], v[56:59]
    ds_read_b128 v[244:247], v9 offset:35840
    v_accvgpr_write_b32 a59, v125
    v_mfma_f32_16x16x32_bf16 v[60:63], a[52:55], v[188:191], v[60:63]
    v_accvgpr_write_b32 a60, v122
    v_mfma_f32_16x16x32_bf16 v[64:67], a[48:51], v[192:195], v[64:67]
    v_mfma_f32_16x16x32_bf16 v[68:71], a[52:55], v[192:195], v[68:71]
    buffer_load_dwordx4 v3, s[12:15], s35 offen offset:3072 sc1 lds
    v_mfma_f32_16x16x32_bf16 v[72:75], a[48:51], v[196:199], v[72:75]
    v_mfma_f32_16x16x32_bf16 v[76:79], a[52:55], v[196:199], v[76:79]
    v_accvgpr_write_b32 a61, v123
    v_mfma_f32_16x16x32_bf16 v[80:83], a[48:51], v[200:203], v[80:83]
    v_mfma_f32_16x16x32_bf16 v[84:87], a[52:55], v[200:203], v[84:87]
    v_accvgpr_write_b32 a62, v126
    v_mfma_f32_16x16x32_bf16 v[88:91], a[48:51], v[204:207], v[88:91]
    s_add_u32 m0, s38, 0x1c000
    v_mfma_f32_16x16x32_bf16 v[92:95], a[52:55], v[204:207], v[92:95]
    buffer_load_dwordx4 v4, s[12:15], s35 offen offset:0 sc1 lds
    v_mfma_f32_16x16x32_bf16 v[96:99], a[48:51], v[208:211], v[96:99]
    v_mfma_f32_16x16x32_bf16 v[100:103], a[52:55], v[208:211], v[100:103]
    v_accvgpr_write_b32 a63, v127
    s_waitcnt vmcnt(9) lgkmcnt(0)
    s_barrier
    v_mfma_f32_16x16x32_bf16 v[104:107], a[56:59], a[56:59], v[104:107]
    ds_read_b128 v[176:179], v10 offset:0
    v_accvgpr_write_b32 a64, v128
    v_mfma_f32_16x16x32_bf16 v[112:115], a[56:59], v[28:31], v[112:115]
    ds_read_b128 v[180:183], v10 offset:1024
    v_mfma_f32_16x16x32_bf16 v[108:111], a[60:63], a[60:63], v[108:111]
    ds_read_b128 v[184:187], v10 offset:2048
    buffer_load_dwordx4 v[120:123], v4, s[16:19], s39 offen offset:0 sc1
    v_mfma_f32_16x16x32_bf16 v[116:119], a[60:63], v[28:31], v[116:119]
    v_mfma_f32_16x16x32_bf16 v[32:35], a[56:59], v[212:215], v[32:35]
    ds_read_b128 v[188:191], v10 offset:3072
    v_accvgpr_write_b32 a65, v129
    v_mfma_f32_16x16x32_bf16 v[36:39], a[60:63], v[212:215], v[36:39]
    ds_read_b128 v[192:195], v10 offset:4096
    v_mfma_f32_16x16x32_bf16 v[40:43], a[56:59], v[216:219], v[40:43]
    ds_read_b128 v[196:199], v10 offset:5120
    v_accvgpr_write_b32 a66, v132
    v_mfma_f32_16x16x32_bf16 v[44:47], a[60:63], v[216:219], v[44:47]
    v_mfma_f32_16x16x32_bf16 v[48:51], a[56:59], v[220:223], v[48:51]
    ds_read_b128 v[200:203], v10 offset:6144
    buffer_load_dwordx4 v[124:127], v4, s[16:19], s39 offen offset:1024 sc1
    v_mfma_f32_16x16x32_bf16 v[52:55], a[60:63], v[220:223], v[52:55]
    ds_read_b128 v[204:207], v10 offset:7168
    v_mfma_f32_16x16x32_bf16 v[56:59], a[56:59], v[224:227], v[56:59]
    ds_read_b128 v[208:211], v10 offset:8192
    v_accvgpr_write_b32 a67, v133
    v_mfma_f32_16x16x32_bf16 v[60:63], a[60:63], v[224:227], v[60:63]
    v_accvgpr_write_b32 a68, v130
    v_mfma_f32_16x16x32_bf16 v[64:67], a[56:59], v[228:231], v[64:67]
    v_mfma_f32_16x16x32_bf16 v[68:71], a[60:63], v[228:231], v[68:71]
    buffer_load_dwordx4 v4, s[12:15], s35 offen offset:1024 sc1 lds
    v_mfma_f32_16x16x32_bf16 v[72:75], a[56:59], v[232:235], v[72:75]
    v_mfma_f32_16x16x32_bf16 v[76:79], a[60:63], v[232:235], v[76:79]
    v_accvgpr_write_b32 a69, v131
    v_mfma_f32_16x16x32_bf16 v[80:83], a[56:59], v[236:239], v[80:83]
    v_mfma_f32_16x16x32_bf16 v[84:87], a[60:63], v[236:239], v[84:87]
    v_accvgpr_write_b32 a70, v134
    v_mfma_f32_16x16x32_bf16 v[88:91], a[56:59], v[240:243], v[88:91]
    v_mfma_f32_16x16x32_bf16 v[92:95], a[60:63], v[240:243], v[92:95]
    buffer_load_dwordx4 v4, s[12:15], s35 offen offset:2048 sc1 lds
    v_mfma_f32_16x16x32_bf16 v[96:99], a[56:59], v[244:247], v[96:99]
    v_mfma_f32_16x16x32_bf16 v[100:103], a[60:63], v[244:247], v[100:103]
    v_accvgpr_write_b32 a71, v135
    s_waitcnt vmcnt(22) lgkmcnt(0)
    v_mfma_f32_16x16x32_bf16 v[104:107], a[64:67], a[64:67], v[104:107]
    ds_read_b128 v[212:215], v10 offset:9216
    v_accvgpr_write_b32 a72, v136
    v_mfma_f32_16x16x32_bf16 v[112:115], a[64:67], v[28:31], v[112:115]
    ds_read_b128 v[216:219], v10 offset:10240
    v_mfma_f32_16x16x32_bf16 v[108:111], a[68:71], a[68:71], v[108:111]
    ds_read_b128 v[220:223], v10 offset:11264
    buffer_load_dwordx4 v[128:131], v4, s[16:19], s39 offen offset:2048 sc1
    v_mfma_f32_16x16x32_bf16 v[116:119], a[68:71], v[28:31], v[116:119]
    v_mfma_f32_16x16x32_bf16 v[32:35], a[64:67], v[176:179], v[32:35]
    ds_read_b128 v[224:227], v10 offset:12288
    v_accvgpr_write_b32 a73, v137
    v_mfma_f32_16x16x32_bf16 v[36:39], a[68:71], v[176:179], v[36:39]
    ds_read_b128 v[228:231], v10 offset:13312
    v_mfma_f32_16x16x32_bf16 v[40:43], a[64:67], v[180:183], v[40:43]
    ds_read_b128 v[232:235], v10 offset:14336
    v_accvgpr_write_b32 a74, v140
    v_mfma_f32_16x16x32_bf16 v[44:47], a[68:71], v[180:183], v[44:47]
    v_mfma_f32_16x16x32_bf16 v[48:51], a[64:67], v[184:187], v[48:51]
    ds_read_b128 v[236:239], v10 offset:15360
    buffer_load_dwordx4 v[132:135], v4, s[16:19], s39 offen offset:3072 sc1
    s_add_u32 s39, s39, 8192
    v_mfma_f32_16x16x32_bf16 v[52:55], a[68:71], v[184:187], v[52:55]
    ds_read_b128 v[240:243], v10 offset:16384
    v_mfma_f32_16x16x32_bf16 v[56:59], a[64:67], v[188:191], v[56:59]
    ds_read_b128 v[244:247], v10 offset:17408
    v_accvgpr_write_b32 a75, v141
    v_mfma_f32_16x16x32_bf16 v[60:63], a[68:71], v[188:191], v[60:63]
    v_accvgpr_write_b32 a76, v138
    v_mfma_f32_16x16x32_bf16 v[64:67], a[64:67], v[192:195], v[64:67]
    v_mfma_f32_16x16x32_bf16 v[68:71], a[68:71], v[192:195], v[68:71]
    buffer_load_dwordx4 v4, s[12:15], s35 offen offset:3072 sc1 lds
    v_mfma_f32_16x16x32_bf16 v[72:75], a[64:67], v[196:199], v[72:75]
    v_mfma_f32_16x16x32_bf16 v[76:79], a[68:71], v[196:199], v[76:79]
    v_accvgpr_write_b32 a77, v139
    v_mfma_f32_16x16x32_bf16 v[80:83], a[64:67], v[200:203], v[80:83]
    v_mfma_f32_16x16x32_bf16 v[84:87], a[68:71], v[200:203], v[84:87]
    v_accvgpr_write_b32 a78, v142
    v_mfma_f32_16x16x32_bf16 v[88:91], a[64:67], v[204:207], v[88:91]
    s_add_u32 m0, s38, 0x1d000
    v_mfma_f32_16x16x32_bf16 v[92:95], a[68:71], v[204:207], v[92:95]
    buffer_load_dwordx4 v5, s[12:15], s35 offen offset:0 sc1 lds
    s_add_u32 s35, s35, 36864
    v_mfma_f32_16x16x32_bf16 v[96:99], a[64:67], v[208:211], v[96:99]
    v_mfma_f32_16x16x32_bf16 v[100:103], a[68:71], v[208:211], v[100:103]
    v_accvgpr_write_b32 a79, v143
    s_waitcnt vmcnt(22) lgkmcnt(0)
    v_mfma_f32_16x16x32_bf16 v[104:107], a[72:75], a[72:75], v[104:107]
    ds_read_b128 v[176:179], v10 offset:18432
    v_accvgpr_write_b32 a80, v144
    v_mfma_f32_16x16x32_bf16 v[112:115], a[72:75], v[28:31], v[112:115]
    ds_read_b128 v[180:183], v10 offset:19456
    v_mfma_f32_16x16x32_bf16 v[108:111], a[76:79], a[76:79], v[108:111]
    ds_read_b128 v[184:187], v10 offset:20480
    buffer_load_dwordx4 v[136:139], v3, s[16:19], s39 offen offset:0 sc1
    v_mfma_f32_16x16x32_bf16 v[116:119], a[76:79], v[28:31], v[116:119]
    v_mfma_f32_16x16x32_bf16 v[32:35], a[72:75], v[212:215], v[32:35]
    ds_read_b128 v[188:191], v10 offset:21504
    v_accvgpr_write_b32 a81, v145
    v_mfma_f32_16x16x32_bf16 v[36:39], a[76:79], v[212:215], v[36:39]
    ds_read_b128 v[192:195], v10 offset:22528
    v_mfma_f32_16x16x32_bf16 v[40:43], a[72:75], v[216:219], v[40:43]
    ds_read_b128 v[196:199], v10 offset:23552
    v_accvgpr_write_b32 a82, v148
    v_mfma_f32_16x16x32_bf16 v[44:47], a[76:79], v[216:219], v[44:47]
    v_mfma_f32_16x16x32_bf16 v[48:51], a[72:75], v[220:223], v[48:51]
    ds_read_b128 v[200:203], v10 offset:24576
    buffer_load_dwordx4 v[140:143], v3, s[16:19], s39 offen offset:1024 sc1
    v_mfma_f32_16x16x32_bf16 v[52:55], a[76:79], v[220:223], v[52:55]
    ds_read_b128 v[204:207], v10 offset:25600
    v_mfma_f32_16x16x32_bf16 v[56:59], a[72:75], v[224:227], v[56:59]
    ds_read_b128 v[208:211], v10 offset:26624
    v_accvgpr_write_b32 a83, v149
    v_mfma_f32_16x16x32_bf16 v[60:63], a[76:79], v[224:227], v[60:63]
    v_accvgpr_write_b32 a84, v146
    v_mfma_f32_16x16x32_bf16 v[64:67], a[72:75], v[228:231], v[64:67]
    s_add_u32 m0, s38, 0x0
    v_mfma_f32_16x16x32_bf16 v[68:71], a[76:79], v[228:231], v[68:71]
    buffer_load_dwordx4 v3, s[12:15], s35 offen offset:0 sc1 lds
    v_mfma_f32_16x16x32_bf16 v[72:75], a[72:75], v[232:235], v[72:75]
    v_mfma_f32_16x16x32_bf16 v[76:79], a[76:79], v[232:235], v[76:79]
    v_accvgpr_write_b32 a85, v147
    v_mfma_f32_16x16x32_bf16 v[80:83], a[72:75], v[236:239], v[80:83]
    v_mfma_f32_16x16x32_bf16 v[84:87], a[76:79], v[236:239], v[84:87]
    v_accvgpr_write_b32 a86, v150
    v_mfma_f32_16x16x32_bf16 v[88:91], a[72:75], v[240:243], v[88:91]
    v_mfma_f32_16x16x32_bf16 v[92:95], a[76:79], v[240:243], v[92:95]
    buffer_load_dwordx4 v3, s[12:15], s35 offen offset:1024 sc1 lds
    v_mfma_f32_16x16x32_bf16 v[96:99], a[72:75], v[244:247], v[96:99]
    v_mfma_f32_16x16x32_bf16 v[100:103], a[76:79], v[244:247], v[100:103]
    v_accvgpr_write_b32 a87, v151
    s_waitcnt vmcnt(22) lgkmcnt(0)
    v_mfma_f32_16x16x32_bf16 v[104:107], a[80:83], a[80:83], v[104:107]
    ds_read_b128 v[212:215], v10 offset:27648
    v_accvgpr_write_b32 a88, v152
    v_mfma_f32_16x16x32_bf16 v[112:115], a[80:83], v[28:31], v[112:115]
    ds_read_b128 v[216:219], v10 offset:28672
    v_mfma_f32_16x16x32_bf16 v[108:111], a[84:87], a[84:87], v[108:111]
    ds_read_b128 v[220:223], v10 offset:29696
    buffer_load_dwordx4 v[144:147], v3, s[16:19], s39 offen offset:2048 sc1
    v_mfma_f32_16x16x32_bf16 v[116:119], a[84:87], v[28:31], v[116:119]
    v_mfma_f32_16x16x32_bf16 v[32:35], a[80:83], v[176:179], v[32:35]
    ds_read_b128 v[224:227], v10 offset:30720
    v_accvgpr_write_b32 a89, v153
    v_mfma_f32_16x16x32_bf16 v[36:39], a[84:87], v[176:179], v[36:39]
    ds_read_b128 v[228:231], v10 offset:31744
    v_mfma_f32_16x16x32_bf16 v[40:43], a[80:83], v[180:183], v[40:43]
    ds_read_b128 v[232:235], v10 offset:32768
    v_accvgpr_write_b32 a90, v156
    v_mfma_f32_16x16x32_bf16 v[44:47], a[84:87], v[180:183], v[44:47]
    v_mfma_f32_16x16x32_bf16 v[48:51], a[80:83], v[184:187], v[48:51]
    ds_read_b128 v[236:239], v10 offset:33792
    buffer_load_dwordx4 v[148:151], v3, s[16:19], s39 offen offset:3072 sc1
    v_mfma_f32_16x16x32_bf16 v[52:55], a[84:87], v[184:187], v[52:55]
    ds_read_b128 v[240:243], v10 offset:34816
    v_mfma_f32_16x16x32_bf16 v[56:59], a[80:83], v[188:191], v[56:59]
    ds_read_b128 v[244:247], v10 offset:35840
    v_accvgpr_write_b32 a91, v157
    v_mfma_f32_16x16x32_bf16 v[60:63], a[84:87], v[188:191], v[60:63]
    v_accvgpr_write_b32 a92, v154
    v_mfma_f32_16x16x32_bf16 v[64:67], a[80:83], v[192:195], v[64:67]
    v_mfma_f32_16x16x32_bf16 v[68:71], a[84:87], v[192:195], v[68:71]
    buffer_load_dwordx4 v3, s[12:15], s35 offen offset:2048 sc1 lds
    v_mfma_f32_16x16x32_bf16 v[72:75], a[80:83], v[196:199], v[72:75]
    v_mfma_f32_16x16x32_bf16 v[76:79], a[84:87], v[196:199], v[76:79]
    v_accvgpr_write_b32 a93, v155
    v_mfma_f32_16x16x32_bf16 v[80:83], a[80:83], v[200:203], v[80:83]
    v_mfma_f32_16x16x32_bf16 v[84:87], a[84:87], v[200:203], v[84:87]
    v_accvgpr_write_b32 a94, v158
    v_mfma_f32_16x16x32_bf16 v[88:91], a[80:83], v[204:207], v[88:91]
    v_mfma_f32_16x16x32_bf16 v[92:95], a[84:87], v[204:207], v[92:95]
    buffer_load_dwordx4 v3, s[12:15], s35 offen offset:3072 sc1 lds
    v_mfma_f32_16x16x32_bf16 v[96:99], a[80:83], v[208:211], v[96:99]
    v_mfma_f32_16x16x32_bf16 v[100:103], a[84:87], v[208:211], v[100:103]
    v_accvgpr_write_b32 a95, v159
    s_waitcnt vmcnt(8) lgkmcnt(0)
    s_barrier
    v_mfma_f32_16x16x32_bf16 v[104:107], a[88:91], a[88:91], v[104:107]
    ds_read_b128 v[176:179], v11 offset:0
    v_mfma_f32_16x16x32_bf16 v[112:115], a[88:91], v[28:31], v[112:115]
    ds_read_b128 v[180:183], v11 offset:1024
    v_accvgpr_write_b32 a96, v160
    v_mfma_f32_16x16x32_bf16 v[108:111], a[92:95], a[92:95], v[108:111]
    ds_read_b128 v[184:187], v11 offset:2048
    v_mfma_f32_16x16x32_bf16 v[116:119], a[92:95], v[28:31], v[116:119]
    v_accvgpr_write_b32 a97, v161
    v_mfma_f32_16x16x32_bf16 v[32:35], a[88:91], v[212:215], v[32:35]
    ds_read_b128 v[188:191], v11 offset:3072
    s_add_u32 m0, s38, 0x1000
    v_mfma_f32_16x16x32_bf16 v[36:39], a[92:95], v[212:215], v[36:39]
    ds_read_b128 v[192:195], v11 offset:4096
    buffer_load_dwordx4 v4, s[12:15], s35 offen offset:0 sc1 lds
    v_mfma_f32_16x16x32_bf16 v[40:43], a[88:91], v[216:219], v[40:43]
    ds_read_b128 v[196:199], v11 offset:5120
    v_mfma_f32_16x16x32_bf16 v[44:47], a[92:95], v[216:219], v[44:47]
    v_accvgpr_write_b32 a98, v164
    v_mfma_f32_16x16x32_bf16 v[48:51], a[88:91], v[220:223], v[48:51]
    ds_read_b128 v[200:203], v11 offset:6144
    v_mfma_f32_16x16x32_bf16 v[52:55], a[92:95], v[220:223], v[52:55]
    ds_read_b128 v[204:207], v11 offset:7168
    v_accvgpr_write_b32 a99, v165
    v_mfma_f32_16x16x32_bf16 v[56:59], a[88:91], v[224:227], v[56:59]
    ds_read_b128 v[208:211], v11 offset:8192
    v_mfma_f32_16x16x32_bf16 v[60:63], a[92:95], v[224:227], v[60:63]
    v_mfma_f32_16x16x32_bf16 v[64:67], a[88:91], v[228:231], v[64:67]
    v_accvgpr_write_b32 a100, v162
    v_mfma_f32_16x16x32_bf16 v[68:71], a[92:95], v[228:231], v[68:71]
    v_mfma_f32_16x16x32_bf16 v[72:75], a[88:91], v[232:235], v[72:75]
    v_accvgpr_write_b32 a101, v163
    v_mfma_f32_16x16x32_bf16 v[76:79], a[92:95], v[232:235], v[76:79]
    v_mfma_f32_16x16x32_bf16 v[80:83], a[88:91], v[236:239], v[80:83]
    buffer_load_dwordx4 v4, s[12:15], s35 offen offset:1024 sc1 lds
    v_mfma_f32_16x16x32_bf16 v[84:87], a[92:95], v[236:239], v[84:87]
    v_mfma_f32_16x16x32_bf16 v[88:91], a[88:91], v[240:243], v[88:91]
    v_accvgpr_write_b32 a102, v166
    v_mfma_f32_16x16x32_bf16 v[92:95], a[92:95], v[240:243], v[92:95]
    v_mfma_f32_16x16x32_bf16 v[96:99], a[88:91], v[244:247], v[96:99]
    v_accvgpr_write_b32 a103, v167
    v_mfma_f32_16x16x32_bf16 v[100:103], a[92:95], v[244:247], v[100:103]
    s_waitcnt vmcnt(20) lgkmcnt(0)
    v_mfma_f32_16x16x32_bf16 v[104:107], a[96:99], a[96:99], v[104:107]
    ds_read_b128 v[212:215], v11 offset:9216
    v_mfma_f32_16x16x32_bf16 v[112:115], a[96:99], v[28:31], v[112:115]
    ds_read_b128 v[216:219], v11 offset:10240
    v_accvgpr_write_b32 a104, v168
    v_mfma_f32_16x16x32_bf16 v[108:111], a[100:103], a[100:103], v[108:111]
    ds_read_b128 v[220:223], v11 offset:11264
    v_mfma_f32_16x16x32_bf16 v[116:119], a[100:103], v[28:31], v[116:119]
    v_accvgpr_write_b32 a105, v169
    v_mfma_f32_16x16x32_bf16 v[32:35], a[96:99], v[176:179], v[32:35]
    ds_read_b128 v[224:227], v11 offset:12288
    v_mfma_f32_16x16x32_bf16 v[36:39], a[100:103], v[176:179], v[36:39]
    ds_read_b128 v[228:231], v11 offset:13312
    buffer_load_dwordx4 v4, s[12:15], s35 offen offset:2048 sc1 lds
    v_mfma_f32_16x16x32_bf16 v[40:43], a[96:99], v[180:183], v[40:43]
    ds_read_b128 v[232:235], v11 offset:14336
    v_mfma_f32_16x16x32_bf16 v[44:47], a[100:103], v[180:183], v[44:47]
    v_accvgpr_write_b32 a106, v172
    v_mfma_f32_16x16x32_bf16 v[48:51], a[96:99], v[184:187], v[48:51]
    ds_read_b128 v[236:239], v11 offset:15360
    v_mfma_f32_16x16x32_bf16 v[52:55], a[100:103], v[184:187], v[52:55]
    ds_read_b128 v[240:243], v11 offset:16384
    v_accvgpr_write_b32 a107, v173
    v_mfma_f32_16x16x32_bf16 v[56:59], a[96:99], v[188:191], v[56:59]
    ds_read_b128 v[244:247], v11 offset:17408
    v_mfma_f32_16x16x32_bf16 v[60:63], a[100:103], v[188:191], v[60:63]
    v_mfma_f32_16x16x32_bf16 v[64:67], a[96:99], v[192:195], v[64:67]
    v_accvgpr_write_b32 a108, v170
    v_mfma_f32_16x16x32_bf16 v[68:71], a[100:103], v[192:195], v[68:71]
    v_mfma_f32_16x16x32_bf16 v[72:75], a[96:99], v[196:199], v[72:75]
    v_accvgpr_write_b32 a109, v171
    v_mfma_f32_16x16x32_bf16 v[76:79], a[100:103], v[196:199], v[76:79]
    v_mfma_f32_16x16x32_bf16 v[80:83], a[96:99], v[200:203], v[80:83]
    buffer_load_dwordx4 v4, s[12:15], s35 offen offset:3072 sc1 lds
    v_mfma_f32_16x16x32_bf16 v[84:87], a[100:103], v[200:203], v[84:87]
    v_mfma_f32_16x16x32_bf16 v[88:91], a[96:99], v[204:207], v[88:91]
    v_accvgpr_write_b32 a110, v174
    v_mfma_f32_16x16x32_bf16 v[92:95], a[100:103], v[204:207], v[92:95]
    v_mfma_f32_16x16x32_bf16 v[96:99], a[96:99], v[208:211], v[96:99]
    v_accvgpr_write_b32 a111, v175
    v_mfma_f32_16x16x32_bf16 v[100:103], a[100:103], v[208:211], v[100:103]
    s_waitcnt vmcnt(18) lgkmcnt(0)
    v_mfma_f32_16x16x32_bf16 v[104:107], a[104:107], a[104:107], v[104:107]
    ds_read_b128 v[176:179], v11 offset:18432
    v_mfma_f32_16x16x32_bf16 v[112:115], a[104:107], v[28:31], v[112:115]
    ds_read_b128 v[180:183], v11 offset:19456
    v_accvgpr_write_b32 a112, v120
    v_mfma_f32_16x16x32_bf16 v[108:111], a[108:111], a[108:111], v[108:111]
    ds_read_b128 v[184:187], v11 offset:20480
    s_add_u32 m0, s38, 0x2000
    v_mfma_f32_16x16x32_bf16 v[116:119], a[108:111], v[28:31], v[116:119]
    buffer_load_dwordx4 v5, s[12:15], s35 offen offset:0 sc1 lds
    s_add_u32 s35, s35, 36864
    v_mfma_f32_16x16x32_bf16 v[32:35], a[104:107], v[212:215], v[32:35]
    ds_read_b128 v[188:191], v11 offset:21504
    v_mfma_f32_16x16x32_bf16 v[36:39], a[108:111], v[212:215], v[36:39]
    ds_read_b128 v[192:195], v11 offset:22528
    v_accvgpr_write_b32 a113, v121
    v_mfma_f32_16x16x32_bf16 v[40:43], a[104:107], v[216:219], v[40:43]
    ds_read_b128 v[196:199], v11 offset:23552
    v_mfma_f32_16x16x32_bf16 v[44:47], a[108:111], v[216:219], v[44:47]
    v_accvgpr_write_b32 a114, v124
    v_mfma_f32_16x16x32_bf16 v[48:51], a[104:107], v[220:223], v[48:51]
    ds_read_b128 v[200:203], v11 offset:24576
    v_mfma_f32_16x16x32_bf16 v[52:55], a[108:111], v[220:223], v[52:55]
    ds_read_b128 v[204:207], v11 offset:25600
    v_accvgpr_write_b32 a115, v125
    v_mfma_f32_16x16x32_bf16 v[56:59], a[104:107], v[224:227], v[56:59]
    ds_read_b128 v[208:211], v11 offset:26624
    s_mov_b32 m0, s42
    v_mfma_f32_16x16x32_bf16 v[60:63], a[108:111], v[224:227], v[60:63]
    buffer_load_dwordx4 v3, s[44:47], s37 offen sc1 lds
    v_mfma_f32_16x16x32_bf16 v[64:67], a[104:107], v[228:231], v[64:67]
    v_mfma_f32_16x16x32_bf16 v[68:71], a[108:111], v[228:231], v[68:71]
    v_accvgpr_write_b32 a116, v122
    v_mfma_f32_16x16x32_bf16 v[72:75], a[104:107], v[232:235], v[72:75]
    v_mfma_f32_16x16x32_bf16 v[76:79], a[108:111], v[232:235], v[76:79]
    v_accvgpr_write_b32 a117, v123
    v_mfma_f32_16x16x32_bf16 v[80:83], a[104:107], v[236:239], v[80:83]
    s_add_u32 m0, s42, 4096
    v_mfma_f32_16x16x32_bf16 v[84:87], a[108:111], v[236:239], v[84:87]
    buffer_load_dwordx4 v3, s[44:47], s49 offen sc1 lds
    v_mfma_f32_16x16x32_bf16 v[88:91], a[104:107], v[240:243], v[88:91]
    v_mfma_f32_16x16x32_bf16 v[92:95], a[108:111], v[240:243], v[92:95]
    v_accvgpr_write_b32 a118, v126
    v_mfma_f32_16x16x32_bf16 v[96:99], a[104:107], v[244:247], v[96:99]
    v_mfma_f32_16x16x32_bf16 v[100:103], a[108:111], v[244:247], v[100:103]
    v_accvgpr_write_b32 a119, v127
    s_waitcnt vmcnt(17) lgkmcnt(0)
    v_mfma_f32_16x16x32_bf16 v[104:107], a[112:115], a[112:115], v[104:107]
    ds_read_b128 v[212:215], v11 offset:27648
    v_mfma_f32_16x16x32_bf16 v[112:115], a[112:115], v[28:31], v[112:115]
    ds_read_b128 v[216:219], v11 offset:28672
    v_accvgpr_write_b32 a120, v128
    v_mfma_f32_16x16x32_bf16 v[108:111], a[116:119], a[116:119], v[108:111]
    ds_read_b128 v[220:223], v11 offset:29696
    v_mfma_f32_16x16x32_bf16 v[116:119], a[116:119], v[28:31], v[116:119]
    v_mfma_f32_16x16x32_bf16 v[32:35], a[112:115], v[176:179], v[32:35]
    ds_read_b128 v[224:227], v11 offset:30720
    v_accvgpr_write_b32 a121, v129
    v_mfma_f32_16x16x32_bf16 v[36:39], a[116:119], v[176:179], v[36:39]
    ds_read_b128 v[228:231], v11 offset:31744
    v_mfma_f32_16x16x32_bf16 v[40:43], a[112:115], v[180:183], v[40:43]
    ds_read_b128 v[232:235], v11 offset:32768
    v_accvgpr_write_b32 a122, v132
    v_mfma_f32_16x16x32_bf16 v[44:47], a[116:119], v[180:183], v[44:47]
    v_mfma_f32_16x16x32_bf16 v[48:51], a[112:115], v[184:187], v[48:51]
    ds_read_b128 v[236:239], v11 offset:33792
    v_mfma_f32_16x16x32_bf16 v[52:55], a[116:119], v[184:187], v[52:55]
    ds_read_b128 v[240:243], v11 offset:34816
    v_accvgpr_write_b32 a123, v133
    v_mfma_f32_16x16x32_bf16 v[56:59], a[112:115], v[188:191], v[56:59]
    ds_read_b128 v[244:247], v11 offset:35840
    v_mfma_f32_16x16x32_bf16 v[60:63], a[116:119], v[188:191], v[60:63]
    v_mfma_f32_16x16x32_bf16 v[64:67], a[112:115], v[192:195], v[64:67]
    v_accvgpr_write_b32 a124, v130
    v_mfma_f32_16x16x32_bf16 v[68:71], a[116:119], v[192:195], v[68:71]
    v_mfma_f32_16x16x32_bf16 v[72:75], a[112:115], v[196:199], v[72:75]
    v_mfma_f32_16x16x32_bf16 v[76:79], a[116:119], v[196:199], v[76:79]
    v_accvgpr_write_b32 a125, v131
    v_mfma_f32_16x16x32_bf16 v[80:83], a[112:115], v[200:203], v[80:83]
    v_mfma_f32_16x16x32_bf16 v[84:87], a[116:119], v[200:203], v[84:87]
    v_accvgpr_write_b32 a126, v134
    v_mfma_f32_16x16x32_bf16 v[88:91], a[112:115], v[204:207], v[88:91]
    v_mfma_f32_16x16x32_bf16 v[92:95], a[116:119], v[204:207], v[92:95]
    v_mfma_f32_16x16x32_bf16 v[96:99], a[112:115], v[208:211], v[96:99]
    v_accvgpr_write_b32 a127, v135
    v_mfma_f32_16x16x32_bf16 v[100:103], a[116:119], v[208:211], v[100:103]
    s_waitcnt vmcnt(2) lgkmcnt(0)
    s_barrier
    v_mfma_f32_16x16x32_bf16 v[104:107], a[120:123], a[120:123], v[104:107]
    ds_read_b128 v[176:179], v8 offset:0
    v_accvgpr_write_b32 a128, v136
    v_mfma_f32_16x16x32_bf16 v[112:115], a[120:123], v[28:31], v[112:115]
    ds_read_b128 v[180:183], v8 offset:1024
    v_mfma_f32_16x16x32_bf16 v[108:111], a[124:127], a[124:127], v[108:111]
    ds_read_b128 v[184:187], v8 offset:2048
    v_accvgpr_write_b32 a129, v137
    v_mfma_f32_16x16x32_bf16 v[116:119], a[124:127], v[28:31], v[116:119]
    v_accvgpr_write_b32 a130, v140
    v_mfma_f32_16x16x32_bf16 v[32:35], a[120:123], v[212:215], v[32:35]
    ds_read_b128 v[188:191], v8 offset:3072
    v_accvgpr_write_b32 a131, v141
    v_mfma_f32_16x16x32_bf16 v[36:39], a[124:127], v[212:215], v[36:39]
    ds_read_b128 v[192:195], v8 offset:4096
    v_mfma_f32_16x16x32_bf16 v[40:43], a[120:123], v[216:219], v[40:43]
    ds_read_b128 v[196:199], v8 offset:5120
    v_accvgpr_write_b32 a132, v138
    v_mfma_f32_16x16x32_bf16 v[44:47], a[124:127], v[216:219], v[44:47]
    v_accvgpr_write_b32 a133, v139
    v_mfma_f32_16x16x32_bf16 v[48:51], a[120:123], v[220:223], v[48:51]
    ds_read_b128 v[200:203], v8 offset:6144
    v_accvgpr_write_b32 a134, v142
    v_mfma_f32_16x16x32_bf16 v[52:55], a[124:127], v[220:223], v[52:55]
    ds_read_b128 v[204:207], v8 offset:7168
    v_mfma_f32_16x16x32_bf16 v[56:59], a[120:123], v[224:227], v[56:59]
    ds_read_b128 v[208:211], v8 offset:8192
    v_accvgpr_write_b32 a135, v143
    v_mfma_f32_16x16x32_bf16 v[60:63], a[124:127], v[224:227], v[60:63]
    v_accvgpr_write_b32 a136, v144
    v_mfma_f32_16x16x32_bf16 v[64:67], a[120:123], v[228:231], v[64:67]
    v_mfma_f32_16x16x32_bf16 v[68:71], a[124:127], v[228:231], v[68:71]
    v_accvgpr_write_b32 a137, v145
    v_mfma_f32_16x16x32_bf16 v[72:75], a[120:123], v[232:235], v[72:75]
    v_accvgpr_write_b32 a138, v148
    v_mfma_f32_16x16x32_bf16 v[76:79], a[124:127], v[232:235], v[76:79]
    v_accvgpr_write_b32 a139, v149
    v_mfma_f32_16x16x32_bf16 v[80:83], a[120:123], v[236:239], v[80:83]
    v_mfma_f32_16x16x32_bf16 v[84:87], a[124:127], v[236:239], v[84:87]
    v_accvgpr_write_b32 a140, v146
    v_mfma_f32_16x16x32_bf16 v[88:91], a[120:123], v[240:243], v[88:91]
    v_accvgpr_write_b32 a141, v147
    v_mfma_f32_16x16x32_bf16 v[92:95], a[124:127], v[240:243], v[92:95]
    v_accvgpr_write_b32 a142, v150
    v_mfma_f32_16x16x32_bf16 v[96:99], a[120:123], v[244:247], v[96:99]
    v_mfma_f32_16x16x32_bf16 v[100:103], a[124:127], v[244:247], v[100:103]
    v_accvgpr_write_b32 a143, v151
    s_waitcnt vmcnt(0) lgkmcnt(0)
    v_mfma_f32_16x16x32_bf16 v[104:107], a[128:131], a[128:131], v[104:107]
    ds_read_b128 v[212:215], v8 offset:9216
    s_lshl_b32 s43, s34, 7
    v_mfma_f32_16x16x32_bf16 v[112:115], a[128:131], v[28:31], v[112:115]
    ds_read_b128 v[216:219], v8 offset:10240
    s_add_u32 s43, s43, 147456
    v_mfma_f32_16x16x32_bf16 v[108:111], a[132:135], a[132:135], v[108:111]
    ds_read_b128 v[220:223], v8 offset:11264
    s_mov_b32 s40, 0x00f0000f
    v_mfma_f32_16x16x32_bf16 v[116:119], a[132:135], v[28:31], v[116:119]
    v_mfma_f32_16x16x32_bf16 v[104:107], a[136:139], a[136:139], v[104:107]
    ds_read_b128 v[224:227], v8 offset:12288
    s_mov_b32 s41, 0xf0000f00
    v_mfma_f32_16x16x32_bf16 v[112:115], a[136:139], v[28:31], v[112:115]
    ds_read_b128 v[228:231], v8 offset:13312
    v_lshrrev_b32 v7, 2, v6
    v_mfma_f32_16x16x32_bf16 v[108:111], a[140:143], a[140:143], v[108:111]
    ds_read_b128 v[232:235], v8 offset:14336
    v_lshlrev_b32 v7, 3, v7
    v_mfma_f32_16x16x32_bf16 v[116:119], a[140:143], v[28:31], v[116:119]
    v_and_b32 v22, 3, v6
    v_mfma_f32_16x16x32_bf16 v[32:35], a[128:131], v[176:179], v[32:35]
    ds_read_b128 v[236:239], v8 offset:15360
    v_add_u32 v7, v7, v22
    v_mfma_f32_16x16x32_bf16 v[36:39], a[132:135], v[176:179], v[36:39]
    ds_read_b128 v[240:243], v8 offset:16384
    v_mfma_f32_16x16x32_bf16 v[40:43], a[128:131], v[180:183], v[40:43]
    ds_read_b128 v[244:247], v8 offset:17408
    v_lshl_add_u32 v7, v7, 2, s43
    v_mfma_f32_16x16x32_bf16 v[44:47], a[132:135], v[180:183], v[44:47]
    v_mov_b32 v22, 156160
    v_mfma_f32_16x16x32_bf16 v[48:51], a[128:131], v[184:187], v[48:51]
    v_cndmask_b32 v22, v22, v7, s[40:41]
    v_mfma_f32_16x16x32_bf16 v[52:55], a[132:135], v[184:187], v[52:55]
    v_lshrrev_b32 v23, 4, v2
    v_mfma_f32_16x16x32_bf16 v[56:59], a[128:131], v[188:191], v[56:59]
    v_lshl_add_u32 v23, v23, 5, s43
    v_mfma_f32_16x16x32_bf16 v[60:63], a[132:135], v[188:191], v[60:63]
    ds_read_b32 v12, v21 offset:4096
    v_mfma_f32_16x16x32_bf16 v[64:67], a[128:131], v[192:195], v[64:67]
    v_mfma_f32_16x16x32_bf16 v[68:71], a[132:135], v[192:195], v[68:71]
    ds_read_b32 v13, v21 offset:4160
    v_mfma_f32_16x16x32_bf16 v[72:75], a[128:131], v[196:199], v[72:75]
    ds_read_b32 v14, v21 offset:4224
    v_mfma_f32_16x16x32_bf16 v[76:79], a[132:135], v[196:199], v[76:79]
    ds_read_b32 v15, v21 offset:4288
    v_mfma_f32_16x16x32_bf16 v[80:83], a[128:131], v[200:203], v[80:83]
    ds_read_b32 v16, v21 offset:4352
    v_mfma_f32_16x16x32_bf16 v[84:87], a[132:135], v[200:203], v[84:87]
    ds_read_b32 v17, v21 offset:4416
    v_mfma_f32_16x16x32_bf16 v[88:91], a[128:131], v[204:207], v[88:91]
    v_mfma_f32_16x16x32_bf16 v[92:95], a[132:135], v[204:207], v[92:95]
    ds_read_b32 v18, v21 offset:4480
    v_mfma_f32_16x16x32_bf16 v[96:99], a[128:131], v[208:211], v[96:99]
    ds_read_b32 v19, v21 offset:4544
    v_mfma_f32_16x16x32_bf16 v[100:103], a[132:135], v[208:211], v[100:103]
    ds_read_b32 v20, v21 offset:4608
    s_waitcnt lgkmcnt(0)
    v_mfma_f32_16x16x32_bf16 v[32:35], a[136:139], v[212:215], v[32:35]
    ds_read_b128 v[176:179], v8 offset:18432
    s_mov_b32 s40, 0x22222222
    s_mov_b32 s41, 0x22222222
    s_mov_b32 s48, 0x44444444
    s_mov_b32 s49, 0x44444444
    s_mov_b32 s50, 0x88888888
    s_mov_b32 s51, 0x88888888
    v_cndmask_b32 v104, v104, v105, s[40:41]
    v_mfma_f32_16x16x32_bf16 v[36:39], a[140:143], v[212:215], v[36:39]
    ds_read_b128 v[180:183], v8 offset:19456
    v_cndmask_b32 v108, v108, v109, s[40:41]
    v_mfma_f32_16x16x32_bf16 v[40:43], a[136:139], v[216:219], v[40:43]
    ds_read_b128 v[184:187], v8 offset:20480
    v_cndmask_b32 v112, v112, v113, s[40:41]
    v_mfma_f32_16x16x32_bf16 v[44:47], a[140:143], v[216:219], v[44:47]
    v_cndmask_b32 v116, v116, v117, s[40:41]
    v_cndmask_b32 v104, v104, v106, s[48:49]
    v_mfma_f32_16x16x32_bf16 v[48:51], a[136:139], v[220:223], v[48:51]
    ds_read_b128 v[188:191], v8 offset:21504
    v_cndmask_b32 v108, v108, v110, s[48:49]
    v_mfma_f32_16x16x32_bf16 v[52:55], a[140:143], v[220:223], v[52:55]
    ds_read_b128 v[192:195], v8 offset:22528
    v_cndmask_b32 v112, v112, v114, s[48:49]
    v_mfma_f32_16x16x32_bf16 v[56:59], a[136:139], v[224:227], v[56:59]
    ds_read_b128 v[196:199], v8 offset:23552
    v_cndmask_b32 v116, v116, v118, s[48:49]
    v_mfma_f32_16x16x32_bf16 v[60:63], a[140:143], v[224:227], v[60:63]
    v_cndmask_b32 v104, v104, v107, s[50:51]
    v_cndmask_b32 v108, v108, v111, s[50:51]
    v_mfma_f32_16x16x32_bf16 v[64:67], a[136:139], v[228:231], v[64:67]
    ds_read_b128 v[200:203], v8 offset:24576
    v_cndmask_b32 v112, v112, v115, s[50:51]
    v_mfma_f32_16x16x32_bf16 v[68:71], a[140:143], v[228:231], v[68:71]
    ds_read_b128 v[204:207], v8 offset:25600
    v_cndmask_b32 v116, v116, v119, s[50:51]
    v_mfma_f32_16x16x32_bf16 v[72:75], a[136:139], v[232:235], v[72:75]
    ds_read_b128 v[208:211], v8 offset:26624
    v_mul_f32 v104, 0x3ae38e39, v104
    v_mfma_f32_16x16x32_bf16 v[76:79], a[140:143], v[232:235], v[76:79]
    v_mul_f32 v112, 0x3ae38e39, v112
    v_mul_f32 v108, 0x3ae38e39, v108
    v_mfma_f32_16x16x32_bf16 v[80:83], a[136:139], v[236:239], v[80:83]
    v_mul_f32 v116, 0x3ae38e39, v116
    v_fma_f32 v104, -v112, v112, v104
    v_mfma_f32_16x16x32_bf16 v[84:87], a[140:143], v[236:239], v[84:87]
    v_fma_f32 v108, -v116, v116, v108
    v_max_f32 v104, 0, v104
    v_mfma_f32_16x16x32_bf16 v[88:91], a[136:139], v[240:243], v[88:91]
    v_max_f32 v108, 0, v108
    v_add_f32 v104, 0x3727c5ac, v104
    v_mfma_f32_16x16x32_bf16 v[92:95], a[140:143], v[240:243], v[92:95]
    v_add_f32 v108, 0x3727c5ac, v108
    v_mfma_f32_16x16x32_bf16 v[96:99], a[136:139], v[244:247], v[96:99]
    v_rsq_f32 v104, v104
    v_mfma_f32_16x16x32_bf16 v[100:103], a[140:143], v[244:247], v[100:103]
    v_rsq_f32 v108, v108
    s_nop 0
    ds_write_b32 v22, v104
    ds_write_b32 v22, v108 offset:16
    ds_read_b128 v[248:251], v23
    ds_read_b128 v[252:255], v23 offset:16
    ds_read_b32 v22, v7
    ds_read_b32 v23, v7 offset:16
    s_waitcnt lgkmcnt(0)
    v_pk_fma_f32 v[32:33], v[32:33], v[248:249], v[12:13] op_sel_hi:[1,1,0]
    v_pk_fma_f32 v[34:35], v[34:35], v[250:251], v[12:13] op_sel_hi:[1,1,0]
    v_pk_mul_f32 v[104:105], v[32:33], v[32:33]
    v_pk_mul_f32 v[106:107], v[34:35], v[34:35]
    v_pk_fma_f32 v[104:105], v[104:105], v[26:27], v[24:25]
    v_pk_fma_f32 v[106:107], v[106:107], v[26:27], v[24:25]
    v_pk_mul_f32 v[104:105], v[104:105], v[32:33]
    v_pk_mul_f32 v[106:107], v[106:107], v[34:35]
    v_exp_f32 v104, v104
    v_exp_f32 v105, v105
    v_exp_f32 v106, v106
    s_add_u32 m0, s38, 0x9000
    s_nop 0
    buffer_load_dwordx4 v3, s[12:15], s35 offen offset:0 sc1 lds
    v_exp_f32 v107, v107
    v_pk_add_f32 v[104:105], v[104:105], 1.0 op_sel_hi:[1,0]
    v_pk_add_f32 v[106:107], v[106:107], 1.0 op_sel_hi:[1,0]
    v_rcp_f32 v104, v104
    v_rcp_f32 v105, v105
    v_rcp_f32 v106, v106
    v_rcp_f32 v107, v107
    v_pk_mul_f32 v[32:33], v[32:33], v[104:105]
    v_pk_mul_f32 v[34:35], v[34:35], v[106:107]
    v_pk_mul_f32 v[120:121], v[32:33], v[32:33]
    v_pk_mul_f32 v[122:123], v[34:35], v[34:35]
    buffer_load_dwordx4 v3, s[12:15], s35 offen offset:1024 sc1 lds
    v_pk_fma_f32 v[36:37], v[36:37], v[252:253], v[12:13] op_sel_hi:[1,1,0]
    v_pk_fma_f32 v[38:39], v[38:39], v[254:255], v[12:13] op_sel_hi:[1,1,0]
    v_pk_mul_f32 v[108:109], v[36:37], v[36:37]
    v_pk_mul_f32 v[110:111], v[38:39], v[38:39]
    v_pk_fma_f32 v[108:109], v[108:109], v[26:27], v[24:25]
    v_pk_fma_f32 v[110:111], v[110:111], v[26:27], v[24:25]
    v_pk_mul_f32 v[108:109], v[108:109], v[36:37]
    v_pk_mul_f32 v[110:111], v[110:111], v[38:39]
    v_exp_f32 v108, v108
    v_exp_f32 v109, v109
    v_exp_f32 v110, v110
    buffer_load_dwordx4 v3, s[12:15], s35 offen offset:2048 sc1 lds
    v_exp_f32 v111, v111
    v_pk_add_f32 v[108:109], v[108:109], 1.0 op_sel_hi:[1,0]
    v_pk_add_f32 v[110:111], v[110:111], 1.0 op_sel_hi:[1,0]
    v_rcp_f32 v108, v108
    v_rcp_f32 v109, v109
    v_rcp_f32 v110, v110
    v_rcp_f32 v111, v111
    v_pk_mul_f32 v[36:37], v[36:37], v[108:109]
    v_pk_mul_f32 v[38:39], v[38:39], v[110:111]
    v_pk_mul_f32 v[124:125], v[36:37], v[36:37]
    v_pk_mul_f32 v[126:127], v[38:39], v[38:39]
    v_add_u32 v1, s55, v3
    s_add_u32 s55, s55, 1024
    buffer_load_dwordx4 a[144:147], v1, s[76:79], s81 offen sc1
    v_pk_fma_f32 v[40:41], v[40:41], v[248:249], v[12:13] op_sel:[0,0,1] op_sel_hi:[1,1,1]
    v_pk_fma_f32 v[42:43], v[42:43], v[250:251], v[12:13] op_sel:[0,0,1] op_sel_hi:[1,1,1]
    v_pk_mul_f32 v[104:105], v[40:41], v[40:41]
    v_pk_mul_f32 v[106:107], v[42:43], v[42:43]
    v_pk_fma_f32 v[104:105], v[104:105], v[26:27], v[24:25]
    v_pk_fma_f32 v[106:107], v[106:107], v[26:27], v[24:25]
    v_pk_mul_f32 v[104:105], v[104:105], v[40:41]
    v_pk_mul_f32 v[106:107], v[106:107], v[42:43]
    v_exp_f32 v104, v104
    v_exp_f32 v105, v105
    v_exp_f32 v106, v106
    buffer_load_dwordx4 v3, s[12:15], s35 offen offset:3072 sc1 lds
    v_exp_f32 v107, v107
    v_pk_add_f32 v[104:105], v[104:105], 1.0 op_sel_hi:[1,0]
    v_pk_add_f32 v[106:107], v[106:107], 1.0 op_sel_hi:[1,0]
    v_rcp_f32 v104, v104
    v_rcp_f32 v105, v105
    v_rcp_f32 v106, v106
    v_rcp_f32 v107, v107
    v_pk_mul_f32 v[40:41], v[40:41], v[104:105]
    v_pk_mul_f32 v[42:43], v[42:43], v[106:107]
    v_pk_fma_f32 v[120:121], v[40:41], v[40:41], v[120:121]
    v_pk_add_f32 v[112:113], v[40:41], v[32:33]
    s_add_u32 m0, s38, 0xa000
    s_nop 0
    buffer_load_dwordx4 v4, s[12:15], s35 offen offset:0 sc1 lds
    v_pk_fma_f32 v[122:123], v[42:43], v[42:43], v[122:123]
    v_pk_add_f32 v[114:115], v[42:43], v[34:35]
    v_pk_fma_f32 v[44:45], v[44:45], v[252:253], v[12:13] op_sel:[0,0,1] op_sel_hi:[1,1,1]
    v_pk_fma_f32 v[46:47], v[46:47], v[254:255], v[12:13] op_sel:[0,0,1] op_sel_hi:[1,1,1]
    v_pk_mul_f32 v[108:109], v[44:45], v[44:45]
    v_pk_mul_f32 v[110:111], v[46:47], v[46:47]
    v_pk_fma_f32 v[108:109], v[108:109], v[26:27], v[24:25]
    v_pk_fma_f32 v[110:111], v[110:111], v[26:27], v[24:25]
    v_pk_mul_f32 v[108:109], v[108:109], v[44:45]
    v_pk_mul_f32 v[110:111], v[110:111], v[46:47]
    v_exp_f32 v108, v108
    buffer_load_dwordx4 v4, s[12:15], s35 offen offset:1024 sc1 lds
    v_exp_f32 v109, v109
    v_exp_f32 v110, v110
    v_exp_f32 v111, v111
    v_pk_add_f32 v[108:109], v[108:109], 1.0 op_sel_hi:[1,0]
    v_pk_add_f32 v[110:111], v[110:111], 1.0 op_sel_hi:[1,0]
    v_rcp_f32 v108, v108
    v_rcp_f32 v109, v109
    v_rcp_f32 v110, v110
    v_rcp_f32 v111, v111
    v_pk_mul_f32 v[44:45], v[44:45], v[108:109]
    v_pk_mul_f32 v[46:47], v[46:47], v[110:111]
    buffer_load_dwordx4 a[148:151], v1, s[76:79], s82 offen sc1
    v_pk_fma_f32 v[124:125], v[44:45], v[44:45], v[124:125]
    v_pk_add_f32 v[116:117], v[44:45], v[36:37]
    v_pk_fma_f32 v[126:127], v[46:47], v[46:47], v[126:127]
    v_pk_add_f32 v[118:119], v[46:47], v[38:39]
    v_pk_fma_f32 v[48:49], v[48:49], v[248:249], v[14:15] op_sel_hi:[1,1,0]
    v_pk_fma_f32 v[50:51], v[50:51], v[250:251], v[14:15] op_sel_hi:[1,1,0]
    v_pk_mul_f32 v[104:105], v[48:49], v[48:49]
    v_pk_mul_f32 v[106:107], v[50:51], v[50:51]
    v_pk_fma_f32 v[104:105], v[104:105], v[26:27], v[24:25]
    v_pk_fma_f32 v[106:107], v[106:107], v[26:27], v[24:25]
    v_pk_mul_f32 v[104:105], v[104:105], v[48:49]
    buffer_load_dwordx4 v4, s[12:15], s35 offen offset:2048 sc1 lds
    v_pk_mul_f32 v[106:107], v[106:107], v[50:51]
    v_exp_f32 v104, v104
    v_exp_f32 v105, v105
    v_exp_f32 v106, v106
    v_exp_f32 v107, v107
    v_pk_add_f32 v[104:105], v[104:105], 1.0 op_sel_hi:[1,0]
    v_pk_add_f32 v[106:107], v[106:107], 1.0 op_sel_hi:[1,0]
    v_rcp_f32 v104, v104
    v_rcp_f32 v105, v105
    v_rcp_f32 v106, v106
    v_rcp_f32 v107, v107
    buffer_load_dwordx4 v4, s[12:15], s35 offen offset:3072 sc1 lds
    v_pk_mul_f32 v[48:49], v[48:49], v[104:105]
    v_pk_mul_f32 v[50:51], v[50:51], v[106:107]
    v_pk_fma_f32 v[120:121], v[48:49], v[48:49], v[120:121]
    v_pk_add_f32 v[112:113], v[48:49], v[112:113]
    v_pk_fma_f32 v[122:123], v[50:51], v[50:51], v[122:123]
    v_pk_add_f32 v[114:115], v[50:51], v[114:115]
    v_pk_fma_f32 v[52:53], v[52:53], v[252:253], v[14:15] op_sel_hi:[1,1,0]
    v_pk_fma_f32 v[54:55], v[54:55], v[254:255], v[14:15] op_sel_hi:[1,1,0]
    v_pk_mul_f32 v[108:109], v[52:53], v[52:53]
    v_pk_mul_f32 v[110:111], v[54:55], v[54:55]
    v_pk_fma_f32 v[108:109], v[108:109], v[26:27], v[24:25]
    s_add_u32 m0, s38, 0xb000
    s_nop 0
    buffer_load_dwordx4 v5, s[12:15], s35 offen offset:0 sc1 lds
    s_add_u32 s35, s35, 36864
    v_pk_fma_f32 v[110:111], v[110:111], v[26:27], v[24:25]
    v_pk_mul_f32 v[108:109], v[108:109], v[52:53]
    v_pk_mul_f32 v[110:111], v[110:111], v[54:55]
    v_exp_f32 v108, v108
    v_exp_f32 v109, v109
    v_exp_f32 v110, v110
    v_exp_f32 v111, v111
    v_pk_add_f32 v[108:109], v[108:109], 1.0 op_sel_hi:[1,0]
    v_pk_add_f32 v[110:111], v[110:111], 1.0 op_sel_hi:[1,0]
    v_rcp_f32 v108, v108
    v_rcp_f32 v109, v109
    buffer_load_dwordx4 a[152:155], v1, s[76:79], s83 offen sc1
    v_rcp_f32 v110, v110
    v_rcp_f32 v111, v111
    v_pk_mul_f32 v[52:53], v[52:53], v[108:109]
    v_pk_mul_f32 v[54:55], v[54:55], v[110:111]
    v_pk_fma_f32 v[124:125], v[52:53], v[52:53], v[124:125]
    v_pk_add_f32 v[116:117], v[52:53], v[116:117]
    v_pk_fma_f32 v[126:127], v[54:55], v[54:55], v[126:127]
    v_pk_add_f32 v[118:119], v[54:55], v[118:119]
    v_pk_fma_f32 v[56:57], v[56:57], v[248:249], v[14:15] op_sel:[0,0,1] op_sel_hi:[1,1,1]
    v_pk_fma_f32 v[58:59], v[58:59], v[250:251], v[14:15] op_sel:[0,0,1] op_sel_hi:[1,1,1]
    v_pk_mul_f32 v[104:105], v[56:57], v[56:57]
    s_add_u32 m0, s38, 0x12000
    s_nop 0
    buffer_load_dwordx4 v3, s[12:15], s35 offen offset:0 sc1 lds
    v_pk_mul_f32 v[106:107], v[58:59], v[58:59]
    v_pk_fma_f32 v[104:105], v[104:105], v[26:27], v[24:25]
    v_pk_fma_f32 v[106:107], v[106:107], v[26:27], v[24:25]
    v_pk_mul_f32 v[104:105], v[104:105], v[56:57]
    v_pk_mul_f32 v[106:107], v[106:107], v[58:59]
    v_exp_f32 v104, v104
    v_exp_f32 v105, v105
    v_exp_f32 v106, v106
    v_exp_f32 v107, v107
    v_pk_add_f32 v[104:105], v[104:105], 1.0 op_sel_hi:[1,0]
    v_pk_add_f32 v[106:107], v[106:107], 1.0 op_sel_hi:[1,0]
    buffer_load_dwordx4 v3, s[12:15], s35 offen offset:1024 sc1 lds
    v_rcp_f32 v104, v104
    v_rcp_f32 v105, v105
    v_rcp_f32 v106, v106
    v_rcp_f32 v107, v107
    v_pk_mul_f32 v[56:57], v[56:57], v[104:105]
    v_pk_mul_f32 v[58:59], v[58:59], v[106:107]
    v_pk_fma_f32 v[120:121], v[56:57], v[56:57], v[120:121]
    v_pk_add_f32 v[112:113], v[56:57], v[112:113]
    v_pk_fma_f32 v[122:123], v[58:59], v[58:59], v[122:123]
    v_pk_add_f32 v[114:115], v[58:59], v[114:115]
    v_pk_fma_f32 v[60:61], v[60:61], v[252:253], v[14:15] op_sel:[0,0,1] op_sel_hi:[1,1,1]
    buffer_load_dwordx4 v3, s[12:15], s35 offen offset:2048 sc1 lds
    v_pk_fma_f32 v[62:63], v[62:63], v[254:255], v[14:15] op_sel:[0,0,1] op_sel_hi:[1,1,1]
    v_pk_mul_f32 v[108:109], v[60:61], v[60:61]
    v_pk_mul_f32 v[110:111], v[62:63], v[62:63]
    v_pk_fma_f32 v[108:109], v[108:109], v[26:27], v[24:25]
    v_pk_fma_f32 v[110:111], v[110:111], v[26:27], v[24:25]
    v_pk_mul_f32 v[108:109], v[108:109], v[60:61]
    v_pk_mul_f32 v[110:111], v[110:111], v[62:63]
    v_exp_f32 v108, v108
    v_exp_f32 v109, v109
    v_exp_f32 v110, v110
    v_exp_f32 v111, v111
    buffer_load_dwordx4 a[156:159], v1, s[76:79], s84 offen sc1
    v_pk_add_f32 v[108:109], v[108:109], 1.0 op_sel_hi:[1,0]
    v_pk_add_f32 v[110:111], v[110:111], 1.0 op_sel_hi:[1,0]
    v_rcp_f32 v108, v108
    v_rcp_f32 v109, v109
    v_rcp_f32 v110, v110
    v_rcp_f32 v111, v111
    v_pk_mul_f32 v[60:61], v[60:61], v[108:109]
    v_pk_mul_f32 v[62:63], v[62:63], v[110:111]
    v_pk_fma_f32 v[124:125], v[60:61], v[60:61], v[124:125]
    v_pk_add_f32 v[116:117], v[60:61], v[116:117]
    v_pk_fma_f32 v[126:127], v[62:63], v[62:63], v[126:127]
    buffer_load_dwordx4 v3, s[12:15], s35 offen offset:3072 sc1 lds
    v_pk_add_f32 v[118:119], v[62:63], v[118:119]
    v_pk_fma_f32 v[64:65], v[64:65], v[248:249], v[16:17] op_sel_hi:[1,1,0]
    v_pk_fma_f32 v[66:67], v[66:67], v[250:251], v[16:17] op_sel_hi:[1,1,0]
    v_pk_mul_f32 v[104:105], v[64:65], v[64:65]
    v_pk_mul_f32 v[106:107], v[66:67], v[66:67]
    v_pk_fma_f32 v[104:105], v[104:105], v[26:27], v[24:25]
    v_pk_fma_f32 v[106:107], v[106:107], v[26:27], v[24:25]
    v_pk_mul_f32 v[104:105], v[104:105], v[64:65]
    v_pk_mul_f32 v[106:107], v[106:107], v[66:67]
    v_exp_f32 v104, v104
    v_exp_f32 v105, v105
    s_add_u32 m0, s38, 0x13000
    s_nop 0
    buffer_load_dwordx4 v4, s[12:15], s35 offen offset:0 sc1 lds
    v_exp_f32 v106, v106
    v_exp_f32 v107, v107
    v_pk_add_f32 v[104:105], v[104:105], 1.0 op_sel_hi:[1,0]
    v_pk_add_f32 v[106:107], v[106:107], 1.0 op_sel_hi:[1,0]
    v_rcp_f32 v104, v104
    v_rcp_f32 v105, v105
    v_rcp_f32 v106, v106
    v_rcp_f32 v107, v107
    v_pk_mul_f32 v[64:65], v[64:65], v[104:105]
    v_pk_mul_f32 v[66:67], v[66:67], v[106:107]
    v_pk_fma_f32 v[120:121], v[64:65], v[64:65], v[120:121]
    buffer_load_dwordx4 v4, s[12:15], s35 offen offset:1024 sc1 lds
    v_pk_add_f32 v[112:113], v[64:65], v[112:113]
    v_pk_fma_f32 v[122:123], v[66:67], v[66:67], v[122:123]
    v_pk_add_f32 v[114:115], v[66:67], v[114:115]
    v_pk_fma_f32 v[68:69], v[68:69], v[252:253], v[16:17] op_sel_hi:[1,1,0]
    v_pk_fma_f32 v[70:71], v[70:71], v[254:255], v[16:17] op_sel_hi:[1,1,0]
    v_pk_mul_f32 v[108:109], v[68:69], v[68:69]
    v_pk_mul_f32 v[110:111], v[70:71], v[70:71]
    v_pk_fma_f32 v[108:109], v[108:109], v[26:27], v[24:25]
    v_pk_fma_f32 v[110:111], v[110:111], v[26:27], v[24:25]
    v_pk_mul_f32 v[108:109], v[108:109], v[68:69]
    v_pk_mul_f32 v[110:111], v[110:111], v[70:71]
    buffer_load_dwordx4 a[160:163], v1, s[76:79], s85 offen sc1
    v_exp_f32 v108, v108
    v_exp_f32 v109, v109
    v_exp_f32 v110, v110
    v_exp_f32 v111, v111
    v_pk_add_f32 v[108:109], v[108:109], 1.0 op_sel_hi:[1,0]
    v_pk_add_f32 v[110:111], v[110:111], 1.0 op_sel_hi:[1,0]
    v_rcp_f32 v108, v108
    v_rcp_f32 v109, v109
    v_rcp_f32 v110, v110
    v_rcp_f32 v111, v111
    v_pk_mul_f32 v[68:69], v[68:69], v[108:109]
    buffer_load_dwordx4 v4, s[12:15], s35 offen offset:2048 sc1 lds
    v_pk_mul_f32 v[70:71], v[70:71], v[110:111]
    v_pk_fma_f32 v[124:125], v[68:69], v[68:69], v[124:125]
    v_pk_add_f32 v[116:117], v[68:69], v[116:117]
    v_pk_fma_f32 v[126:127], v[70:71], v[70:71], v[126:127]
    v_pk_add_f32 v[118:119], v[70:71], v[118:119]
    v_pk_fma_f32 v[72:73], v[72:73], v[248:249], v[16:17] op_sel:[0,0,1] op_sel_hi:[1,1,1]
    v_pk_fma_f32 v[74:75], v[74:75], v[250:251], v[16:17] op_sel:[0,0,1] op_sel_hi:[1,1,1]
    v_pk_mul_f32 v[104:105], v[72:73], v[72:73]
    v_pk_mul_f32 v[106:107], v[74:75], v[74:75]
    v_pk_fma_f32 v[104:105], v[104:105], v[26:27], v[24:25]
    v_pk_fma_f32 v[106:107], v[106:107], v[26:27], v[24:25]
    buffer_load_dwordx4 v4, s[12:15], s35 offen offset:3072 sc1 lds
    v_pk_mul_f32 v[104:105], v[104:105], v[72:73]
    v_pk_mul_f32 v[106:107], v[106:107], v[74:75]
    v_exp_f32 v104, v104
    v_exp_f32 v105, v105
    v_exp_f32 v106, v106
    v_exp_f32 v107, v107
    v_pk_add_f32 v[104:105], v[104:105], 1.0 op_sel_hi:[1,0]
    v_pk_add_f32 v[106:107], v[106:107], 1.0 op_sel_hi:[1,0]
    v_rcp_f32 v104, v104
    v_rcp_f32 v105, v105
    v_rcp_f32 v106, v106
    s_add_u32 m0, s38, 0x14000
    s_nop 0
    buffer_load_dwordx4 v5, s[12:15], s35 offen offset:0 sc1 lds
    s_add_u32 s35, s35, 36864
    v_rcp_f32 v107, v107
    v_pk_mul_f32 v[72:73], v[72:73], v[104:105]
    v_pk_mul_f32 v[74:75], v[74:75], v[106:107]
    v_pk_fma_f32 v[120:121], v[72:73], v[72:73], v[120:121]
    v_pk_add_f32 v[112:113], v[72:73], v[112:113]
    v_pk_fma_f32 v[122:123], v[74:75], v[74:75], v[122:123]
    v_pk_add_f32 v[114:115], v[74:75], v[114:115]
    v_pk_fma_f32 v[76:77], v[76:77], v[252:253], v[16:17] op_sel:[0,0,1] op_sel_hi:[1,1,1]
    v_pk_fma_f32 v[78:79], v[78:79], v[254:255], v[16:17] op_sel:[0,0,1] op_sel_hi:[1,1,1]
    v_pk_mul_f32 v[108:109], v[76:77], v[76:77]
    v_pk_mul_f32 v[110:111], v[78:79], v[78:79]
    v_add_u32 v1, s55, v3
    s_add_u32 s55, s55, 1024
    buffer_load_dwordx4 a[164:167], v1, s[76:79], s81 offen sc1
    v_pk_fma_f32 v[108:109], v[108:109], v[26:27], v[24:25]
    v_pk_fma_f32 v[110:111], v[110:111], v[26:27], v[24:25]
    v_pk_mul_f32 v[108:109], v[108:109], v[76:77]
    v_pk_mul_f32 v[110:111], v[110:111], v[78:79]
    v_exp_f32 v108, v108
    v_exp_f32 v109, v109
    v_exp_f32 v110, v110
    v_exp_f32 v111, v111
    v_pk_add_f32 v[108:109], v[108:109], 1.0 op_sel_hi:[1,0]
    v_pk_add_f32 v[110:111], v[110:111], 1.0 op_sel_hi:[1,0]
    v_rcp_f32 v108, v108
    s_add_u32 m0, s38, 0x1b000
    s_nop 0
    buffer_load_dwordx4 v3, s[12:15], s35 offen offset:0 sc1 lds
    v_rcp_f32 v109, v109
    v_rcp_f32 v110, v110
    v_rcp_f32 v111, v111
    v_pk_mul_f32 v[76:77], v[76:77], v[108:109]
    v_pk_mul_f32 v[78:79], v[78:79], v[110:111]
    v_pk_fma_f32 v[124:125], v[76:77], v[76:77], v[124:125]
    v_pk_add_f32 v[116:117], v[76:77], v[116:117]
    v_pk_fma_f32 v[126:127], v[78:79], v[78:79], v[126:127]
    v_pk_add_f32 v[118:119], v[78:79], v[118:119]
    v_pk_fma_f32 v[80:81], v[80:81], v[248:249], v[18:19] op_sel_hi:[1,1,0]
    v_pk_fma_f32 v[82:83], v[82:83], v[250:251], v[18:19] op_sel_hi:[1,1,0]
    buffer_load_dwordx4 v3, s[12:15], s35 offen offset:1024 sc1 lds
    v_pk_mul_f32 v[104:105], v[80:81], v[80:81]
    v_pk_mul_f32 v[106:107], v[82:83], v[82:83]
    v_pk_fma_f32 v[104:105], v[104:105], v[26:27], v[24:25]
    v_pk_fma_f32 v[106:107], v[106:107], v[26:27], v[24:25]
    v_pk_mul_f32 v[104:105], v[104:105], v[80:81]
    v_pk_mul_f32 v[106:107], v[106:107], v[82:83]
    v_exp_f32 v104, v104
    v_exp_f32 v105, v105
    v_exp_f32 v106, v106
    v_exp_f32 v107, v107
    v_pk_add_f32 v[104:105], v[104:105], 1.0 op_sel_hi:[1,0]
    buffer_load_dwordx4 v3, s[12:15], s35 offen offset:2048 sc1 lds
    v_pk_add_f32 v[106:107], v[106:107], 1.0 op_sel_hi:[1,0]
    v_rcp_f32 v104, v104
    v_rcp_f32 v105, v105
    v_rcp_f32 v106, v106
    v_rcp_f32 v107, v107
    v_pk_mul_f32 v[80:81], v[80:81], v[104:105]
    v_pk_mul_f32 v[82:83], v[82:83], v[106:107]
    v_pk_fma_f32 v[120:121], v[80:81], v[80:81], v[120:121]
    v_pk_add_f32 v[112:113], v[80:81], v[112:113]
    v_pk_fma_f32 v[122:123], v[82:83], v[82:83], v[122:123]
    v_pk_add_f32 v[114:115], v[82:83], v[114:115]
    buffer_load_dwordx4 a[168:171], v1, s[76:79], s82 offen sc1
    v_pk_fma_f32 v[84:85], v[84:85], v[252:253], v[18:19] op_sel_hi:[1,1,0]
    v_pk_fma_f32 v[86:87], v[86:87], v[254:255], v[18:19] op_sel_hi:[1,1,0]
    v_pk_mul_f32 v[108:109], v[84:85], v[84:85]
    v_pk_mul_f32 v[110:111], v[86:87], v[86:87]
    v_pk_fma_f32 v[108:109], v[108:109], v[26:27], v[24:25]
    v_pk_fma_f32 v[110:111], v[110:111], v[26:27], v[24:25]
    v_pk_mul_f32 v[108:109], v[108:109], v[84:85]
    v_pk_mul_f32 v[110:111], v[110:111], v[86:87]
    v_exp_f32 v108, v108
    v_exp_f32 v109, v109
    v_exp_f32 v110, v110
    buffer_load_dwordx4 v3, s[12:15], s35 offen offset:3072 sc1 lds
    v_exp_f32 v111, v111
    v_pk_add_f32 v[108:109], v[108:109], 1.0 op_sel_hi:[1,0]
    v_pk_add_f32 v[110:111], v[110:111], 1.0 op_sel_hi:[1,0]
    v_rcp_f32 v108, v108
    v_rcp_f32 v109, v109
    v_rcp_f32 v110, v110
    v_rcp_f32 v111, v111
    v_pk_mul_f32 v[84:85], v[84:85], v[108:109]
    v_pk_mul_f32 v[86:87], v[86:87], v[110:111]
    v_pk_fma_f32 v[124:125], v[84:85], v[84:85], v[124:125]
    v_pk_add_f32 v[116:117], v[84:85], v[116:117]
    s_add_u32 m0, s38, 0x1c000
    s_nop 0
    buffer_load_dwordx4 v4, s[12:15], s35 offen offset:0 sc1 lds
    v_pk_fma_f32 v[126:127], v[86:87], v[86:87], v[126:127]
    v_pk_add_f32 v[118:119], v[86:87], v[118:119]
    v_pk_fma_f32 v[88:89], v[88:89], v[248:249], v[18:19] op_sel:[0,0,1] op_sel_hi:[1,1,1]
    v_pk_fma_f32 v[90:91], v[90:91], v[250:251], v[18:19] op_sel:[0,0,1] op_sel_hi:[1,1,1]
    v_pk_mul_f32 v[104:105], v[88:89], v[88:89]
    v_pk_mul_f32 v[106:107], v[90:91], v[90:91]
    v_pk_fma_f32 v[104:105], v[104:105], v[26:27], v[24:25]
    v_pk_fma_f32 v[106:107], v[106:107], v[26:27], v[24:25]
    v_pk_mul_f32 v[104:105], v[104:105], v[88:89]
    v_pk_mul_f32 v[106:107], v[106:107], v[90:91]
    v_exp_f32 v104, v104
    buffer_load_dwordx4 v4, s[12:15], s35 offen offset:1024 sc1 lds
    v_exp_f32 v105, v105
    v_exp_f32 v106, v106
    v_exp_f32 v107, v107
    v_pk_add_f32 v[104:105], v[104:105], 1.0 op_sel_hi:[1,0]
    v_pk_add_f32 v[106:107], v[106:107], 1.0 op_sel_hi:[1,0]
    v_rcp_f32 v104, v104
    v_rcp_f32 v105, v105
    v_rcp_f32 v106, v106
    v_rcp_f32 v107, v107
    v_pk_mul_f32 v[88:89], v[88:89], v[104:105]
    v_pk_mul_f32 v[90:91], v[90:91], v[106:107]
    buffer_load_dwordx4 a[172:175], v1, s[76:79], s83 offen sc1
    v_pk_fma_f32 v[120:121], v[88:89], v[88:89], v[120:121]
    v_pk_add_f32 v[112:113], v[88:89], v[112:113]
    v_pk_fma_f32 v[122:123], v[90:91], v[90:91], v[122:123]
    v_pk_add_f32 v[114:115], v[90:91], v[114:115]
    v_pk_fma_f32 v[92:93], v[92:93], v[252:253], v[18:19] op_sel:[0,0,1] op_sel_hi:[1,1,1]
    v_pk_fma_f32 v[94:95], v[94:95], v[254:255], v[18:19] op_sel:[0,0,1] op_sel_hi:[1,1,1]
    v_pk_mul_f32 v[108:109], v[92:93], v[92:93]
    v_pk_mul_f32 v[110:111], v[94:95], v[94:95]
    v_pk_fma_f32 v[108:109], v[108:109], v[26:27], v[24:25]
    v_pk_fma_f32 v[110:111], v[110:111], v[26:27], v[24:25]
    v_pk_mul_f32 v[108:109], v[108:109], v[92:93]
    buffer_load_dwordx4 v4, s[12:15], s35 offen offset:2048 sc1 lds
    v_pk_mul_f32 v[110:111], v[110:111], v[94:95]
    v_exp_f32 v108, v108
    v_exp_f32 v109, v109
    v_exp_f32 v110, v110
    v_exp_f32 v111, v111
    v_pk_add_f32 v[108:109], v[108:109], 1.0 op_sel_hi:[1,0]
    v_pk_add_f32 v[110:111], v[110:111], 1.0 op_sel_hi:[1,0]
    v_rcp_f32 v108, v108
    v_rcp_f32 v109, v109
    v_rcp_f32 v110, v110
    v_rcp_f32 v111, v111
    buffer_load_dwordx4 v4, s[12:15], s35 offen offset:3072 sc1 lds
    v_pk_mul_f32 v[92:93], v[92:93], v[108:109]
    v_pk_mul_f32 v[94:95], v[94:95], v[110:111]
    v_pk_fma_f32 v[124:125], v[92:93], v[92:93], v[124:125]
    v_pk_add_f32 v[116:117], v[92:93], v[116:117]
    v_pk_fma_f32 v[126:127], v[94:95], v[94:95], v[126:127]
    v_pk_add_f32 v[118:119], v[94:95], v[118:119]
    v_pk_fma_f32 v[96:97], v[96:97], v[248:249], v[20:21] op_sel_hi:[1,1,0]
    v_pk_fma_f32 v[98:99], v[98:99], v[250:251], v[20:21] op_sel_hi:[1,1,0]
    v_pk_mul_f32 v[104:105], v[96:97], v[96:97]
    v_pk_mul_f32 v[106:107], v[98:99], v[98:99]
    v_pk_fma_f32 v[104:105], v[104:105], v[26:27], v[24:25]
    s_add_u32 m0, s38, 0x1d000
    s_nop 0
    buffer_load_dwordx4 v5, s[12:15], s35 offen offset:0 sc1 lds
    s_add_u32 s35, s35, 36864
    v_pk_fma_f32 v[106:107], v[106:107], v[26:27], v[24:25]
    v_pk_mul_f32 v[104:105], v[104:105], v[96:97]
    v_pk_mul_f32 v[106:107], v[106:107], v[98:99]
    v_exp_f32 v104, v104
    v_exp_f32 v105, v105
    v_exp_f32 v106, v106
    v_exp_f32 v107, v107
    v_pk_add_f32 v[104:105], v[104:105], 1.0 op_sel_hi:[1,0]
    v_pk_add_f32 v[106:107], v[106:107], 1.0 op_sel_hi:[1,0]
    v_rcp_f32 v104, v104
    v_rcp_f32 v105, v105
    buffer_load_dwordx4 a[176:179], v1, s[76:79], s84 offen sc1
    v_rcp_f32 v106, v106
    v_rcp_f32 v107, v107
    v_pk_mul_f32 v[96:97], v[96:97], v[104:105]
    v_pk_mul_f32 v[98:99], v[98:99], v[106:107]
    v_pk_fma_f32 v[120:121], v[96:97], v[96:97], v[120:121]
    v_pk_add_f32 v[112:113], v[96:97], v[112:113]
    v_pk_fma_f32 v[122:123], v[98:99], v[98:99], v[122:123]
    v_pk_add_f32 v[114:115], v[98:99], v[114:115]
    v_pk_fma_f32 v[100:101], v[100:101], v[252:253], v[20:21] op_sel_hi:[1,1,0]
    v_pk_fma_f32 v[102:103], v[102:103], v[254:255], v[20:21] op_sel_hi:[1,1,0]
    v_pk_mul_f32 v[108:109], v[100:101], v[100:101]
    buffer_load_dwordx4 a[180:183], v1, s[76:79], s85 offen sc1
    v_pk_mul_f32 v[110:111], v[102:103], v[102:103]
    v_pk_fma_f32 v[108:109], v[108:109], v[26:27], v[24:25]
    v_pk_fma_f32 v[110:111], v[110:111], v[26:27], v[24:25]
    v_pk_mul_f32 v[108:109], v[108:109], v[100:101]
    v_pk_mul_f32 v[110:111], v[110:111], v[102:103]
    v_exp_f32 v108, v108
    v_exp_f32 v109, v109
    v_exp_f32 v110, v110
    v_exp_f32 v111, v111
    v_pk_add_f32 v[108:109], v[108:109], 1.0 op_sel_hi:[1,0]
    v_pk_add_f32 v[110:111], v[110:111], 1.0 op_sel_hi:[1,0]
    v_rcp_f32 v108, v108
    v_rcp_f32 v109, v109
    v_rcp_f32 v110, v110
    v_rcp_f32 v111, v111
    v_pk_mul_f32 v[100:101], v[100:101], v[108:109]
    v_pk_mul_f32 v[102:103], v[102:103], v[110:111]
    v_pk_fma_f32 v[124:125], v[100:101], v[100:101], v[124:125]
    v_pk_add_f32 v[116:117], v[100:101], v[116:117]
    v_pk_fma_f32 v[126:127], v[102:103], v[102:103], v[126:127]
    v_pk_add_f32 v[118:119], v[102:103], v[118:119]
    s_lshl_b32 s43, s36, 12
    s_lshl_b32 s3, s33, 8
    v_add_f32_dpp v112, v112, v112 row_ror:8 row_mask:0xf bank_mask:0x3
    v_add_f32_dpp v113, v113, v113 row_ror:8 row_mask:0xf bank_mask:0x3
    v_add_f32_dpp v114, v114, v114 row_ror:8 row_mask:0xf bank_mask:0x3
    v_add_f32_dpp v115, v115, v115 row_ror:8 row_mask:0xf bank_mask:0x3
    v_add_f32_dpp v120, v120, v120 row_ror:8 row_mask:0xf bank_mask:0x3
    v_add_f32_dpp v121, v121, v121 row_ror:8 row_mask:0xf bank_mask:0x3
    v_add_f32_dpp v122, v122, v122 row_ror:8 row_mask:0xf bank_mask:0x3
    v_add_f32_dpp v123, v123, v123 row_ror:8 row_mask:0xf bank_mask:0x3
    v_add_f32_dpp v112, v116, v116 row_ror:8 row_mask:0xf bank_mask:0xc
    v_add_f32_dpp v113, v117, v117 row_ror:8 row_mask:0xf bank_mask:0xc
    v_add_f32_dpp v114, v118, v118 row_ror:8 row_mask:0xf bank_mask:0xc
    v_add_f32_dpp v115, v119, v119 row_ror:8 row_mask:0xf bank_mask:0xc
    v_add_f32_dpp v120, v124, v124 row_ror:8 row_mask:0xf bank_mask:0xc
    v_add_f32_dpp v121, v125, v125 row_ror:8 row_mask:0xf bank_mask:0xc
    v_add_f32_dpp v122, v126, v126 row_ror:8 row_mask:0xf bank_mask:0xc
    v_add_f32_dpp v123, v127, v127 row_ror:8 row_mask:0xf bank_mask:0xc
    v_add_f32_dpp v112, v112, v112 row_half_mirror row_mask:0xf bank_mask:0x5
    v_add_f32_dpp v113, v113, v113 row_half_mirror row_mask:0xf bank_mask:0x5
    v_add_f32_dpp v120, v120, v120 row_half_mirror row_mask:0xf bank_mask:0x5
    v_add_f32_dpp v121, v121, v121 row_half_mirror row_mask:0xf bank_mask:0x5
    v_add_f32_dpp v112, v114, v114 row_half_mirror row_mask:0xf bank_mask:0xa
    v_add_f32_dpp v113, v115, v115 row_half_mirror row_mask:0xf bank_mask:0xa
    v_add_f32_dpp v120, v122, v122 row_half_mirror row_mask:0xf bank_mask:0xa
    v_add_f32_dpp v121, v123, v123 row_half_mirror row_mask:0xf bank_mask:0xa
    v_add_f32_dpp v112, v112, v112 quad_perm:[1,0,3,2] row_mask:0xf bank_mask:0xf
    v_add_f32_dpp v113, v113, v113 quad_perm:[1,0,3,2] row_mask:0xf bank_mask:0xf
    v_add_f32_dpp v120, v120, v120 quad_perm:[1,0,3,2] row_mask:0xf bank_mask:0xf
    v_add_f32_dpp v121, v121, v121 quad_perm:[1,0,3,2] row_mask:0xf bank_mask:0xf
    v_add_f32_dpp v112, v112, v112 quad_perm:[2,3,0,1] row_mask:0xf bank_mask:0xf
    v_add_f32_dpp v113, v113, v113 quad_perm:[2,3,0,1] row_mask:0xf bank_mask:0xf
    v_add_f32_dpp v120, v120, v120 quad_perm:[2,3,0,1] row_mask:0xf bank_mask:0xf
    v_add_f32_dpp v121, v121, v121 quad_perm:[2,3,0,1] row_mask:0xf bank_mask:0xf
    v_min_u32 v128, -2, v112
    v_min_u32 v129, -2, v120
    v_min_u32 v130, -2, v113
    v_min_u32 v131, -2, v121
    v_lshlrev_b32 v7, 2, v2
    s_add_u32 s3, s3, s43
    s_mov_b32 s40, 0x11111111
    s_mov_b32 s41, 0x11111111
    s_mov_b64 exec, s[40:41]
    buffer_store_dwordx4 v[128:131], v7, s[28:31], s3 offen sc1
    s_mov_b64 exec, -1
    v_lshrrev_b32 v7, 4, v2
    v_lshlrev_b32 v7, 6, v7
    s_lshl_b32 s3, s34, 8
    s_add_u32 s3, s3, 156160
    v_add_u32 v7, s3, v7
    v_lshl_add_u32 v6, v6, 4, s3
    s_waitcnt lgkmcnt(0)
    v_mfma_f32_16x16x32_bf16 v[104:107], v[176:179], a[0:3], 0
    ds_read_b128 v[212:215], v8 offset:27648
    v_mfma_f32_16x16x32_bf16 v[108:111], v[176:179], a[4:7], 0
    ds_read_b128 v[216:219], v8 offset:28672
    v_mfma_f32_16x16x32_bf16 v[112:115], v[180:183], a[0:3], 0
    ds_read_b128 v[220:223], v8 offset:29696
    v_mfma_f32_16x16x32_bf16 v[116:119], v[180:183], a[4:7], 0
    v_mfma_f32_16x16x32_bf16 v[120:123], v[184:187], a[0:3], 0
    ds_read_b128 v[224:227], v8 offset:30720
    v_mfma_f32_16x16x32_bf16 v[124:127], v[184:187], a[4:7], 0
    ds_read_b128 v[228:231], v8 offset:31744
    v_mfma_f32_16x16x32_bf16 v[128:131], v[188:191], a[0:3], 0
    ds_read_b128 v[232:235], v8 offset:32768
    v_mfma_f32_16x16x32_bf16 v[132:135], v[188:191], a[4:7], 0
    v_mfma_f32_16x16x32_bf16 v[136:139], v[192:195], a[0:3], 0
    ds_read_b128 v[236:239], v8 offset:33792
    v_mfma_f32_16x16x32_bf16 v[140:143], v[192:195], a[4:7], 0
    ds_read_b128 v[240:243], v8 offset:34816
    v_mfma_f32_16x16x32_bf16 v[144:147], v[196:199], a[0:3], 0
    ds_read_b128 v[244:247], v8 offset:35840
    v_mfma_f32_16x16x32_bf16 v[148:151], v[196:199], a[4:7], 0
    v_add_u32 v1, s55, v3
    s_add_u32 s55, s55, 1024
    buffer_load_dwordx4 a[184:187], v1, s[76:79], s81 offen sc1
    v_mfma_f32_16x16x32_bf16 v[152:155], v[200:203], a[0:3], 0
    v_mfma_f32_16x16x32_bf16 v[156:159], v[200:203], a[4:7], 0
    v_mfma_f32_16x16x32_bf16 v[160:163], v[204:207], a[0:3], 0
    v_mfma_f32_16x16x32_bf16 v[164:167], v[204:207], a[4:7], 0
    v_mfma_f32_16x16x32_bf16 v[168:171], v[208:211], a[0:3], 0
    v_mfma_f32_16x16x32_bf16 v[172:175], v[208:211], a[4:7], 0
    s_waitcnt vmcnt(28) lgkmcnt(0)
    s_barrier
    v_mfma_f32_16x16x32_bf16 v[104:107], v[212:215], a[8:11], v[104:107]
    ds_read_b128 v[176:179], v9 offset:0
    v_mfma_f32_16x16x32_bf16 v[108:111], v[212:215], a[12:15], v[108:111]
    ds_read_b128 v[180:183], v9 offset:1024
    v_mfma_f32_16x16x32_bf16 v[112:115], v[216:219], a[8:11], v[112:115]
    ds_read_b128 v[184:187], v9 offset:2048
    v_mfma_f32_16x16x32_bf16 v[116:119], v[216:219], a[12:15], v[116:119]
    v_mfma_f32_16x16x32_bf16 v[120:123], v[220:223], a[8:11], v[120:123]
    ds_read_b128 v[188:191], v9 offset:3072
    buffer_load_dwordx4 a[188:191], v1, s[76:79], s82 offen sc1
    v_mfma_f32_16x16x32_bf16 v[124:127], v[220:223], a[12:15], v[124:127]
    ds_read_b128 v[192:195], v9 offset:4096
    v_mfma_f32_16x16x32_bf16 v[128:131], v[224:227], a[8:11], v[128:131]
    ds_read_b128 v[196:199], v9 offset:5120
    v_mfma_f32_16x16x32_bf16 v[132:135], v[224:227], a[12:15], v[132:135]
    v_mfma_f32_16x16x32_bf16 v[136:139], v[228:231], a[8:11], v[136:139]
    ds_read_b128 v[200:203], v9 offset:6144
    v_mfma_f32_16x16x32_bf16 v[140:143], v[228:231], a[12:15], v[140:143]
    ds_read_b128 v[204:207], v9 offset:7168
    v_mfma_f32_16x16x32_bf16 v[144:147], v[232:235], a[8:11], v[144:147]
    ds_read_b128 v[208:211], v9 offset:8192
    v_mfma_f32_16x16x32_bf16 v[148:151], v[232:235], a[12:15], v[148:151]
    v_mfma_f32_16x16x32_bf16 v[152:155], v[236:239], a[8:11], v[152:155]
    v_mfma_f32_16x16x32_bf16 v[156:159], v[236:239], a[12:15], v[156:159]
    buffer_load_dwordx4 a[192:195], v1, s[76:79], s83 offen sc1
    v_mfma_f32_16x16x32_bf16 v[160:163], v[240:243], a[8:11], v[160:163]
    v_mfma_f32_16x16x32_bf16 v[164:167], v[240:243], a[12:15], v[164:167]
    v_mfma_f32_16x16x32_bf16 v[168:171], v[244:247], a[8:11], v[168:171]
    v_mfma_f32_16x16x32_bf16 v[172:175], v[244:247], a[12:15], v[172:175]
    s_waitcnt lgkmcnt(0)
    v_mfma_f32_16x16x32_bf16 v[104:107], v[176:179], a[16:19], v[104:107]
    ds_read_b128 v[212:215], v9 offset:9216
    v_mfma_f32_16x16x32_bf16 v[108:111], v[176:179], a[20:23], v[108:111]
    ds_read_b128 v[216:219], v9 offset:10240
    s_add_u32 m0, s38, 0x0
    v_mfma_f32_16x16x32_bf16 v[112:115], v[180:183], a[16:19], v[112:115]
    ds_read_b128 v[220:223], v9 offset:11264
    buffer_load_dwordx4 v3, s[12:15], s35 offen offset:0 sc1 lds
    v_mfma_f32_16x16x32_bf16 v[116:119], v[180:183], a[20:23], v[116:119]
    v_mfma_f32_16x16x32_bf16 v[120:123], v[184:187], a[16:19], v[120:123]
    ds_read_b128 v[224:227], v9 offset:12288
    v_mfma_f32_16x16x32_bf16 v[124:127], v[184:187], a[20:23], v[124:127]
    ds_read_b128 v[228:231], v9 offset:13312
    v_mfma_f32_16x16x32_bf16 v[128:131], v[188:191], a[16:19], v[128:131]
    ds_read_b128 v[232:235], v9 offset:14336
    buffer_load_dwordx4 v3, s[12:15], s35 offen offset:1024 sc1 lds
    v_mfma_f32_16x16x32_bf16 v[132:135], v[188:191], a[20:23], v[132:135]
    v_mfma_f32_16x16x32_bf16 v[136:139], v[192:195], a[16:19], v[136:139]
    ds_read_b128 v[236:239], v9 offset:15360
    v_mfma_f32_16x16x32_bf16 v[140:143], v[192:195], a[20:23], v[140:143]
    ds_read_b128 v[240:243], v9 offset:16384
    v_mfma_f32_16x16x32_bf16 v[144:147], v[196:199], a[16:19], v[144:147]
    ds_read_b128 v[244:247], v9 offset:17408
    v_mfma_f32_16x16x32_bf16 v[148:151], v[196:199], a[20:23], v[148:151]
    buffer_load_dwordx4 a[196:199], v1, s[76:79], s84 offen sc1
    v_mfma_f32_16x16x32_bf16 v[152:155], v[200:203], a[16:19], v[152:155]
    v_mfma_f32_16x16x32_bf16 v[156:159], v[200:203], a[20:23], v[156:159]
    v_mfma_f32_16x16x32_bf16 v[160:163], v[204:207], a[16:19], v[160:163]
    v_mfma_f32_16x16x32_bf16 v[164:167], v[204:207], a[20:23], v[164:167]
    buffer_load_dwordx4 a[200:203], v1, s[76:79], s85 offen sc1
    v_mfma_f32_16x16x32_bf16 v[168:171], v[208:211], a[16:19], v[168:171]
    v_mfma_f32_16x16x32_bf16 v[172:175], v[208:211], a[20:23], v[172:175]
    s_waitcnt lgkmcnt(0)
    v_mfma_f32_16x16x32_bf16 v[104:107], v[212:215], a[24:27], v[104:107]
    ds_read_b128 v[176:179], v9 offset:18432
    v_mfma_f32_16x16x32_bf16 v[108:111], v[212:215], a[28:31], v[108:111]
    ds_read_b128 v[180:183], v9 offset:19456
    v_mfma_f32_16x16x32_bf16 v[112:115], v[216:219], a[24:27], v[112:115]
    ds_read_b128 v[184:187], v9 offset:20480
    v_mfma_f32_16x16x32_bf16 v[116:119], v[216:219], a[28:31], v[116:119]
    buffer_load_dwordx4 v3, s[12:15], s35 offen offset:2048 sc1 lds
    v_mfma_f32_16x16x32_bf16 v[120:123], v[220:223], a[24:27], v[120:123]
    ds_read_b128 v[188:191], v9 offset:21504
    v_mfma_f32_16x16x32_bf16 v[124:127], v[220:223], a[28:31], v[124:127]
    ds_read_b128 v[192:195], v9 offset:22528
    v_mfma_f32_16x16x32_bf16 v[128:131], v[224:227], a[24:27], v[128:131]
    ds_read_b128 v[196:199], v9 offset:23552
    v_mfma_f32_16x16x32_bf16 v[132:135], v[224:227], a[28:31], v[132:135]
    v_mfma_f32_16x16x32_bf16 v[136:139], v[228:231], a[24:27], v[136:139]
    ds_read_b128 v[200:203], v9 offset:24576
    v_mfma_f32_16x16x32_bf16 v[140:143], v[228:231], a[28:31], v[140:143]
    ds_read_b128 v[204:207], v9 offset:25600
    buffer_load_dwordx4 v3, s[12:15], s35 offen offset:3072 sc1 lds
    v_mfma_f32_16x16x32_bf16 v[144:147], v[232:235], a[24:27], v[144:147]
    ds_read_b128 v[208:211], v9 offset:26624
    v_mfma_f32_16x16x32_bf16 v[148:151], v[232:235], a[28:31], v[148:151]
    v_mfma_f32_16x16x32_bf16 v[152:155], v[236:239], a[24:27], v[152:155]
    v_mfma_f32_16x16x32_bf16 v[156:159], v[236:239], a[28:31], v[156:159]
    v_mfma_f32_16x16x32_bf16 v[160:163], v[240:243], a[24:27], v[160:163]
    v_mfma_f32_16x16x32_bf16 v[164:167], v[240:243], a[28:31], v[164:167]
    v_add_u32 v1, s55, v3
    s_add_u32 s55, s55, 1024
    buffer_load_dwordx4 a[204:207], v1, s[76:79], s81 offen sc1
    v_mfma_f32_16x16x32_bf16 v[168:171], v[244:247], a[24:27], v[168:171]
    v_mfma_f32_16x16x32_bf16 v[172:175], v[244:247], a[28:31], v[172:175]
    s_waitcnt lgkmcnt(0)
    v_mfma_f32_16x16x32_bf16 v[104:107], v[176:179], a[32:35], v[104:107]
    ds_read_b128 v[212:215], v9 offset:27648
    v_mfma_f32_16x16x32_bf16 v[108:111], v[176:179], a[36:39], v[108:111]
    ds_read_b128 v[216:219], v9 offset:28672
    s_add_u32 m0, s38, 0x1000
    v_mfma_f32_16x16x32_bf16 v[112:115], v[180:183], a[32:35], v[112:115]
    ds_read_b128 v[220:223], v9 offset:29696
    buffer_load_dwordx4 v4, s[12:15], s35 offen offset:0 sc1 lds
    v_mfma_f32_16x16x32_bf16 v[116:119], v[180:183], a[36:39], v[116:119]
    v_mfma_f32_16x16x32_bf16 v[120:123], v[184:187], a[32:35], v[120:123]
    ds_read_b128 v[224:227], v9 offset:30720
    v_mfma_f32_16x16x32_bf16 v[124:127], v[184:187], a[36:39], v[124:127]
    ds_read_b128 v[228:231], v9 offset:31744
    v_mfma_f32_16x16x32_bf16 v[128:131], v[188:191], a[32:35], v[128:131]
    ds_read_b128 v[232:235], v9 offset:32768
    buffer_load_dwordx4 v4, s[12:15], s35 offen offset:1024 sc1 lds
    v_mfma_f32_16x16x32_bf16 v[132:135], v[188:191], a[36:39], v[132:135]
    v_mfma_f32_16x16x32_bf16 v[136:139], v[192:195], a[32:35], v[136:139]
    ds_read_b128 v[236:239], v9 offset:33792
    v_mfma_f32_16x16x32_bf16 v[140:143], v[192:195], a[36:39], v[140:143]
    ds_read_b128 v[240:243], v9 offset:34816
    v_mfma_f32_16x16x32_bf16 v[144:147], v[196:199], a[32:35], v[144:147]
    ds_read_b128 v[244:247], v9 offset:35840
    v_mfma_f32_16x16x32_bf16 v[148:151], v[196:199], a[36:39], v[148:151]
    buffer_load_dwordx4 a[208:211], v1, s[76:79], s82 offen sc1
    v_mfma_f32_16x16x32_bf16 v[152:155], v[200:203], a[32:35], v[152:155]
    v_mfma_f32_16x16x32_bf16 v[156:159], v[200:203], a[36:39], v[156:159]
    v_mfma_f32_16x16x32_bf16 v[160:163], v[204:207], a[32:35], v[160:163]
    v_mfma_f32_16x16x32_bf16 v[164:167], v[204:207], a[36:39], v[164:167]
    buffer_load_dwordx4 a[212:215], v1, s[76:79], s83 offen sc1
    v_mfma_f32_16x16x32_bf16 v[168:171], v[208:211], a[32:35], v[168:171]
    v_mfma_f32_16x16x32_bf16 v[172:175], v[208:211], a[36:39], v[172:175]
    s_waitcnt vmcnt(29) lgkmcnt(0)
    s_barrier
    v_mfma_f32_16x16x32_bf16 v[104:107], v[212:215], a[40:43], v[104:107]
    ds_read_b128 v[176:179], v10 offset:0
    v_mfma_f32_16x16x32_bf16 v[108:111], v[212:215], a[44:47], v[108:111]
    ds_read_b128 v[180:183], v10 offset:1024
    buffer_load_dwordx4 v4, s[12:15], s35 offen offset:2048 sc1 lds
    v_mfma_f32_16x16x32_bf16 v[112:115], v[216:219], a[40:43], v[112:115]
    ds_read_b128 v[184:187], v10 offset:2048
    v_mfma_f32_16x16x32_bf16 v[116:119], v[216:219], a[44:47], v[116:119]
    v_mfma_f32_16x16x32_bf16 v[120:123], v[220:223], a[40:43], v[120:123]
    ds_read_b128 v[188:191], v10 offset:3072
    v_mfma_f32_16x16x32_bf16 v[124:127], v[220:223], a[44:47], v[124:127]
    ds_read_b128 v[192:195], v10 offset:4096
    buffer_load_dwordx4 v4, s[12:15], s35 offen offset:3072 sc1 lds
    v_mfma_f32_16x16x32_bf16 v[128:131], v[224:227], a[40:43], v[128:131]
    ds_read_b128 v[196:199], v10 offset:5120
    v_mfma_f32_16x16x32_bf16 v[132:135], v[224:227], a[44:47], v[132:135]
    v_mfma_f32_16x16x32_bf16 v[136:139], v[228:231], a[40:43], v[136:139]
    ds_read_b128 v[200:203], v10 offset:6144
    s_add_u32 m0, s38, 0x2000
    v_mfma_f32_16x16x32_bf16 v[140:143], v[228:231], a[44:47], v[140:143]
    ds_read_b128 v[204:207], v10 offset:7168
    buffer_load_dwordx4 v5, s[12:15], s35 offen offset:0 sc1 lds
    s_add_u32 s35, s35, 36864
    v_mfma_f32_16x16x32_bf16 v[144:147], v[232:235], a[40:43], v[144:147]
    ds_read_b128 v[208:211], v10 offset:8192
    v_mfma_f32_16x16x32_bf16 v[148:151], v[232:235], a[44:47], v[148:151]
    v_mfma_f32_16x16x32_bf16 v[152:155], v[236:239], a[40:43], v[152:155]
    buffer_load_dwordx4 a[216:219], v1, s[76:79], s84 offen sc1
    v_mfma_f32_16x16x32_bf16 v[156:159], v[236:239], a[44:47], v[156:159]
    v_mfma_f32_16x16x32_bf16 v[160:163], v[240:243], a[40:43], v[160:163]
    v_mfma_f32_16x16x32_bf16 v[164:167], v[240:243], a[44:47], v[164:167]
    v_mfma_f32_16x16x32_bf16 v[168:171], v[244:247], a[40:43], v[168:171]
    buffer_load_dwordx4 a[220:223], v1, s[76:79], s85 offen sc1
    v_mfma_f32_16x16x32_bf16 v[172:175], v[244:247], a[44:47], v[172:175]
    s_waitcnt lgkmcnt(0)
    v_mfma_f32_16x16x32_bf16 v[104:107], v[176:179], a[48:51], v[104:107]
    ds_read_b128 v[212:215], v10 offset:9216
    v_mfma_f32_16x16x32_bf16 v[108:111], v[176:179], a[52:55], v[108:111]
    ds_read_b128 v[216:219], v10 offset:10240
    buffer_load_dwordx4 v[12:15], v3, s[28:31], s43 offen offset:0 sc1
    v_mfma_f32_16x16x32_bf16 v[112:115], v[180:183], a[48:51], v[112:115]
    ds_read_b128 v[220:223], v10 offset:11264
    v_mfma_f32_16x16x32_bf16 v[116:119], v[180:183], a[52:55], v[116:119]
    v_mfma_f32_16x16x32_bf16 v[120:123], v[184:187], a[48:51], v[120:123]
    ds_read_b128 v[224:227], v10 offset:12288
    v_mfma_f32_16x16x32_bf16 v[124:127], v[184:187], a[52:55], v[124:127]
    ds_read_b128 v[228:231], v10 offset:13312
    buffer_load_dwordx4 v[16:19], v3, s[28:31], s43 offen offset:1024 sc1
    v_mfma_f32_16x16x32_bf16 v[128:131], v[188:191], a[48:51], v[128:131]
    ds_read_b128 v[232:235], v10 offset:14336
    v_mfma_f32_16x16x32_bf16 v[132:135], v[188:191], a[52:55], v[132:135]
    v_mfma_f32_16x16x32_bf16 v[136:139], v[192:195], a[48:51], v[136:139]
    ds_read_b128 v[236:239], v10 offset:15360
    v_mfma_f32_16x16x32_bf16 v[140:143], v[192:195], a[52:55], v[140:143]
    ds_read_b128 v[240:243], v10 offset:16384
    buffer_load_dwordx4 v[248:251], v3, s[28:31], s43 offen offset:2048 sc1
    v_mfma_f32_16x16x32_bf16 v[144:147], v[196:199], a[48:51], v[144:147]
    ds_read_b128 v[244:247], v10 offset:17408
    v_mfma_f32_16x16x32_bf16 v[148:151], v[196:199], a[52:55], v[148:151]
    v_mfma_f32_16x16x32_bf16 v[152:155], v[200:203], a[48:51], v[152:155]
    buffer_load_dwordx4 v[252:255], v3, s[28:31], s43 offen offset:3072 sc1
    v_mfma_f32_16x16x32_bf16 v[156:159], v[200:203], a[52:55], v[156:159]
    v_mfma_f32_16x16x32_bf16 v[160:163], v[204:207], a[48:51], v[160:163]
    v_mfma_f32_16x16x32_bf16 v[164:167], v[204:207], a[52:55], v[164:167]
    v_mfma_f32_16x16x32_bf16 v[168:171], v[208:211], a[48:51], v[168:171]
    v_add_u32 v1, s55, v3
    s_add_u32 s55, s55, 1024
    buffer_load_dwordx4 a[224:227], v1, s[76:79], s81 offen sc1
    v_mfma_f32_16x16x32_bf16 v[172:175], v[208:211], a[52:55], v[172:175]
    s_waitcnt lgkmcnt(0)
    v_mfma_f32_16x16x32_bf16 v[104:107], v[212:215], a[56:59], v[104:107]
    ds_read_b128 v[176:179], v10 offset:18432
    v_mfma_f32_16x16x32_bf16 v[108:111], v[212:215], a[60:63], v[108:111]
    ds_read_b128 v[180:183], v10 offset:19456
    v_mfma_f32_16x16x32_bf16 v[112:115], v[216:219], a[56:59], v[112:115]
    ds_read_b128 v[184:187], v10 offset:20480
    v_mfma_f32_16x16x32_bf16 v[116:119], v[216:219], a[60:63], v[116:119]
    v_mfma_f32_16x16x32_bf16 v[120:123], v[220:223], a[56:59], v[120:123]
    ds_read_b128 v[188:191], v10 offset:21504
    buffer_load_dwordx4 a[228:231], v1, s[76:79], s82 offen sc1
    v_mfma_f32_16x16x32_bf16 v[124:127], v[220:223], a[60:63], v[124:127]
    ds_read_b128 v[192:195], v10 offset:22528
    v_mfma_f32_16x16x32_bf16 v[128:131], v[224:227], a[56:59], v[128:131]
    ds_read_b128 v[196:199], v10 offset:23552
    v_mfma_f32_16x16x32_bf16 v[132:135], v[224:227], a[60:63], v[132:135]
    v_mfma_f32_16x16x32_bf16 v[136:139], v[228:231], a[56:59], v[136:139]
    ds_read_b128 v[200:203], v10 offset:24576
    v_mfma_f32_16x16x32_bf16 v[140:143], v[228:231], a[60:63], v[140:143]
    ds_read_b128 v[204:207], v10 offset:25600
    v_mfma_f32_16x16x32_bf16 v[144:147], v[232:235], a[56:59], v[144:147]
    ds_read_b128 v[208:211], v10 offset:26624
    v_mfma_f32_16x16x32_bf16 v[148:151], v[232:235], a[60:63], v[148:151]
    v_mfma_f32_16x16x32_bf16 v[152:155], v[236:239], a[56:59], v[152:155]
    v_mfma_f32_16x16x32_bf16 v[156:159], v[236:239], a[60:63], v[156:159]
    buffer_load_dwordx4 a[232:235], v1, s[76:79], s83 offen sc1
    v_mfma_f32_16x16x32_bf16 v[160:163], v[240:243], a[56:59], v[160:163]
    v_mfma_f32_16x16x32_bf16 v[164:167], v[240:243], a[60:63], v[164:167]
    v_mfma_f32_16x16x32_bf16 v[168:171], v[244:247], a[56:59], v[168:171]
    v_mfma_f32_16x16x32_bf16 v[172:175], v[244:247], a[60:63], v[172:175]
    s_waitcnt vmcnt(3) lgkmcnt(0)
    v_max_u32 v20, v12, v13
    v_max3_u32 v20, v14, v15, v20
    v_max3_u32 v20, v16, v17, v20
    v_max3_u32 v20, v18, v19, v20
    v_max3_u32 v20, v248, v249, v20
    v_max3_u32 v20, v250, v251, v20
    v_max3_u32 v20, v252, v253, v20
    v_max3_u32 v20, v254, v255, v20
    v_cmp_eq_u32 vcc, -1, v20
    s_cbranch_vccnz L_g1slow_34
L_g1back_35:
    v_mfma_f32_16x16x32_bf16 v[104:107], v[176:179], a[64:67], v[104:107]
    ds_read_b128 v[212:215], v10 offset:27648
    buffer_load_dwordx4 a[236:239], v1, s[76:79], s84 offen sc1
    v_mfma_f32_16x16x32_bf16 v[108:111], v[176:179], a[68:71], v[108:111]
    ds_read_b128 v[216:219], v10 offset:28672
    buffer_load_dwordx4 a[240:243], v1, s[76:79], s85 offen sc1
    v_mfma_f32_16x16x32_bf16 v[112:115], v[180:183], a[64:67], v[112:115]
    ds_read_b128 v[220:223], v10 offset:29696
    v_add_f32 v12, v12, v16
    v_mfma_f32_16x16x32_bf16 v[116:119], v[180:183], a[68:71], v[116:119]
    v_add_f32 v13, v13, v17
    v_add_f32 v14, v14, v18
    v_mfma_f32_16x16x32_bf16 v[120:123], v[184:187], a[64:67], v[120:123]
    ds_read_b128 v[224:227], v10 offset:30720
    v_add_f32 v15, v15, v19
    v_mfma_f32_16x16x32_bf16 v[124:127], v[184:187], a[68:71], v[124:127]
    ds_read_b128 v[228:231], v10 offset:31744
    v_add_f32 v248, v248, v252
    v_mfma_f32_16x16x32_bf16 v[128:131], v[188:191], a[64:67], v[128:131]
    ds_read_b128 v[232:235], v10 offset:32768
    v_add_f32 v249, v249, v253
    v_mfma_f32_16x16x32_bf16 v[132:135], v[188:191], a[68:71], v[132:135]
    v_add_f32 v250, v250, v254
    v_add_f32 v251, v251, v255
    v_mfma_f32_16x16x32_bf16 v[136:139], v[192:195], a[64:67], v[136:139]
    ds_read_b128 v[236:239], v10 offset:33792
    v_add_f32 v12, v12, v248
    v_mfma_f32_16x16x32_bf16 v[140:143], v[192:195], a[68:71], v[140:143]
    ds_read_b128 v[240:243], v10 offset:34816
    v_add_f32 v13, v13, v249
    v_mfma_f32_16x16x32_bf16 v[144:147], v[196:199], a[64:67], v[144:147]
    ds_read_b128 v[244:247], v10 offset:35840
    v_add_f32 v14, v14, v250
    v_mfma_f32_16x16x32_bf16 v[148:151], v[196:199], a[68:71], v[148:151]
    v_add_f32 v15, v15, v251
    v_mov_b32 v16, v12
    v_mfma_f32_16x16x32_bf16 v[152:155], v[200:203], a[64:67], v[152:155]
    v_mov_b32 v17, v13
    v_mov_b32 v18, v14
    v_mfma_f32_16x16x32_bf16 v[156:159], v[200:203], a[68:71], v[156:159]
    v_mov_b32 v19, v15
    s_nop 1
    v_permlane32_swap_b32 v12, v16
    v_mfma_f32_16x16x32_bf16 v[160:163], v[204:207], a[64:67], v[160:163]
    v_permlane32_swap_b32 v13, v17
    v_permlane32_swap_b32 v14, v18
    v_mfma_f32_16x16x32_bf16 v[164:167], v[204:207], a[68:71], v[164:167]
    v_permlane32_swap_b32 v15, v19
    v_add_f32 v12, v12, v16
    v_mfma_f32_16x16x32_bf16 v[168:171], v[208:211], a[64:67], v[168:171]
    v_add_f32 v13, v13, v17
    v_add_f32 v14, v14, v18
    v_mfma_f32_16x16x32_bf16 v[172:175], v[208:211], a[68:71], v[172:175]
    v_add_f32 v15, v15, v19
    v_mov_b32 v16, v12
    v_mov_b32 v17, v13
    v_mov_b32 v18, v14
    v_mov_b32 v19, v15
    s_nop 1
    s_waitcnt vmcnt(31) lgkmcnt(0)
    s_barrier
    v_mfma_f32_16x16x32_bf16 v[104:107], v[212:215], a[72:75], v[104:107]
    ds_read_b128 v[176:179], v11 offset:0
    v_mfma_f32_16x16x32_bf16 v[108:111], v[212:215], a[76:79], v[108:111]
    ds_read_b128 v[180:183], v11 offset:1024
    v_mfma_f32_16x16x32_bf16 v[112:115], v[216:219], a[72:75], v[112:115]
    ds_read_b128 v[184:187], v11 offset:2048
    v_mfma_f32_16x16x32_bf16 v[116:119], v[216:219], a[76:79], v[116:119]
    v_add_u32 v1, s55, v3
    s_add_u32 s55, s55, 1024
    buffer_load_dwordx4 a[244:247], v1, s[76:79], s81 offen sc1
    v_mfma_f32_16x16x32_bf16 v[120:123], v[220:223], a[72:75], v[120:123]
    ds_read_b128 v[188:191], v11 offset:3072
    v_permlane16_swap_b32 v12, v16
    v_mfma_f32_16x16x32_bf16 v[124:127], v[220:223], a[76:79], v[124:127]
    ds_read_b128 v[192:195], v11 offset:4096
    v_permlane16_swap_b32 v13, v17
    v_mfma_f32_16x16x32_bf16 v[128:131], v[224:227], a[72:75], v[128:131]
    ds_read_b128 v[196:199], v11 offset:5120
    v_permlane16_swap_b32 v14, v18
    v_mfma_f32_16x16x32_bf16 v[132:135], v[224:227], a[76:79], v[132:135]
    v_permlane16_swap_b32 v15, v19
    v_add_f32 v12, v12, v16
    v_mfma_f32_16x16x32_bf16 v[136:139], v[228:231], a[72:75], v[136:139]
    ds_read_b128 v[200:203], v11 offset:6144
    v_add_f32 v13, v13, v17
    v_mfma_f32_16x16x32_bf16 v[140:143], v[228:231], a[76:79], v[140:143]
    ds_read_b128 v[204:207], v11 offset:7168
    v_add_f32 v14, v14, v18
    v_mfma_f32_16x16x32_bf16 v[144:147], v[232:235], a[72:75], v[144:147]
    ds_read_b128 v[208:211], v11 offset:8192
    v_add_f32 v15, v15, v19
    v_mfma_f32_16x16x32_bf16 v[148:151], v[232:235], a[76:79], v[148:151]
    v_mul_f32 v12, 0x39e38e39, v12
    v_mul_f32 v13, 0x39e38e39, v13
    v_mfma_f32_16x16x32_bf16 v[152:155], v[236:239], a[72:75], v[152:155]
    v_mul_f32 v14, 0x39e38e39, v14
    v_mul_f32 v15, 0x39e38e39, v15
    v_mfma_f32_16x16x32_bf16 v[156:159], v[236:239], a[76:79], v[156:159]
    v_fma_f32 v13, -v12, v12, v13
    v_fma_f32 v15, -v14, v14, v15
    v_mfma_f32_16x16x32_bf16 v[160:163], v[240:243], a[72:75], v[160:163]
    v_max_f32 v13, 0, v13
    v_max_f32 v15, 0, v15
    v_mfma_f32_16x16x32_bf16 v[164:167], v[240:243], a[76:79], v[164:167]
    v_add_f32 v13, 0x3727c5ac, v13
    v_add_f32 v15, 0x3727c5ac, v15
    v_mfma_f32_16x16x32_bf16 v[168:171], v[244:247], a[72:75], v[168:171]
    v_rsq_f32 v13, v13
    v_mfma_f32_16x16x32_bf16 v[172:175], v[244:247], a[76:79], v[172:175]
    v_rsq_f32 v15, v15
    s_lshl_b32 s48, s33, 6
    s_add_u32 s48, s48, s36
    s_mul_i32 s48, s48, 9216
    v_mul_f32 v12, v12, v13
    v_mul_f32 v14, v14, v15
    ds_write_b128 v6, v[12:15]
    ds_read_b128 v[12:15], v7 offset:0
    ds_read_b128 v[16:19], v7 offset:16
    ds_read_b128 v[248:251], v7 offset:32
    ds_read_b128 v[252:255], v7 offset:48
    s_waitcnt lgkmcnt(0)
    v_mfma_f32_16x16x32_bf16 v[104:107], v[176:179], a[80:83], v[104:107]
    ds_read_b128 v[212:215], v11 offset:9216
    buffer_load_dwordx4 a[248:251], v1, s[76:79], s82 offen sc1
    v_mfma_f32_16x16x32_bf16 v[108:111], v[176:179], a[84:87], v[108:111]
    ds_read_b128 v[216:219], v11 offset:10240
    buffer_load_dwordx4 a[252:255], v1, s[76:79], s83 offen sc1
    v_mfma_f32_16x16x32_bf16 v[112:115], v[180:183], a[80:83], v[112:115]
    ds_read_b128 v[220:223], v11 offset:11264
    v_fma_f32 v32, v32, v13, -v12
    v_mfma_f32_16x16x32_bf16 v[116:119], v[180:183], a[84:87], v[116:119]
    v_fma_f32 v33, v33, v15, -v14
    v_fma_f32 v34, v34, v17, -v16
    v_mfma_f32_16x16x32_bf16 v[120:123], v[184:187], a[80:83], v[120:123]
    ds_read_b128 v[224:227], v11 offset:12288
    v_fma_f32 v35, v35, v19, -v18
    v_mfma_f32_16x16x32_bf16 v[124:127], v[184:187], a[84:87], v[124:127]
    ds_read_b128 v[228:231], v11 offset:13312
    v_fma_f32 v36, v36, v249, -v248
    v_mfma_f32_16x16x32_bf16 v[128:131], v[188:191], a[80:83], v[128:131]
    ds_read_b128 v[232:235], v11 offset:14336
    v_fma_f32 v37, v37, v251, -v250
    v_mfma_f32_16x16x32_bf16 v[132:135], v[188:191], a[84:87], v[132:135]
    v_fma_f32 v38, v38, v253, -v252
    v_fma_f32 v39, v39, v255, -v254
    v_mfma_f32_16x16x32_bf16 v[136:139], v[192:195], a[80:83], v[136:139]
    ds_read_b128 v[236:239], v11 offset:15360
    v_cvt_pk_bf16_f32 v32, v32, v33
    v_mfma_f32_16x16x32_bf16 v[140:143], v[192:195], a[84:87], v[140:143]
    ds_read_b128 v[240:243], v11 offset:16384
    v_cvt_pk_bf16_f32 v33, v34, v35
    v_mfma_f32_16x16x32_bf16 v[144:147], v[196:199], a[80:83], v[144:147]
    ds_read_b128 v[244:247], v11 offset:17408
    v_cvt_pk_bf16_f32 v34, v36, v37
    v_mfma_f32_16x16x32_bf16 v[148:151], v[196:199], a[84:87], v[148:151]
    v_cvt_pk_bf16_f32 v35, v38, v39
    buffer_store_dwordx4 v[32:35], v3, s[24:27], s48 offen offset:0 sc1
    v_mfma_f32_16x16x32_bf16 v[152:155], v[200:203], a[80:83], v[152:155]
    v_fma_f32 v40, v40, v13, -v12
    v_fma_f32 v41, v41, v15, -v14
    v_mfma_f32_16x16x32_bf16 v[156:159], v[200:203], a[84:87], v[156:159]
    v_fma_f32 v42, v42, v17, -v16
    v_fma_f32 v43, v43, v19, -v18
    v_mfma_f32_16x16x32_bf16 v[160:163], v[204:207], a[80:83], v[160:163]
    v_fma_f32 v44, v44, v249, -v248
    v_fma_f32 v45, v45, v251, -v250
    v_mfma_f32_16x16x32_bf16 v[164:167], v[204:207], a[84:87], v[164:167]
    v_fma_f32 v46, v46, v253, -v252
    v_mfma_f32_16x16x32_bf16 v[168:171], v[208:211], a[80:83], v[168:171]
    v_fma_f32 v47, v47, v255, -v254
    v_cvt_pk_bf16_f32 v40, v40, v41
    v_mfma_f32_16x16x32_bf16 v[172:175], v[208:211], a[84:87], v[172:175]
    v_cvt_pk_bf16_f32 v41, v42, v43
    s_waitcnt lgkmcnt(0)
    v_mfma_f32_16x16x32_bf16 v[104:107], v[212:215], a[88:91], v[104:107]
    ds_read_b128 v[176:179], v11 offset:18432
    buffer_load_dwordx4 a[0:3], v1, s[76:79], s84 offen sc1
    v_mfma_f32_16x16x32_bf16 v[108:111], v[212:215], a[92:95], v[108:111]
    ds_read_b128 v[180:183], v11 offset:19456
    buffer_load_dwordx4 a[4:7], v1, s[76:79], s85 offen sc1
    v_mfma_f32_16x16x32_bf16 v[112:115], v[216:219], a[88:91], v[112:115]
    ds_read_b128 v[184:187], v11 offset:20480
    v_cvt_pk_bf16_f32 v42, v44, v45
    v_mfma_f32_16x16x32_bf16 v[116:119], v[216:219], a[92:95], v[116:119]
    v_cvt_pk_bf16_f32 v43, v46, v47
    buffer_store_dwordx4 v[40:43], v3, s[24:27], s48 offen offset:1024 sc1
    v_mfma_f32_16x16x32_bf16 v[120:123], v[220:223], a[88:91], v[120:123]
    ds_read_b128 v[188:191], v11 offset:21504
    v_fma_f32 v48, v48, v13, -v12
    v_mfma_f32_16x16x32_bf16 v[124:127], v[220:223], a[92:95], v[124:127]
    ds_read_b128 v[192:195], v11 offset:22528
    v_fma_f32 v49, v49, v15, -v14
    v_mfma_f32_16x16x32_bf16 v[128:131], v[224:227], a[88:91], v[128:131]
    ds_read_b128 v[196:199], v11 offset:23552
    v_fma_f32 v50, v50, v17, -v16
    v_mfma_f32_16x16x32_bf16 v[132:135], v[224:227], a[92:95], v[132:135]
    v_fma_f32 v51, v51, v19, -v18
    v_fma_f32 v52, v52, v249, -v248
    v_mfma_f32_16x16x32_bf16 v[136:139], v[228:231], a[88:91], v[136:139]
    ds_read_b128 v[200:203], v11 offset:24576
    v_fma_f32 v53, v53, v251, -v250
    v_mfma_f32_16x16x32_bf16 v[140:143], v[228:231], a[92:95], v[140:143]
    ds_read_b128 v[204:207], v11 offset:25600
    v_fma_f32 v54, v54, v253, -v252
    v_mfma_f32_16x16x32_bf16 v[144:147], v[232:235], a[88:91], v[144:147]
    ds_read_b128 v[208:211], v11 offset:26624
    v_fma_f32 v55, v55, v255, -v254
    v_mfma_f32_16x16x32_bf16 v[148:151], v[232:235], a[92:95], v[148:151]
    v_cvt_pk_bf16_f32 v48, v48, v49
    v_cvt_pk_bf16_f32 v49, v50, v51
    v_mfma_f32_16x16x32_bf16 v[152:155], v[236:239], a[88:91], v[152:155]
    v_cvt_pk_bf16_f32 v50, v52, v53
    v_cvt_pk_bf16_f32 v51, v54, v55
    v_mfma_f32_16x16x32_bf16 v[156:159], v[236:239], a[92:95], v[156:159]
    buffer_store_dwordx4 v[48:51], v3, s[24:27], s48 offen offset:2048 sc1
    v_fma_f32 v56, v56, v13, -v12
    v_mfma_f32_16x16x32_bf16 v[160:163], v[240:243], a[88:91], v[160:163]
    v_fma_f32 v57, v57, v15, -v14
    v_fma_f32 v58, v58, v17, -v16
    v_mfma_f32_16x16x32_bf16 v[164:167], v[240:243], a[92:95], v[164:167]
    v_fma_f32 v59, v59, v19, -v18
    v_mfma_f32_16x16x32_bf16 v[168:171], v[244:247], a[88:91], v[168:171]
    v_fma_f32 v60, v60, v249, -v248
    v_fma_f32 v61, v61, v251, -v250
    v_mfma_f32_16x16x32_bf16 v[172:175], v[244:247], a[92:95], v[172:175]
    v_fma_f32 v62, v62, v253, -v252
    s_waitcnt lgkmcnt(0)
    v_mfma_f32_16x16x32_bf16 v[104:107], v[176:179], a[96:99], v[104:107]
    ds_read_b128 v[212:215], v11 offset:27648
    v_mfma_f32_16x16x32_bf16 v[108:111], v[176:179], a[100:103], v[108:111]
    ds_read_b128 v[216:219], v11 offset:28672
    v_mfma_f32_16x16x32_bf16 v[112:115], v[180:183], a[96:99], v[112:115]
    ds_read_b128 v[220:223], v11 offset:29696
    v_mfma_f32_16x16x32_bf16 v[116:119], v[180:183], a[100:103], v[116:119]
    v_add_u32 v1, s55, v3
    s_add_u32 s55, s55, 1024
    buffer_load_dwordx4 a[8:11], v1, s[76:79], s81 offen sc1
    v_mfma_f32_16x16x32_bf16 v[120:123], v[184:187], a[96:99], v[120:123]
    ds_read_b128 v[224:227], v11 offset:30720
    v_fma_f32 v63, v63, v255, -v254
    v_mfma_f32_16x16x32_bf16 v[124:127], v[184:187], a[100:103], v[124:127]
    ds_read_b128 v[228:231], v11 offset:31744
    v_cvt_pk_bf16_f32 v56, v56, v57
    v_mfma_f32_16x16x32_bf16 v[128:131], v[188:191], a[96:99], v[128:131]
    ds_read_b128 v[232:235], v11 offset:32768
    v_cvt_pk_bf16_f32 v57, v58, v59
    v_mfma_f32_16x16x32_bf16 v[132:135], v[188:191], a[100:103], v[132:135]
    v_cvt_pk_bf16_f32 v58, v60, v61
    v_cvt_pk_bf16_f32 v59, v62, v63
    v_mfma_f32_16x16x32_bf16 v[136:139], v[192:195], a[96:99], v[136:139]
    ds_read_b128 v[236:239], v11 offset:33792
    buffer_store_dwordx4 v[56:59], v3, s[24:27], s48 offen offset:3072 sc1
    v_mfma_f32_16x16x32_bf16 v[140:143], v[192:195], a[100:103], v[140:143]
    ds_read_b128 v[240:243], v11 offset:34816
    v_fma_f32 v64, v64, v13, -v12
    v_mfma_f32_16x16x32_bf16 v[144:147], v[196:199], a[96:99], v[144:147]
    ds_read_b128 v[244:247], v11 offset:35840
    v_fma_f32 v65, v65, v15, -v14
    v_mfma_f32_16x16x32_bf16 v[148:151], v[196:199], a[100:103], v[148:151]
    v_fma_f32 v66, v66, v17, -v16
    v_fma_f32 v67, v67, v19, -v18
    v_mfma_f32_16x16x32_bf16 v[152:155], v[200:203], a[96:99], v[152:155]
    v_fma_f32 v68, v68, v249, -v248
    v_fma_f32 v69, v69, v251, -v250
    v_mfma_f32_16x16x32_bf16 v[156:159], v[200:203], a[100:103], v[156:159]
    v_fma_f32 v70, v70, v253, -v252
    v_fma_f32 v71, v71, v255, -v254
    v_mfma_f32_16x16x32_bf16 v[160:163], v[204:207], a[96:99], v[160:163]
    v_cvt_pk_bf16_f32 v64, v64, v65
    v_cvt_pk_bf16_f32 v65, v66, v67
    v_mfma_f32_16x16x32_bf16 v[164:167], v[204:207], a[100:103], v[164:167]
    v_cvt_pk_bf16_f32 v66, v68, v69
    v_cvt_pk_bf16_f32 v67, v70, v71
    v_mfma_f32_16x16x32_bf16 v[168:171], v[208:211], a[96:99], v[168:171]
    buffer_store_dwordx4 v[64:67], v4, s[24:27], s48 offen offset:0 sc1
    v_fma_f32 v72, v72, v13, -v12
    v_mfma_f32_16x16x32_bf16 v[172:175], v[208:211], a[100:103], v[172:175]
    v_fma_f32 v73, v73, v15, -v14
    v_fma_f32 v74, v74, v17, -v16
    v_fma_f32 v75, v75, v19, -v18
    v_fma_f32 v76, v76, v249, -v248
    s_waitcnt vmcnt(22) lgkmcnt(0)
    s_barrier
    v_mfma_f32_16x16x32_bf16 v[104:107], v[212:215], a[104:107], v[104:107]
    ds_read_b128 v[176:179], v8 offset:0
    buffer_load_dwordx4 a[12:15], v1, s[76:79], s82 offen sc1
    v_mfma_f32_16x16x32_bf16 v[108:111], v[212:215], a[108:111], v[108:111]
    ds_read_b128 v[180:183], v8 offset:1024
    buffer_load_dwordx4 a[16:19], v1, s[76:79], s83 offen sc1
    v_mfma_f32_16x16x32_bf16 v[112:115], v[216:219], a[104:107], v[112:115]
    ds_read_b128 v[184:187], v8 offset:2048
    v_fma_f32 v77, v77, v251, -v250
    v_mfma_f32_16x16x32_bf16 v[116:119], v[216:219], a[108:111], v[116:119]
    v_fma_f32 v78, v78, v253, -v252
    v_fma_f32 v79, v79, v255, -v254
    v_mfma_f32_16x16x32_bf16 v[120:123], v[220:223], a[104:107], v[120:123]
    ds_read_b128 v[188:191], v8 offset:3072
    v_cvt_pk_bf16_f32 v72, v72, v73
    v_mfma_f32_16x16x32_bf16 v[124:127], v[220:223], a[108:111], v[124:127]
    ds_read_b128 v[192:195], v8 offset:4096
    v_cvt_pk_bf16_f32 v73, v74, v75
    v_mfma_f32_16x16x32_bf16 v[128:131], v[224:227], a[104:107], v[128:131]
    ds_read_b128 v[196:199], v8 offset:5120
    v_cvt_pk_bf16_f32 v74, v76, v77
    v_mfma_f32_16x16x32_bf16 v[132:135], v[224:227], a[108:111], v[132:135]
    v_cvt_pk_bf16_f32 v75, v78, v79
    buffer_store_dwordx4 v[72:75], v4, s[24:27], s48 offen offset:1024 sc1
    v_mfma_f32_16x16x32_bf16 v[136:139], v[228:231], a[104:107], v[136:139]
    ds_read_b128 v[200:203], v8 offset:6144
    v_fma_f32 v80, v80, v13, -v12
    v_mfma_f32_16x16x32_bf16 v[140:143], v[228:231], a[108:111], v[140:143]
    ds_read_b128 v[204:207], v8 offset:7168
    v_fma_f32 v81, v81, v15, -v14
    v_mfma_f32_16x16x32_bf16 v[144:147], v[232:235], a[104:107], v[144:147]
    ds_read_b128 v[208:211], v8 offset:8192
    v_fma_f32 v82, v82, v17, -v16
    v_mfma_f32_16x16x32_bf16 v[148:151], v[232:235], a[108:111], v[148:151]
    v_fma_f32 v83, v83, v19, -v18
    v_fma_f32 v84, v84, v249, -v248
    v_mfma_f32_16x16x32_bf16 v[152:155], v[236:239], a[104:107], v[152:155]
    v_fma_f32 v85, v85, v251, -v250
    v_fma_f32 v86, v86, v253, -v252
    v_mfma_f32_16x16x32_bf16 v[156:159], v[236:239], a[108:111], v[156:159]
    v_fma_f32 v87, v87, v255, -v254
    v_cvt_pk_bf16_f32 v80, v80, v81
    v_mfma_f32_16x16x32_bf16 v[160:163], v[240:243], a[104:107], v[160:163]
    v_cvt_pk_bf16_f32 v81, v82, v83
    v_cvt_pk_bf16_f32 v82, v84, v85
    v_mfma_f32_16x16x32_bf16 v[164:167], v[240:243], a[108:111], v[164:167]
    v_cvt_pk_bf16_f32 v83, v86, v87
    v_mfma_f32_16x16x32_bf16 v[168:171], v[244:247], a[104:107], v[168:171]
    buffer_store_dwordx4 v[80:83], v4, s[24:27], s48 offen offset:2048 sc1
    v_fma_f32 v88, v88, v13, -v12
    v_mfma_f32_16x16x32_bf16 v[172:175], v[244:247], a[108:111], v[172:175]
    v_fma_f32 v89, v89, v15, -v14
    s_waitcnt lgkmcnt(0)
    v_mfma_f32_16x16x32_bf16 v[104:107], v[176:179], a[112:115], v[104:107]
    ds_read_b128 v[212:215], v8 offset:9216
    buffer_load_dwordx4 a[20:23], v1, s[76:79], s84 offen sc1
    v_mfma_f32_16x16x32_bf16 v[108:111], v[176:179], a[116:119], v[108:111]
    ds_read_b128 v[216:219], v8 offset:10240
    buffer_load_dwordx4 a[24:27], v1, s[76:79], s85 offen sc1
    v_mfma_f32_16x16x32_bf16 v[112:115], v[180:183], a[112:115], v[112:115]
    ds_read_b128 v[220:223], v8 offset:11264
    v_fma_f32 v90, v90, v17, -v16
    v_mfma_f32_16x16x32_bf16 v[116:119], v[180:183], a[116:119], v[116:119]
    v_fma_f32 v91, v91, v19, -v18
    v_fma_f32 v92, v92, v249, -v248
    v_mfma_f32_16x16x32_bf16 v[120:123], v[184:187], a[112:115], v[120:123]
    ds_read_b128 v[224:227], v8 offset:12288
    v_fma_f32 v93, v93, v251, -v250
    v_mfma_f32_16x16x32_bf16 v[124:127], v[184:187], a[116:119], v[124:127]
    ds_read_b128 v[228:231], v8 offset:13312
    v_fma_f32 v94, v94, v253, -v252
    v_mfma_f32_16x16x32_bf16 v[128:131], v[188:191], a[112:115], v[128:131]
    ds_read_b128 v[232:235], v8 offset:14336
    v_fma_f32 v95, v95, v255, -v254
    v_mfma_f32_16x16x32_bf16 v[132:135], v[188:191], a[116:119], v[132:135]
    v_cvt_pk_bf16_f32 v88, v88, v89
    v_cvt_pk_bf16_f32 v89, v90, v91
    v_mfma_f32_16x16x32_bf16 v[136:139], v[192:195], a[112:115], v[136:139]
    ds_read_b128 v[236:239], v8 offset:15360
    v_cvt_pk_bf16_f32 v90, v92, v93
    v_mfma_f32_16x16x32_bf16 v[140:143], v[192:195], a[116:119], v[140:143]
    ds_read_b128 v[240:243], v8 offset:16384
    v_cvt_pk_bf16_f32 v91, v94, v95
    v_mfma_f32_16x16x32_bf16 v[144:147], v[196:199], a[112:115], v[144:147]
    ds_read_b128 v[244:247], v8 offset:17408
    buffer_store_dwordx4 v[88:91], v4, s[24:27], s48 offen offset:3072 sc1
    v_mfma_f32_16x16x32_bf16 v[148:151], v[196:199], a[116:119], v[148:151]
    v_fma_f32 v96, v96, v13, -v12
    v_fma_f32 v97, v97, v15, -v14
    v_mfma_f32_16x16x32_bf16 v[152:155], v[200:203], a[112:115], v[152:155]
    v_fma_f32 v98, v98, v17, -v16
    v_fma_f32 v99, v99, v19, -v18
    v_mfma_f32_16x16x32_bf16 v[156:159], v[200:203], a[116:119], v[156:159]
    v_fma_f32 v100, v100, v249, -v248
    v_fma_f32 v101, v101, v251, -v250
    v_mfma_f32_16x16x32_bf16 v[160:163], v[204:207], a[112:115], v[160:163]
    v_fma_f32 v102, v102, v253, -v252
    v_fma_f32 v103, v103, v255, -v254
    v_mfma_f32_16x16x32_bf16 v[164:167], v[204:207], a[116:119], v[164:167]
    v_cvt_pk_bf16_f32 v96, v96, v97
    v_cvt_pk_bf16_f32 v97, v98, v99
    v_mfma_f32_16x16x32_bf16 v[168:171], v[208:211], a[112:115], v[168:171]
    v_cvt_pk_bf16_f32 v98, v100, v101
    v_cvt_pk_bf16_f32 v99, v102, v103
    v_mfma_f32_16x16x32_bf16 v[172:175], v[208:211], a[116:119], v[172:175]
    buffer_store_dwordx4 v[96:99], v5, s[24:27], s48 offen offset:0 sc1
    s_waitcnt lgkmcnt(0)
    v_mfma_f32_16x16x32_bf16 v[104:107], v[212:215], a[120:123], v[104:107]
    ds_read_b128 v[176:179], v8 offset:18432
    v_mfma_f32_16x16x32_bf16 v[108:111], v[212:215], a[124:127], v[108:111]
    ds_read_b128 v[180:183], v8 offset:19456
    v_mfma_f32_16x16x32_bf16 v[112:115], v[216:219], a[120:123], v[112:115]
    ds_read_b128 v[184:187], v8 offset:20480
    v_mfma_f32_16x16x32_bf16 v[116:119], v[216:219], a[124:127], v[116:119]
    v_mfma_f32_16x16x32_bf16 v[120:123], v[220:223], a[120:123], v[120:123]
    ds_read_b128 v[188:191], v8 offset:21504
    v_mfma_f32_16x16x32_bf16 v[124:127], v[220:223], a[124:127], v[124:127]
    ds_read_b128 v[192:195], v8 offset:22528
    v_mfma_f32_16x16x32_bf16 v[128:131], v[224:227], a[120:123], v[128:131]
    ds_read_b128 v[196:199], v8 offset:23552
    v_mfma_f32_16x16x32_bf16 v[132:135], v[224:227], a[124:127], v[132:135]
    v_mfma_f32_16x16x32_bf16 v[136:139], v[228:231], a[120:123], v[136:139]
    ds_read_b128 v[200:203], v8 offset:24576
    v_mfma_f32_16x16x32_bf16 v[140:143], v[228:231], a[124:127], v[140:143]
    ds_read_b128 v[204:207], v8 offset:25600
    v_mfma_f32_16x16x32_bf16 v[144:147], v[232:235], a[120:123], v[144:147]
    ds_read_b128 v[208:211], v8 offset:26624
    v_mfma_f32_16x16x32_bf16 v[148:151], v[232:235], a[124:127], v[148:151]
    v_add_u32 v1, s55, v3
    s_add_u32 s55, s55, 1024
    buffer_load_dwordx4 a[28:31], v1, s[76:79], s81 offen sc1
    v_mfma_f32_16x16x32_bf16 v[152:155], v[236:239], a[120:123], v[152:155]
    v_mfma_f32_16x16x32_bf16 v[156:159], v[236:239], a[124:127], v[156:159]
    v_mfma_f32_16x16x32_bf16 v[160:163], v[240:243], a[120:123], v[160:163]
    v_mfma_f32_16x16x32_bf16 v[164:167], v[240:243], a[124:127], v[164:167]
    v_mfma_f32_16x16x32_bf16 v[168:171], v[244:247], a[120:123], v[168:171]
    v_mfma_f32_16x16x32_bf16 v[172:175], v[244:247], a[124:127], v[172:175]
    s_waitcnt lgkmcnt(0)
    v_mfma_f32_16x16x32_bf16 v[104:107], v[176:179], a[128:131], v[104:107]
    ds_read_b128 v[212:215], v8 offset:27648
    v_mfma_f32_16x16x32_bf16 v[108:111], v[176:179], a[132:135], v[108:111]
    ds_read_b128 v[216:219], v8 offset:28672
    v_mfma_f32_16x16x32_bf16 v[112:115], v[180:183], a[128:131], v[112:115]
    ds_read_b128 v[220:223], v8 offset:29696
    v_mfma_f32_16x16x32_bf16 v[116:119], v[180:183], a[132:135], v[116:119]
    v_mfma_f32_16x16x32_bf16 v[120:123], v[184:187], a[128:131], v[120:123]
    ds_read_b128 v[224:227], v8 offset:30720
    buffer_load_dwordx4 a[32:35], v1, s[76:79], s82 offen sc1
    v_mfma_f32_16x16x32_bf16 v[124:127], v[184:187], a[132:135], v[124:127]
    ds_read_b128 v[228:231], v8 offset:31744
    v_mfma_f32_16x16x32_bf16 v[128:131], v[188:191], a[128:131], v[128:131]
    ds_read_b128 v[232:235], v8 offset:32768
    v_mfma_f32_16x16x32_bf16 v[132:135], v[188:191], a[132:135], v[132:135]
    v_mfma_f32_16x16x32_bf16 v[136:139], v[192:195], a[128:131], v[136:139]
    ds_read_b128 v[236:239], v8 offset:33792
    v_mfma_f32_16x16x32_bf16 v[140:143], v[192:195], a[132:135], v[140:143]
    ds_read_b128 v[240:243], v8 offset:34816
    v_mfma_f32_16x16x32_bf16 v[144:147], v[196:199], a[128:131], v[144:147]
    ds_read_b128 v[244:247], v8 offset:35840
    v_mfma_f32_16x16x32_bf16 v[148:151], v[196:199], a[132:135], v[148:151]
    v_mfma_f32_16x16x32_bf16 v[152:155], v[200:203], a[128:131], v[152:155]
    v_mfma_f32_16x16x32_bf16 v[156:159], v[200:203], a[132:135], v[156:159]
    buffer_load_dwordx4 a[36:39], v1, s[76:79], s83 offen sc1
    v_mfma_f32_16x16x32_bf16 v[160:163], v[204:207], a[128:131], v[160:163]
    v_mfma_f32_16x16x32_bf16 v[164:167], v[204:207], a[132:135], v[164:167]
    v_mfma_f32_16x16x32_bf16 v[168:171], v[208:211], a[128:131], v[168:171]
    v_mfma_f32_16x16x32_bf16 v[172:175], v[208:211], a[132:135], v[172:175]
    s_waitcnt lgkmcnt(0)
    v_mfma_f32_16x16x32_bf16 v[104:107], v[212:215], a[136:139], v[104:107]
    v_mfma_f32_16x16x32_bf16 v[108:111], v[212:215], a[140:143], v[108:111]
    v_mfma_f32_16x16x32_bf16 v[112:115], v[216:219], a[136:139], v[112:115]
    v_mfma_f32_16x16x32_bf16 v[116:119], v[216:219], a[140:143], v[116:119]
    v_mfma_f32_16x16x32_bf16 v[120:123], v[220:223], a[136:139], v[120:123]
    buffer_load_dwordx4 a[40:43], v1, s[76:79], s84 offen sc1
    v_mfma_f32_16x16x32_bf16 v[124:127], v[220:223], a[140:143], v[124:127]
    v_mfma_f32_16x16x32_bf16 v[128:131], v[224:227], a[136:139], v[128:131]
    v_mfma_f32_16x16x32_bf16 v[132:135], v[224:227], a[140:143], v[132:135]
    v_mfma_f32_16x16x32_bf16 v[136:139], v[228:231], a[136:139], v[136:139]
    v_mfma_f32_16x16x32_bf16 v[140:143], v[228:231], a[140:143], v[140:143]
    v_mfma_f32_16x16x32_bf16 v[144:147], v[232:235], a[136:139], v[144:147]
    v_mfma_f32_16x16x32_bf16 v[148:151], v[232:235], a[140:143], v[148:151]
    v_mfma_f32_16x16x32_bf16 v[152:155], v[236:239], a[136:139], v[152:155]
    v_mfma_f32_16x16x32_bf16 v[156:159], v[236:239], a[140:143], v[156:159]
    buffer_load_dwordx4 a[44:47], v1, s[76:79], s85 offen sc1
    v_mfma_f32_16x16x32_bf16 v[160:163], v[240:243], a[136:139], v[160:163]
    v_mfma_f32_16x16x32_bf16 v[164:167], v[240:243], a[140:143], v[164:167]
    v_mfma_f32_16x16x32_bf16 v[168:171], v[244:247], a[136:139], v[168:171]
    v_mfma_f32_16x16x32_bf16 v[172:175], v[244:247], a[140:143], v[172:175]
    v_lshrrev_b32 v6, 4, v2
    v_lshl_add_u32 v6, v6, 4, s42
    ds_read_b128 v[176:179], v6 offset:0
    ds_read_b128 v[180:183], v6 offset:64
    ds_read_b128 v[184:187], v6 offset:128
    ds_read_b128 v[188:191], v6 offset:192
    ds_read_b128 v[192:195], v6 offset:256
    ds_read_b128 v[196:199], v6 offset:320
    ds_read_b128 v[200:203], v6 offset:384
    ds_read_b128 v[204:207], v6 offset:448
    ds_read_b128 v[208:211], v6 offset:512
    s_waitcnt vmcnt(5)
    s_add_u32 s44, s8, 0x50000
    s_addc_u32 s45, s9, 0
    s_mov_b32 s46, 0x30000
    s_mov_b32 s47, 0x00020000
    s_barrier
    s_cmp_lg_u32 s34, 0
    s_cbranch_scc1 L_tf_36
    s_lshl_b32 s3, s33, 11
    s_lshl_b32 s10, s32, 7
    s_add_u32 s10, s10, s3
    s_add_u32 s10, s10, 131072
    v_lshlrev_b32 v1, 2, v2
    v_mov_b32 v6, s87
    s_mov_b32 exec_hi, 0
    buffer_store_dword v6, v1, s[44:47], s10 offen sc1
    s_mov_b64 exec, -1
L_tf_36:
    s_mov_b32 s72, s88
    s_mov_b32 s73, s89
    s_mov_b32 s74, 0x800000
    s_mov_b32 s75, 0x00020000
    s_lshl_b32 s3, s32, 7
    s_lshl_b32 s10, s34, 5
    s_add_u32 s3, s3, s10
    v_lshrrev_b32 v6, 5, v2
    v_lshlrev_b32 v6, 3, v6
    v_bfe_u32 v7, v2, 3, 2
    v_add3_u32 v6, v6, v7, s3
    v_lshlrev_b32 v6, 12, v6
    v_lshrrev_b32 v7, 4, v2
    v_and_b32 v1, 7, v2
    v_xor_b32 v7, v7, v1
    v_lshl_add_u32 v20, v7, 4, v6
    v_xor_b32 v21, 64, v20
    v_add_u32 v224, 0x0, v20
    v_add_u32 v225, 0xfc00, v21
    v_add_u32 v226, 0x3800, v20
    v_add_u32 v227, 0x13400, v21
    s_lshl_b32 s3, s34, 12
    s_add_u32 s92, s3, 0x4800
    s_add_u32 s93, s3, 0xd000
    s_add_u32 s94, s3, 0x15800
    s_add_u32 s95, s3, 0x1e000
    s_mov_b32 s71, 0
    s_waitcnt lgkmcnt(0)
    v_pk_fma_f32 v[104:105], v[104:105], v[22:23], v[176:177] op_sel_hi:[1,0,1]
    v_pk_fma_f32 v[106:107], v[106:107], v[22:23], v[178:179] op_sel_hi:[1,0,1]
    v_pk_mul_f32 v[236:237], v[104:105], v[104:105]
    v_pk_mul_f32 v[238:239], v[106:107], v[106:107]
    v_pk_fma_f32 v[236:237], v[236:237], v[26:27], v[24:25]
    v_pk_fma_f32 v[238:239], v[238:239], v[26:27], v[24:25]
    v_pk_mul_f32 v[236:237], v[236:237], v[104:105]
    s_mov_b32 m0, s92
    s_nop 0
    buffer_load_dwordx4 v224, s[72:75], s71 offen lds
    v_pk_mul_f32 v[238:239], v[238:239], v[106:107]
    v_exp_f32 v236, v236
    v_exp_f32 v237, v237
    v_exp_f32 v238, v238
    v_exp_f32 v239, v239
    v_pk_add_f32 v[236:237], v[236:237], 1.0 op_sel_hi:[1,0]
    v_pk_add_f32 v[238:239], v[238:239], 1.0 op_sel_hi:[1,0]
    buffer_load_dwordx4 v225, s[72:75], s71 offen offset:1024 lds
    v_rcp_f32 v236, v236
    v_rcp_f32 v237, v237
    v_rcp_f32 v238, v238
    v_rcp_f32 v239, v239
    v_pk_mul_f32 v[104:105], v[104:105], v[236:237]
    v_pk_mul_f32 v[106:107], v[106:107], v[238:239]
    v_pk_fma_f32 v[108:109], v[108:109], v[22:23], v[176:177] op_sel:[0,1,0] op_sel_hi:[1,1,1]
    buffer_load_dwordx4 v226, s[72:75], s71 offen offset:2048 lds
    v_pk_fma_f32 v[110:111], v[110:111], v[22:23], v[178:179] op_sel:[0,1,0] op_sel_hi:[1,1,1]
    v_pk_mul_f32 v[240:241], v[108:109], v[108:109]
    v_pk_mul_f32 v[242:243], v[110:111], v[110:111]
    v_pk_fma_f32 v[240:241], v[240:241], v[26:27], v[24:25]
    v_pk_fma_f32 v[242:243], v[242:243], v[26:27], v[24:25]
    v_pk_mul_f32 v[240:241], v[240:241], v[108:109]
    v_pk_mul_f32 v[242:243], v[242:243], v[110:111]
    buffer_load_dwordx4 v227, s[72:75], s71 offen offset:3072 lds
    s_add_u32 s71, s71, 128
    v_exp_f32 v240, v240
    v_exp_f32 v241, v241
    v_exp_f32 v242, v242
    v_exp_f32 v243, v243
    v_pk_add_f32 v[240:241], v[240:241], 1.0 op_sel_hi:[1,0]
    v_pk_add_f32 v[242:243], v[242:243], 1.0 op_sel_hi:[1,0]
    v_rcp_f32 v240, v240
    s_mov_b32 m0, s93
    s_nop 0
    buffer_load_dwordx4 v224, s[72:75], s71 offen lds
    v_rcp_f32 v241, v241
    v_rcp_f32 v242, v242
    v_rcp_f32 v243, v243
    v_pk_mul_f32 v[108:109], v[108:109], v[240:241]
    v_pk_mul_f32 v[110:111], v[110:111], v[242:243]
    v_cvt_pk_bf16_f32 v28, v104, v105
    v_cvt_pk_bf16_f32 v29, v106, v107
    buffer_load_dwordx4 v225, s[72:75], s71 offen offset:1024 lds
    v_cvt_pk_bf16_f32 v30, v108, v109
    v_cvt_pk_bf16_f32 v31, v110, v111
    v_pk_fma_f32 v[112:113], v[112:113], v[22:23], v[180:181] op_sel_hi:[1,0,1]
    v_pk_fma_f32 v[114:115], v[114:115], v[22:23], v[182:183] op_sel_hi:[1,0,1]
    v_pk_mul_f32 v[236:237], v[112:113], v[112:113]
    v_pk_mul_f32 v[238:239], v[114:115], v[114:115]
    v_pk_fma_f32 v[236:237], v[236:237], v[26:27], v[24:25]
    buffer_load_dwordx4 v226, s[72:75], s71 offen offset:2048 lds
    v_pk_fma_f32 v[238:239], v[238:239], v[26:27], v[24:25]
    v_pk_mul_f32 v[236:237], v[236:237], v[112:113]
    v_pk_mul_f32 v[238:239], v[238:239], v[114:115]
    v_exp_f32 v236, v236
    v_exp_f32 v237, v237
    v_exp_f32 v238, v238
    v_exp_f32 v239, v239
    buffer_load_dwordx4 v227, s[72:75], s71 offen offset:3072 lds
    s_add_u32 s71, s71, 128
    v_pk_add_f32 v[236:237], v[236:237], 1.0 op_sel_hi:[1,0]
    v_pk_add_f32 v[238:239], v[238:239], 1.0 op_sel_hi:[1,0]
    v_rcp_f32 v236, v236
    v_rcp_f32 v237, v237
    v_rcp_f32 v238, v238
    v_rcp_f32 v239, v239
    v_pk_mul_f32 v[112:113], v[112:113], v[236:237]
    s_mov_b32 m0, s94
    s_nop 0
    buffer_load_dwordx4 v224, s[72:75], s71 offen lds
    v_pk_mul_f32 v[114:115], v[114:115], v[238:239]
    v_pk_fma_f32 v[116:117], v[116:117], v[22:23], v[180:181] op_sel:[0,1,0] op_sel_hi:[1,1,1]
    v_pk_fma_f32 v[118:119], v[118:119], v[22:23], v[182:183] op_sel:[0,1,0] op_sel_hi:[1,1,1]
    v_pk_mul_f32 v[240:241], v[116:117], v[116:117]
    v_pk_mul_f32 v[242:243], v[118:119], v[118:119]
    v_pk_fma_f32 v[240:241], v[240:241], v[26:27], v[24:25]
    v_pk_fma_f32 v[242:243], v[242:243], v[26:27], v[24:25]
    buffer_load_dwordx4 v225, s[72:75], s71 offen offset:1024 lds
    v_pk_mul_f32 v[240:241], v[240:241], v[116:117]
    v_pk_mul_f32 v[242:243], v[242:243], v[118:119]
    v_exp_f32 v240, v240
    v_exp_f32 v241, v241
    v_exp_f32 v242, v242
    v_exp_f32 v243, v243
    v_pk_add_f32 v[240:241], v[240:241], 1.0 op_sel_hi:[1,0]
    buffer_load_dwordx4 v226, s[72:75], s71 offen offset:2048 lds
    v_pk_add_f32 v[242:243], v[242:243], 1.0 op_sel_hi:[1,0]
    v_rcp_f32 v240, v240
    v_rcp_f32 v241, v241
    v_rcp_f32 v242, v242
    v_rcp_f32 v243, v243
    v_pk_mul_f32 v[116:117], v[116:117], v[240:241]
    v_pk_mul_f32 v[118:119], v[118:119], v[242:243]
    buffer_load_dwordx4 v227, s[72:75], s71 offen offset:3072 lds
    s_add_u32 s71, s71, 128
    v_cvt_pk_bf16_f32 v32, v112, v113
    v_cvt_pk_bf16_f32 v33, v114, v115
    v_cvt_pk_bf16_f32 v34, v116, v117
    v_cvt_pk_bf16_f32 v35, v118, v119
    v_pk_fma_f32 v[120:121], v[120:121], v[22:23], v[184:185] op_sel_hi:[1,0,1]
    v_pk_fma_f32 v[122:123], v[122:123], v[22:23], v[186:187] op_sel_hi:[1,0,1]
    v_pk_mul_f32 v[236:237], v[120:121], v[120:121]
    v_pk_mul_f32 v[238:239], v[122:123], v[122:123]
    v_pk_fma_f32 v[236:237], v[236:237], v[26:27], v[24:25]
    v_pk_fma_f32 v[238:239], v[238:239], v[26:27], v[24:25]
    v_pk_mul_f32 v[236:237], v[236:237], v[120:121]
    v_pk_mul_f32 v[238:239], v[238:239], v[122:123]
    v_exp_f32 v236, v236
    v_exp_f32 v237, v237
    v_exp_f32 v238, v238
    v_exp_f32 v239, v239
    v_pk_add_f32 v[236:237], v[236:237], 1.0 op_sel_hi:[1,0]
    v_pk_add_f32 v[238:239], v[238:239], 1.0 op_sel_hi:[1,0]
    v_rcp_f32 v236, v236
    v_rcp_f32 v237, v237
    v_rcp_f32 v238, v238
    v_rcp_f32 v239, v239
    v_pk_mul_f32 v[120:121], v[120:121], v[236:237]
    v_pk_mul_f32 v[122:123], v[122:123], v[238:239]
    v_pk_fma_f32 v[124:125], v[124:125], v[22:23], v[184:185] op_sel:[0,1,0] op_sel_hi:[1,1,1]
    v_pk_fma_f32 v[126:127], v[126:127], v[22:23], v[186:187] op_sel:[0,1,0] op_sel_hi:[1,1,1]
    v_pk_mul_f32 v[240:241], v[124:125], v[124:125]
    v_pk_mul_f32 v[242:243], v[126:127], v[126:127]
    v_pk_fma_f32 v[240:241], v[240:241], v[26:27], v[24:25]
    v_pk_fma_f32 v[242:243], v[242:243], v[26:27], v[24:25]
    v_pk_mul_f32 v[240:241], v[240:241], v[124:125]
    v_pk_mul_f32 v[242:243], v[242:243], v[126:127]
    v_exp_f32 v240, v240
    v_exp_f32 v241, v241
    v_exp_f32 v242, v242
    v_exp_f32 v243, v243
    v_pk_add_f32 v[240:241], v[240:241], 1.0 op_sel_hi:[1,0]
    v_pk_add_f32 v[242:243], v[242:243], 1.0 op_sel_hi:[1,0]
    v_rcp_f32 v240, v240
    v_rcp_f32 v241, v241
    v_rcp_f32 v242, v242
    v_rcp_f32 v243, v243
    v_pk_mul_f32 v[124:125], v[124:125], v[240:241]
    v_pk_mul_f32 v[126:127], v[126:127], v[242:243]
    v_cvt_pk_bf16_f32 v36, v120, v121
    v_cvt_pk_bf16_f32 v37, v122, v123
    v_cvt_pk_bf16_f32 v38, v124, v125
    v_cvt_pk_bf16_f32 v39, v126, v127
    v_pk_fma_f32 v[128:129], v[128:129], v[22:23], v[188:189] op_sel_hi:[1,0,1]
    v_pk_fma_f32 v[130:131], v[130:131], v[22:23], v[190:191] op_sel_hi:[1,0,1]
    v_pk_mul_f32 v[236:237], v[128:129], v[128:129]
    v_pk_mul_f32 v[238:239], v[130:131], v[130:131]
    v_pk_fma_f32 v[236:237], v[236:237], v[26:27], v[24:25]
    v_pk_fma_f32 v[238:239], v[238:239], v[26:27], v[24:25]
    v_pk_mul_f32 v[236:237], v[236:237], v[128:129]
    v_pk_mul_f32 v[238:239], v[238:239], v[130:131]
    v_exp_f32 v236, v236
    v_exp_f32 v237, v237
    v_exp_f32 v238, v238
    v_exp_f32 v239, v239
    v_pk_add_f32 v[236:237], v[236:237], 1.0 op_sel_hi:[1,0]
    v_pk_add_f32 v[238:239], v[238:239], 1.0 op_sel_hi:[1,0]
    v_rcp_f32 v236, v236
    v_rcp_f32 v237, v237
    v_rcp_f32 v238, v238
    v_rcp_f32 v239, v239
    v_pk_mul_f32 v[128:129], v[128:129], v[236:237]
    v_pk_mul_f32 v[130:131], v[130:131], v[238:239]
    s_add_u32 s16, s8, 0xd20000
    s_addc_u32 s17, s9, 0
    s_mov_b32 s18, 0x900000
    s_mov_b32 s19, 0x00020000
    s_add_u32 s24, s8, 0x1620000
    s_addc_u32 s25, s9, 0
    s_mov_b32 s26, 0x900000
    s_mov_b32 s27, 0x00020000
    s_mov_b32 s28, s90
    s_mov_b32 s29, s91
    s_mov_b32 s30, 0x1000
    s_mov_b32 s31, 0x00020000
    v_add_u32 v8, 0x0, v3
    v_add_u32 v9, 0x8800, v3
    v_add_u32 v10, 0x11000, v3
    v_add_u32 v11, 0x19800, v3
    v_and_b32 v6, 15, v2
    v_lshrrev_b32 v7, 4, v2
    v_lshrrev_b32 v1, 1, v6
    v_xor_b32 v1, v1, v7
    v_lshlrev_b32 v1, 4, v1
    v_lshl_add_u32 v1, v6, 7, v1
    v_add_u32 v12, s92, v1
    v_xor_b32 v16, 64, v12
    v_add_u32 v13, s93, v1
    v_xor_b32 v17, 64, v13
    v_add_u32 v14, s94, v1
    v_xor_b32 v18, 64, v14
    v_add_u32 v15, s95, v1
    v_xor_b32 v19, 64, v15
    s_lshl_b32 s3, s32, 8
    s_lshl_b32 s10, s34, 6
    s_add_u32 s3, s3, s10
    v_lshrrev_b32 v1, 2, v6
    v_lshlrev_b32 v1, 3, v1
    v_and_b32 v6, 3, v6
    v_add_lshl_u32 v1, v1, v6, 1
    buffer_load_ushort v20, v1, s[28:31], s3 offen
    buffer_load_ushort v21, v1, s[28:31], s3 offen offset:8
    s_mul_i32 s38, s34, 5
    s_min_u32 s38, s38, 14
    s_lshl_b32 s38, s38, 10
    s_mul_i32 s36, s33, 589824
    s_add_u32 s36, s36, s38
    s_add_u32 s40, s38, 0x0
    s_add_u32 s41, s38, 0x8800
    s_add_u32 s42, s38, 0x11000
    s_add_u32 s43, s38, 0x19800
    v_and_b32 v7, 15, v2
    v_lshlrev_b32 v7, 7, v7
    s_lshl_b32 s39, s33, 11
    s_add_u32 s39, s39, 131072
    buffer_load_dword v6, v7, s[44:47], s39 offen sc1
    v_pk_fma_f32 v[132:133], v[132:133], v[22:23], v[188:189] op_sel:[0,1,0] op_sel_hi:[1,1,1]
    v_pk_fma_f32 v[134:135], v[134:135], v[22:23], v[190:191] op_sel:[0,1,0] op_sel_hi:[1,1,1]
    v_pk_mul_f32 v[240:241], v[132:133], v[132:133]
    v_pk_mul_f32 v[242:243], v[134:135], v[134:135]
    v_pk_fma_f32 v[240:241], v[240:241], v[26:27], v[24:25]
    v_pk_fma_f32 v[242:243], v[242:243], v[26:27], v[24:25]
    v_pk_mul_f32 v[240:241], v[240:241], v[132:133]
    v_pk_mul_f32 v[242:243], v[242:243], v[134:135]
    v_exp_f32 v240, v240
    v_exp_f32 v241, v241
    v_exp_f32 v242, v242
    v_exp_f32 v243, v243
    v_pk_add_f32 v[240:241], v[240:241], 1.0 op_sel_hi:[1,0]
    v_pk_add_f32 v[242:243], v[242:243], 1.0 op_sel_hi:[1,0]
    v_rcp_f32 v240, v240
    v_rcp_f32 v241, v241
    v_rcp_f32 v242, v242
    v_rcp_f32 v243, v243
    v_pk_mul_f32 v[132:133], v[132:133], v[240:241]
    v_pk_mul_f32 v[134:135], v[134:135], v[242:243]
    v_cvt_pk_bf16_f32 v40, v128, v129
    v_cvt_pk_bf16_f32 v41, v130, v131
    v_cvt_pk_bf16_f32 v42, v132, v133
    v_cvt_pk_bf16_f32 v43, v134, v135
    v_pk_fma_f32 v[136:137], v[136:137], v[22:23], v[192:193] op_sel_hi:[1,0,1]
    v_pk_fma_f32 v[138:139], v[138:139], v[22:23], v[194:195] op_sel_hi:[1,0,1]
    v_pk_mul_f32 v[236:237], v[136:137], v[136:137]
    v_pk_mul_f32 v[238:239], v[138:139], v[138:139]
    v_pk_fma_f32 v[236:237], v[236:237], v[26:27], v[24:25]
    v_pk_fma_f32 v[238:239], v[238:239], v[26:27], v[24:25]
    v_pk_mul_f32 v[236:237], v[236:237], v[136:137]
    v_pk_mul_f32 v[238:239], v[238:239], v[138:139]
    v_exp_f32 v236, v236
    v_exp_f32 v237, v237
    v_exp_f32 v238, v238
    v_exp_f32 v239, v239
    v_pk_add_f32 v[236:237], v[236:237], 1.0 op_sel_hi:[1,0]
    v_pk_add_f32 v[238:239], v[238:239], 1.0 op_sel_hi:[1,0]
    v_rcp_f32 v236, v236
    v_rcp_f32 v237, v237
    v_rcp_f32 v238, v238
    v_rcp_f32 v239, v239
    v_pk_mul_f32 v[136:137], v[136:137], v[236:237]
    v_pk_mul_f32 v[138:139], v[138:139], v[238:239]
    v_pk_fma_f32 v[140:141], v[140:141], v[22:23], v[192:193] op_sel:[0,1,0] op_sel_hi:[1,1,1]
    v_pk_fma_f32 v[142:143], v[142:143], v[22:23], v[194:195] op_sel:[0,1,0] op_sel_hi:[1,1,1]
    v_pk_mul_f32 v[240:241], v[140:141], v[140:141]
    v_pk_mul_f32 v[242:243], v[142:143], v[142:143]
    v_pk_fma_f32 v[240:241], v[240:241], v[26:27], v[24:25]
    v_pk_fma_f32 v[242:243], v[242:243], v[26:27], v[24:25]
    v_pk_mul_f32 v[240:241], v[240:241], v[140:141]
    v_pk_mul_f32 v[242:243], v[242:243], v[142:143]
    v_exp_f32 v240, v240
    v_exp_f32 v241, v241
    v_exp_f32 v242, v242
    v_exp_f32 v243, v243
    v_pk_add_f32 v[240:241], v[240:241], 1.0 op_sel_hi:[1,0]
    v_pk_add_f32 v[242:243], v[242:243], 1.0 op_sel_hi:[1,0]
    v_rcp_f32 v240, v240
    v_rcp_f32 v241, v241
    v_rcp_f32 v242, v242
    v_rcp_f32 v243, v243
    v_pk_mul_f32 v[140:141], v[140:141], v[240:241]
    v_pk_mul_f32 v[142:143], v[142:143], v[242:243]
    v_cvt_pk_bf16_f32 v44, v136, v137
    v_cvt_pk_bf16_f32 v45, v138, v139
    v_cvt_pk_bf16_f32 v46, v140, v141
    v_cvt_pk_bf16_f32 v47, v142, v143
    v_pk_fma_f32 v[144:145], v[144:145], v[22:23], v[196:197] op_sel_hi:[1,0,1]
    v_pk_fma_f32 v[146:147], v[146:147], v[22:23], v[198:199] op_sel_hi:[1,0,1]
    v_pk_mul_f32 v[236:237], v[144:145], v[144:145]
    v_pk_mul_f32 v[238:239], v[146:147], v[146:147]
    v_pk_fma_f32 v[236:237], v[236:237], v[26:27], v[24:25]
    v_pk_fma_f32 v[238:239], v[238:239], v[26:27], v[24:25]
    v_pk_mul_f32 v[236:237], v[236:237], v[144:145]
    v_pk_mul_f32 v[238:239], v[238:239], v[146:147]
    v_exp_f32 v236, v236
    v_exp_f32 v237, v237
    v_exp_f32 v238, v238
    v_exp_f32 v239, v239
    v_pk_add_f32 v[236:237], v[236:237], 1.0 op_sel_hi:[1,0]
    v_pk_add_f32 v[238:239], v[238:239], 1.0 op_sel_hi:[1,0]
    v_rcp_f32 v236, v236
    v_rcp_f32 v237, v237
    v_rcp_f32 v238, v238
    v_rcp_f32 v239, v239
    v_pk_mul_f32 v[144:145], v[144:145], v[236:237]
    v_pk_mul_f32 v[146:147], v[146:147], v[238:239]
    v_pk_fma_f32 v[148:149], v[148:149], v[22:23], v[196:197] op_sel:[0,1,0] op_sel_hi:[1,1,1]
    v_pk_fma_f32 v[150:151], v[150:151], v[22:23], v[198:199] op_sel:[0,1,0] op_sel_hi:[1,1,1]
    v_pk_mul_f32 v[240:241], v[148:149], v[148:149]
    v_pk_mul_f32 v[242:243], v[150:151], v[150:151]
    v_pk_fma_f32 v[240:241], v[240:241], v[26:27], v[24:25]
    v_pk_fma_f32 v[242:243], v[242:243], v[26:27], v[24:25]
    v_pk_mul_f32 v[240:241], v[240:241], v[148:149]
    v_pk_mul_f32 v[242:243], v[242:243], v[150:151]
    v_exp_f32 v240, v240
    v_exp_f32 v241, v241
    v_exp_f32 v242, v242
    v_exp_f32 v243, v243
    v_pk_add_f32 v[240:241], v[240:241], 1.0 op_sel_hi:[1,0]
    v_pk_add_f32 v[242:243], v[242:243], 1.0 op_sel_hi:[1,0]
    v_rcp_f32 v240, v240
    v_rcp_f32 v241, v241
    v_rcp_f32 v242, v242
    v_rcp_f32 v243, v243
    v_pk_mul_f32 v[148:149], v[148:149], v[240:241]
    v_pk_mul_f32 v[150:151], v[150:151], v[242:243]
    v_cvt_pk_bf16_f32 v48, v144, v145
    v_cvt_pk_bf16_f32 v49, v146, v147
    v_cvt_pk_bf16_f32 v50, v148, v149
    v_cvt_pk_bf16_f32 v51, v150, v151
    s_waitcnt vmcnt(0)
    v_cmp_ne_u32 vcc, s87, v6
    s_cbranch_vccz L_zok_37
    s_mov_b32 s70, 0x20000
L_poll_38:
    buffer_load_dword v6, v7, s[44:47], s39 offen sc1
    s_waitcnt vmcnt(0)
    v_cmp_ne_u32 vcc, s87, v6
    s_cbranch_vccz L_pollok_39
    s_mov_b64 exec, vcc
    s_sub_u32 s70, s70, 1
    s_cmp_eq_u32 s70, 0
    s_cbranch_scc1 L_pollok_39
    s_branch L_poll_38
L_pollok_39:
    s_mov_b64 exec, -1
L_zok_37:
    v_pk_fma_f32 v[152:153], v[152:153], v[22:23], v[200:201] op_sel_hi:[1,0,1]
    v_pk_fma_f32 v[154:155], v[154:155], v[22:23], v[202:203] op_sel_hi:[1,0,1]
    s_mov_b32 m0, s40
    s_nop 0
    buffer_load_dwordx4 v3, s[16:19], s36 offen sc1 lds
    v_pk_mul_f32 v[236:237], v[152:153], v[152:153]
    v_pk_mul_f32 v[238:239], v[154:155], v[154:155]
    v_pk_fma_f32 v[236:237], v[236:237], v[26:27], v[24:25]
    v_pk_fma_f32 v[238:239], v[238:239], v[26:27], v[24:25]
    v_pk_mul_f32 v[236:237], v[236:237], v[152:153]
    v_pk_mul_f32 v[238:239], v[238:239], v[154:155]
    v_exp_f32 v236, v236
    buffer_load_dwordx4 v3, s[16:19], s36 offen offset:1024 sc1 lds
    v_exp_f32 v237, v237
    v_exp_f32 v238, v238
    v_exp_f32 v239, v239
    v_pk_add_f32 v[236:237], v[236:237], 1.0 op_sel_hi:[1,0]
    v_pk_add_f32 v[238:239], v[238:239], 1.0 op_sel_hi:[1,0]
    v_rcp_f32 v236, v236
    v_rcp_f32 v237, v237
    buffer_load_dwordx4 v3, s[16:19], s36 offen offset:2048 sc1 lds
    v_rcp_f32 v238, v238
    v_rcp_f32 v239, v239
    v_pk_mul_f32 v[152:153], v[152:153], v[236:237]
    v_pk_mul_f32 v[154:155], v[154:155], v[238:239]
    v_pk_fma_f32 v[156:157], v[156:157], v[22:23], v[200:201] op_sel:[0,1,0] op_sel_hi:[1,1,1]
    v_pk_fma_f32 v[158:159], v[158:159], v[22:23], v[202:203] op_sel:[0,1,0] op_sel_hi:[1,1,1]
    v_pk_mul_f32 v[240:241], v[156:157], v[156:157]
    buffer_load_dwordx4 v3, s[16:19], s36 offen offset:3072 sc1 lds
    v_pk_mul_f32 v[242:243], v[158:159], v[158:159]
    v_pk_fma_f32 v[240:241], v[240:241], v[26:27], v[24:25]
    v_pk_fma_f32 v[242:243], v[242:243], v[26:27], v[24:25]
    v_pk_mul_f32 v[240:241], v[240:241], v[156:157]
    v_pk_mul_f32 v[242:243], v[242:243], v[158:159]
    v_exp_f32 v240, v240
    v_exp_f32 v241, v241
    s_cmp_ge_u32 s34, 2
    s_cbranch_scc1 L_z5_40
    s_add_u32 m0, s40, 0x1000
    s_nop 0
    buffer_load_dwordx4 v4, s[16:19], s36 offen sc1 lds
L_z5_40:
    s_add_u32 s36, s36, 18432
    v_exp_f32 v242, v242
    v_exp_f32 v243, v243
    v_pk_add_f32 v[240:241], v[240:241], 1.0 op_sel_hi:[1,0]
    v_pk_add_f32 v[242:243], v[242:243], 1.0 op_sel_hi:[1,0]
    v_rcp_f32 v240, v240
    v_rcp_f32 v241, v241
    v_rcp_f32 v242, v242
    s_mov_b32 m0, s41
    s_nop 0
    buffer_load_dwordx4 v3, s[16:19], s36 offen sc1 lds
    v_rcp_f32 v243, v243
    v_pk_mul_f32 v[156:157], v[156:157], v[240:241]
    v_pk_mul_f32 v[158:159], v[158:159], v[242:243]
    v_cvt_pk_bf16_f32 v52, v152, v153
    v_cvt_pk_bf16_f32 v53, v154, v155
    v_cvt_pk_bf16_f32 v54, v156, v157
    v_cvt_pk_bf16_f32 v55, v158, v159
    buffer_load_dwordx4 v3, s[16:19], s36 offen offset:1024 sc1 lds
    v_pk_fma_f32 v[160:161], v[160:161], v[22:23], v[204:205] op_sel_hi:[1,0,1]
    v_pk_fma_f32 v[162:163], v[162:163], v[22:23], v[206:207] op_sel_hi:[1,0,1]
    v_pk_mul_f32 v[236:237], v[160:161], v[160:161]
    v_pk_mul_f32 v[238:239], v[162:163], v[162:163]
    v_pk_fma_f32 v[236:237], v[236:237], v[26:27], v[24:25]
    v_pk_fma_f32 v[238:239], v[238:239], v[26:27], v[24:25]
    v_pk_mul_f32 v[236:237], v[236:237], v[160:161]
    buffer_load_dwordx4 v3, s[16:19], s36 offen offset:2048 sc1 lds
    v_pk_mul_f32 v[238:239], v[238:239], v[162:163]
    v_exp_f32 v236, v236
    v_exp_f32 v237, v237
    v_exp_f32 v238, v238
    v_exp_f32 v239, v239
    v_pk_add_f32 v[236:237], v[236:237], 1.0 op_sel_hi:[1,0]
    v_pk_add_f32 v[238:239], v[238:239], 1.0 op_sel_hi:[1,0]
    buffer_load_dwordx4 v3, s[16:19], s36 offen offset:3072 sc1 lds
    v_rcp_f32 v236, v236
    v_rcp_f32 v237, v237
    v_rcp_f32 v238, v238
    v_rcp_f32 v239, v239
    v_pk_mul_f32 v[160:161], v[160:161], v[236:237]
    v_pk_mul_f32 v[162:163], v[162:163], v[238:239]
    v_pk_fma_f32 v[164:165], v[164:165], v[22:23], v[204:205] op_sel:[0,1,0] op_sel_hi:[1,1,1]
    s_cmp_ge_u32 s34, 2
    s_cbranch_scc1 L_z5_41
    s_add_u32 m0, s41, 0x1000
    s_nop 0
    buffer_load_dwordx4 v4, s[16:19], s36 offen sc1 lds
L_z5_41:
    s_add_u32 s36, s36, 18432
    v_pk_fma_f32 v[166:167], v[166:167], v[22:23], v[206:207] op_sel:[0,1,0] op_sel_hi:[1,1,1]
    v_pk_mul_f32 v[240:241], v[164:165], v[164:165]
    v_pk_mul_f32 v[242:243], v[166:167], v[166:167]
    v_pk_fma_f32 v[240:241], v[240:241], v[26:27], v[24:25]
    v_pk_fma_f32 v[242:243], v[242:243], v[26:27], v[24:25]
    v_pk_mul_f32 v[240:241], v[240:241], v[164:165]
    v_pk_mul_f32 v[242:243], v[242:243], v[166:167]
    s_mov_b32 m0, s42
    s_nop 0
    buffer_load_dwordx4 v3, s[16:19], s36 offen sc1 lds
    v_exp_f32 v240, v240
    v_exp_f32 v241, v241
    v_exp_f32 v242, v242
    v_exp_f32 v243, v243
    v_pk_add_f32 v[240:241], v[240:241], 1.0 op_sel_hi:[1,0]
    v_pk_add_f32 v[242:243], v[242:243], 1.0 op_sel_hi:[1,0]
    v_rcp_f32 v240, v240
    buffer_load_dwordx4 v3, s[16:19], s36 offen offset:1024 sc1 lds
    v_rcp_f32 v241, v241
    v_rcp_f32 v242, v242
    v_rcp_f32 v243, v243
    v_pk_mul_f32 v[164:165], v[164:165], v[240:241]
    v_pk_mul_f32 v[166:167], v[166:167], v[242:243]
    v_cvt_pk_bf16_f32 v56, v160, v161
    v_cvt_pk_bf16_f32 v57, v162, v163
    buffer_load_dwordx4 v3, s[16:19], s36 offen offset:2048 sc1 lds
    v_cvt_pk_bf16_f32 v58, v164, v165
    v_cvt_pk_bf16_f32 v59, v166, v167
    v_pk_fma_f32 v[168:169], v[168:169], v[22:23], v[208:209] op_sel_hi:[1,0,1]
    v_pk_fma_f32 v[170:171], v[170:171], v[22:23], v[210:211] op_sel_hi:[1,0,1]
    v_pk_mul_f32 v[236:237], v[168:169], v[168:169]
    v_pk_mul_f32 v[238:239], v[170:171], v[170:171]
    v_pk_fma_f32 v[236:237], v[236:237], v[26:27], v[24:25]
    buffer_load_dwordx4 v3, s[16:19], s36 offen offset:3072 sc1 lds
    v_pk_fma_f32 v[238:239], v[238:239], v[26:27], v[24:25]
    v_pk_mul_f32 v[236:237], v[236:237], v[168:169]
    v_pk_mul_f32 v[238:239], v[238:239], v[170:171]
    v_exp_f32 v236, v236
    v_exp_f32 v237, v237
    v_exp_f32 v238, v238
    v_exp_f32 v239, v239
    s_cmp_ge_u32 s34, 2
    s_cbranch_scc1 L_z5_42
    s_add_u32 m0, s42, 0x1000
    s_nop 0
    buffer_load_dwordx4 v4, s[16:19], s36 offen sc1 lds
L_z5_42:
    s_add_u32 s36, s36, 18432
    v_pk_add_f32 v[236:237], v[236:237], 1.0 op_sel_hi:[1,0]
    v_pk_add_f32 v[238:239], v[238:239], 1.0 op_sel_hi:[1,0]
    v_rcp_f32 v236, v236
    v_rcp_f32 v237, v237
    v_rcp_f32 v238, v238
    v_rcp_f32 v239, v239
    v_pk_mul_f32 v[168:169], v[168:169], v[236:237]
    s_mov_b32 m0, s43
    s_nop 0
    buffer_load_dwordx4 v3, s[16:19], s36 offen sc1 lds
    v_pk_mul_f32 v[170:171], v[170:171], v[238:239]
    v_pk_fma_f32 v[172:173], v[172:173], v[22:23], v[208:209] op_sel:[0,1,0] op_sel_hi:[1,1,1]
    v_pk_fma_f32 v[174:175], v[174:175], v[22:23], v[210:211] op_sel:[0,1,0] op_sel_hi:[1,1,1]
    v_pk_mul_f32 v[240:241], v[172:173], v[172:173]
    v_pk_mul_f32 v[242:243], v[174:175], v[174:175]
    v_pk_fma_f32 v[240:241], v[240:241], v[26:27], v[24:25]
    v_pk_fma_f32 v[242:243], v[242:243], v[26:27], v[24:25]
    buffer_load_dwordx4 v3, s[16:19], s36 offen offset:1024 sc1 lds
    v_pk_mul_f32 v[240:241], v[240:241], v[172:173]
    v_pk_mul_f32 v[242:243], v[242:243], v[174:175]
    v_exp_f32 v240, v240
    v_exp_f32 v241, v241
    v_exp_f32 v242, v242
    v_exp_f32 v243, v243
    v_pk_add_f32 v[240:241], v[240:241], 1.0 op_sel_hi:[1,0]
    buffer_load_dwordx4 v3, s[16:19], s36 offen offset:2048 sc1 lds
    v_pk_add_f32 v[242:243], v[242:243], 1.0 op_sel_hi:[1,0]
    v_rcp_f32 v240, v240
    v_rcp_f32 v241, v241
    v_rcp_f32 v242, v242
    v_rcp_f32 v243, v243
    v_pk_mul_f32 v[172:173], v[172:173], v[240:241]
    v_pk_mul_f32 v[174:175], v[174:175], v[242:243]
    buffer_load_dwordx4 v3, s[16:19], s36 offen offset:3072 sc1 lds
    v_cvt_pk_bf16_f32 v60, v168, v169
    v_cvt_pk_bf16_f32 v61, v170, v171
    v_cvt_pk_bf16_f32 v62, v172, v173
    v_cvt_pk_bf16_f32 v63, v174, v175
    s_cmp_ge_u32 s34, 2
    s_cbranch_scc1 L_z5_43
    s_add_u32 m0, s43, 0x1000
    s_nop 0
    buffer_load_dwordx4 v4, s[16:19], s36 offen sc1 lds
L_z5_43:
    s_add_u32 s36, s36, 18432
    v_lshlrev_b32 v64, 16, v20
    v_lshlrev_b32 v65, 16, v20
    v_lshlrev_b32 v66, 16, v20
    v_lshlrev_b32 v67, 16, v20
    v_lshlrev_b32 v68, 16, v21
    v_lshlrev_b32 v69, 16, v21
    v_lshlrev_b32 v70, 16, v21
    v_lshlrev_b32 v71, 16, v21
    v_lshlrev_b32 v72, 16, v20
    v_lshlrev_b32 v73, 16, v20
    v_lshlrev_b32 v74, 16, v20
    v_lshlrev_b32 v75, 16, v20
    v_lshlrev_b32 v76, 16, v21
    v_lshlrev_b32 v77, 16, v21
    v_lshlrev_b32 v78, 16, v21
    v_lshlrev_b32 v79, 16, v21
    v_lshlrev_b32 v80, 16, v20
    v_lshlrev_b32 v81, 16, v20
    v_lshlrev_b32 v82, 16, v20
    v_lshlrev_b32 v83, 16, v20
    v_lshlrev_b32 v84, 16, v21
    v_lshlrev_b32 v85, 16, v21
    v_lshlrev_b32 v86, 16, v21
    v_lshlrev_b32 v87, 16, v21
    v_lshlrev_b32 v88, 16, v20
    v_lshlrev_b32 v89, 16, v20
    v_lshlrev_b32 v90, 16, v20
    v_lshlrev_b32 v91, 16, v20
    v_lshlrev_b32 v92, 16, v21
    v_lshlrev_b32 v93, 16, v21
    v_lshlrev_b32 v94, 16, v21
    v_lshlrev_b32 v95, 16, v21
    v_lshlrev_b32 v96, 16, v20
    v_lshlrev_b32 v97, 16, v20
    v_lshlrev_b32 v98, 16, v20
    v_lshlrev_b32 v99, 16, v20
    v_lshlrev_b32 v100, 16, v21
    v_lshlrev_b32 v101, 16, v21
    v_lshlrev_b32 v102, 16, v21
    v_lshlrev_b32 v103, 16, v21
    v_lshlrev_b32 v104, 16, v20
    v_lshlrev_b32 v105, 16, v20
    v_lshlrev_b32 v106, 16, v20
    v_lshlrev_b32 v107, 16, v20
    v_lshlrev_b32 v108, 16, v21
    v_lshlrev_b32 v109, 16, v21
    v_lshlrev_b32 v110, 16, v21
    v_lshlrev_b32 v111, 16, v21
    v_lshlrev_b32 v112, 16, v20
    v_lshlrev_b32 v113, 16, v20
    v_lshlrev_b32 v114, 16, v20
    v_lshlrev_b32 v115, 16, v20
    v_lshlrev_b32 v116, 16, v21
    v_lshlrev_b32 v117, 16, v21
    v_lshlrev_b32 v118, 16, v21
    v_lshlrev_b32 v119, 16, v21
    v_lshlrev_b32 v120, 16, v20
    v_lshlrev_b32 v121, 16, v20
    v_lshlrev_b32 v122, 16, v20
    v_lshlrev_b32 v123, 16, v20
    v_lshlrev_b32 v124, 16, v21
    v_lshlrev_b32 v125, 16, v21
    v_lshlrev_b32 v126, 16, v21
    v_lshlrev_b32 v127, 16, v21
    v_lshlrev_b32 v128, 16, v20
    v_lshlrev_b32 v129, 16, v20
    v_lshlrev_b32 v130, 16, v20
    v_lshlrev_b32 v131, 16, v20
    v_lshlrev_b32 v132, 16, v21
    v_lshlrev_b32 v133, 16, v21
    v_lshlrev_b32 v134, 16, v21
    v_lshlrev_b32 v135, 16, v21
    s_cmp_ge_u32 s34, 2
    s_cbranch_scc1 L_g2nz4_45
    s_waitcnt vmcnt(10)
    s_barrier
    ds_read_b128 v[136:139], v12 offset:0
    ds_read_b128 v[140:143], v12 offset:2048
    ds_read_b128 v[144:147], v8 offset:0
    ds_read_b128 v[148:151], v8 offset:1024
    ds_read_b128 v[152:155], v8 offset:2048
    ds_read_b128 v[156:159], v8 offset:3072
    ds_read_b128 v[160:163], v8 offset:4096
    ds_read_b128 v[164:167], v8 offset:5120
    ds_read_b128 v[168:171], v8 offset:6144
    ds_read_b128 v[172:175], v8 offset:7168
    ds_read_b128 v[176:179], v8 offset:8192
    s_mov_b32 s37, 7
.p2align 3
L_g2loop_46:
    s_waitcnt lgkmcnt(0)
    v_mfma_f32_16x16x32_bf16 v[64:67], v[144:147], v[136:139], v[64:67]
    ds_read_b128 v[180:183], v16 offset:0
    v_mfma_f32_16x16x32_bf16 v[68:71], v[144:147], v[140:143], v[68:71]
    ds_read_b128 v[184:187], v16 offset:2048
    v_mfma_f32_16x16x32_bf16 v[72:75], v[148:151], v[136:139], v[72:75]
    ds_read_b128 v[188:191], v8 offset:9216
    v_mfma_f32_16x16x32_bf16 v[76:79], v[148:151], v[140:143], v[76:79]
    ds_read_b128 v[192:195], v8 offset:10240
    v_mfma_f32_16x16x32_bf16 v[80:83], v[152:155], v[136:139], v[80:83]
    ds_read_b128 v[196:199], v8 offset:11264
    v_mfma_f32_16x16x32_bf16 v[84:87], v[152:155], v[140:143], v[84:87]
    ds_read_b128 v[200:203], v8 offset:12288
    s_mov_b32 m0, s95
    v_mfma_f32_16x16x32_bf16 v[88:91], v[156:159], v[136:139], v[88:91]
    buffer_load_dwordx4 v224, s[72:75], s71 offen lds
    v_mfma_f32_16x16x32_bf16 v[92:95], v[156:159], v[140:143], v[92:95]
    ds_read_b128 v[204:207], v8 offset:13312
    v_mfma_f32_16x16x32_bf16 v[96:99], v[160:163], v[136:139], v[96:99]
    ds_read_b128 v[208:211], v8 offset:14336
    v_mfma_f32_16x16x32_bf16 v[100:103], v[160:163], v[140:143], v[100:103]
    ds_read_b128 v[212:215], v8 offset:15360
    v_mfma_f32_16x16x32_bf16 v[104:107], v[164:167], v[136:139], v[104:107]
    ds_read_b128 v[216:219], v8 offset:16384
    v_mfma_f32_16x16x32_bf16 v[108:111], v[164:167], v[140:143], v[108:111]
    ds_read_b128 v[220:223], v8 offset:17408
    v_mfma_f32_16x16x32_bf16 v[112:115], v[168:171], v[136:139], v[112:115]
    buffer_load_dwordx4 v225, s[72:75], s71 offen offset:1024 lds
    v_mfma_f32_16x16x32_bf16 v[116:119], v[168:171], v[140:143], v[116:119]
    buffer_load_dwordx4 v226, s[72:75], s71 offen offset:2048 lds
    v_mfma_f32_16x16x32_bf16 v[120:123], v[172:175], v[136:139], v[120:123]
    v_mfma_f32_16x16x32_bf16 v[124:127], v[172:175], v[140:143], v[124:127]
    buffer_load_dwordx4 v227, s[72:75], s71 offen offset:3072 lds
    s_add_u32 s71, s71, 128
    v_mfma_f32_16x16x32_bf16 v[128:131], v[176:179], v[136:139], v[128:131]
    v_mfma_f32_16x16x32_bf16 v[132:135], v[176:179], v[140:143], v[132:135]
    s_waitcnt vmcnt(18) lgkmcnt(0)
    s_barrier
    v_mfma_f32_16x16x32_bf16 v[64:67], v[188:191], v[180:183], v[64:67]
    ds_read_b128 v[136:139], v13 offset:0
    v_mfma_f32_16x16x32_bf16 v[68:71], v[188:191], v[184:187], v[68:71]
    ds_read_b128 v[140:143], v13 offset:2048
    v_mfma_f32_16x16x32_bf16 v[72:75], v[192:195], v[180:183], v[72:75]
    ds_read_b128 v[144:147], v9 offset:0
    v_mfma_f32_16x16x32_bf16 v[76:79], v[192:195], v[184:187], v[76:79]
    ds_read_b128 v[148:151], v9 offset:1024
    v_mfma_f32_16x16x32_bf16 v[80:83], v[196:199], v[180:183], v[80:83]
    ds_read_b128 v[152:155], v9 offset:2048
    v_mfma_f32_16x16x32_bf16 v[84:87], v[196:199], v[184:187], v[84:87]
    ds_read_b128 v[156:159], v9 offset:3072
    s_mov_b32 m0, s40
    v_mfma_f32_16x16x32_bf16 v[88:91], v[200:203], v[180:183], v[88:91]
    buffer_load_dwordx4 v3, s[16:19], s36 offen sc1 lds
    v_mfma_f32_16x16x32_bf16 v[92:95], v[200:203], v[184:187], v[92:95]
    ds_read_b128 v[160:163], v9 offset:4096
    v_mfma_f32_16x16x32_bf16 v[96:99], v[204:207], v[180:183], v[96:99]
    ds_read_b128 v[164:167], v9 offset:5120
    v_mfma_f32_16x16x32_bf16 v[100:103], v[204:207], v[184:187], v[100:103]
    ds_read_b128 v[168:171], v9 offset:6144
    v_mfma_f32_16x16x32_bf16 v[104:107], v[208:211], v[180:183], v[104:107]
    ds_read_b128 v[172:175], v9 offset:7168
    v_mfma_f32_16x16x32_bf16 v[108:111], v[208:211], v[184:187], v[108:111]
    ds_read_b128 v[176:179], v9 offset:8192
    v_mfma_f32_16x16x32_bf16 v[112:115], v[212:215], v[180:183], v[112:115]
    buffer_load_dwordx4 v3, s[16:19], s36 offen offset:1024 sc1 lds
    v_mfma_f32_16x16x32_bf16 v[116:119], v[212:215], v[184:187], v[116:119]
    buffer_load_dwordx4 v3, s[16:19], s36 offen offset:2048 sc1 lds
    v_mfma_f32_16x16x32_bf16 v[120:123], v[216:219], v[180:183], v[120:123]
    buffer_load_dwordx4 v3, s[16:19], s36 offen offset:3072 sc1 lds
    v_mfma_f32_16x16x32_bf16 v[124:127], v[216:219], v[184:187], v[124:127]
    s_add_u32 m0, s40, 0x1000
    v_mfma_f32_16x16x32_bf16 v[128:131], v[220:223], v[180:183], v[128:131]
    buffer_load_dwordx4 v4, s[16:19], s36 offen sc1 lds
    s_add_u32 s36, s36, 18432
    v_mfma_f32_16x16x32_bf16 v[132:135], v[220:223], v[184:187], v[132:135]
    s_waitcnt lgkmcnt(0)
    v_mfma_f32_16x16x32_bf16 v[64:67], v[144:147], v[136:139], v[64:67]
    ds_read_b128 v[180:183], v17 offset:0
    v_mfma_f32_16x16x32_bf16 v[68:71], v[144:147], v[140:143], v[68:71]
    ds_read_b128 v[184:187], v17 offset:2048
    v_mfma_f32_16x16x32_bf16 v[72:75], v[148:151], v[136:139], v[72:75]
    ds_read_b128 v[188:191], v9 offset:9216
    v_mfma_f32_16x16x32_bf16 v[76:79], v[148:151], v[140:143], v[76:79]
    ds_read_b128 v[192:195], v9 offset:10240
    v_mfma_f32_16x16x32_bf16 v[80:83], v[152:155], v[136:139], v[80:83]
    ds_read_b128 v[196:199], v9 offset:11264
    v_mfma_f32_16x16x32_bf16 v[84:87], v[152:155], v[140:143], v[84:87]
    ds_read_b128 v[200:203], v9 offset:12288
    s_mov_b32 m0, s92
    v_mfma_f32_16x16x32_bf16 v[88:91], v[156:159], v[136:139], v[88:91]
    buffer_load_dwordx4 v224, s[72:75], s71 offen lds
    v_mfma_f32_16x16x32_bf16 v[92:95], v[156:159], v[140:143], v[92:95]
    ds_read_b128 v[204:207], v9 offset:13312
    v_mfma_f32_16x16x32_bf16 v[96:99], v[160:163], v[136:139], v[96:99]
    ds_read_b128 v[208:211], v9 offset:14336
    v_mfma_f32_16x16x32_bf16 v[100:103], v[160:163], v[140:143], v[100:103]
    ds_read_b128 v[212:215], v9 offset:15360
    v_mfma_f32_16x16x32_bf16 v[104:107], v[164:167], v[136:139], v[104:107]
    ds_read_b128 v[216:219], v9 offset:16384
    v_mfma_f32_16x16x32_bf16 v[108:111], v[164:167], v[140:143], v[108:111]
    ds_read_b128 v[220:223], v9 offset:17408
    v_mfma_f32_16x16x32_bf16 v[112:115], v[168:171], v[136:139], v[112:115]
    buffer_load_dwordx4 v225, s[72:75], s71 offen offset:1024 lds
    v_mfma_f32_16x16x32_bf16 v[116:119], v[168:171], v[140:143], v[116:119]
    buffer_load_dwordx4 v226, s[72:75], s71 offen offset:2048 lds
    v_mfma_f32_16x16x32_bf16 v[120:123], v[172:175], v[136:139], v[120:123]
    v_mfma_f32_16x16x32_bf16 v[124:127], v[172:175], v[140:143], v[124:127]
    buffer_load_dwordx4 v227, s[72:75], s71 offen offset:3072 lds
    s_add_u32 s71, s71, 128
    v_mfma_f32_16x16x32_bf16 v[128:131], v[176:179], v[136:139], v[128:131]
    v_mfma_f32_16x16x32_bf16 v[132:135], v[176:179], v[140:143], v[132:135]
    s_waitcnt vmcnt(18) lgkmcnt(0)
    s_barrier
    v_mfma_f32_16x16x32_bf16 v[64:67], v[188:191], v[180:183], v[64:67]
    ds_read_b128 v[136:139], v14 offset:0
    v_mfma_f32_16x16x32_bf16 v[68:71], v[188:191], v[184:187], v[68:71]
    ds_read_b128 v[140:143], v14 offset:2048
    v_mfma_f32_16x16x32_bf16 v[72:75], v[192:195], v[180:183], v[72:75]
    ds_read_b128 v[144:147], v10 offset:0
    v_mfma_f32_16x16x32_bf16 v[76:79], v[192:195], v[184:187], v[76:79]
    ds_read_b128 v[148:151], v10 offset:1024
    v_mfma_f32_16x16x32_bf16 v[80:83], v[196:199], v[180:183], v[80:83]
    ds_read_b128 v[152:155], v10 offset:2048
    v_mfma_f32_16x16x32_bf16 v[84:87], v[196:199], v[184:187], v[84:87]
    ds_read_b128 v[156:159], v10 offset:3072
    s_mov_b32 m0, s41
    v_mfma_f32_16x16x32_bf16 v[88:91], v[200:203], v[180:183], v[88:91]
    buffer_load_dwordx4 v3, s[16:19], s36 offen sc1 lds
    v_mfma_f32_16x16x32_bf16 v[92:95], v[200:203], v[184:187], v[92:95]
    ds_read_b128 v[160:163], v10 offset:4096
    v_mfma_f32_16x16x32_bf16 v[96:99], v[204:207], v[180:183], v[96:99]
    ds_read_b128 v[164:167], v10 offset:5120
    v_mfma_f32_16x16x32_bf16 v[100:103], v[204:207], v[184:187], v[100:103]
    ds_read_b128 v[168:171], v10 offset:6144
    v_mfma_f32_16x16x32_bf16 v[104:107], v[208:211], v[180:183], v[104:107]
    ds_read_b128 v[172:175], v10 offset:7168
    v_mfma_f32_16x16x32_bf16 v[108:111], v[208:211], v[184:187], v[108:111]
    ds_read_b128 v[176:179], v10 offset:8192
    v_mfma_f32_16x16x32_bf16 v[112:115], v[212:215], v[180:183], v[112:115]
    buffer_load_dwordx4 v3, s[16:19], s36 offen offset:1024 sc1 lds
    v_mfma_f32_16x16x32_bf16 v[116:119], v[212:215], v[184:187], v[116:119]
    buffer_load_dwordx4 v3, s[16:19], s36 offen offset:2048 sc1 lds
    v_mfma_f32_16x16x32_bf16 v[120:123], v[216:219], v[180:183], v[120:123]
    buffer_load_dwordx4 v3, s[16:19], s36 offen offset:3072 sc1 lds
    v_mfma_f32_16x16x32_bf16 v[124:127], v[216:219], v[184:187], v[124:127]
    s_add_u32 m0, s41, 0x1000
    v_mfma_f32_16x16x32_bf16 v[128:131], v[220:223], v[180:183], v[128:131]
    buffer_load_dwordx4 v4, s[16:19], s36 offen sc1 lds
    s_add_u32 s36, s36, 18432
    v_mfma_f32_16x16x32_bf16 v[132:135], v[220:223], v[184:187], v[132:135]
    s_waitcnt lgkmcnt(0)
    v_mfma_f32_16x16x32_bf16 v[64:67], v[144:147], v[136:139], v[64:67]
    ds_read_b128 v[180:183], v18 offset:0
    v_mfma_f32_16x16x32_bf16 v[68:71], v[144:147], v[140:143], v[68:71]
    ds_read_b128 v[184:187], v18 offset:2048
    v_mfma_f32_16x16x32_bf16 v[72:75], v[148:151], v[136:139], v[72:75]
    ds_read_b128 v[188:191], v10 offset:9216
    v_mfma_f32_16x16x32_bf16 v[76:79], v[148:151], v[140:143], v[76:79]
    ds_read_b128 v[192:195], v10 offset:10240
    v_mfma_f32_16x16x32_bf16 v[80:83], v[152:155], v[136:139], v[80:83]
    ds_read_b128 v[196:199], v10 offset:11264
    v_mfma_f32_16x16x32_bf16 v[84:87], v[152:155], v[140:143], v[84:87]
    ds_read_b128 v[200:203], v10 offset:12288
    s_mov_b32 m0, s93
    v_mfma_f32_16x16x32_bf16 v[88:91], v[156:159], v[136:139], v[88:91]
    buffer_load_dwordx4 v224, s[72:75], s71 offen lds
    v_mfma_f32_16x16x32_bf16 v[92:95], v[156:159], v[140:143], v[92:95]
    ds_read_b128 v[204:207], v10 offset:13312
    v_mfma_f32_16x16x32_bf16 v[96:99], v[160:163], v[136:139], v[96:99]
    ds_read_b128 v[208:211], v10 offset:14336
    v_mfma_f32_16x16x32_bf16 v[100:103], v[160:163], v[140:143], v[100:103]
    ds_read_b128 v[212:215], v10 offset:15360
    v_mfma_f32_16x16x32_bf16 v[104:107], v[164:167], v[136:139], v[104:107]
    ds_read_b128 v[216:219], v10 offset:16384
    v_mfma_f32_16x16x32_bf16 v[108:111], v[164:167], v[140:143], v[108:111]
    ds_read_b128 v[220:223], v10 offset:17408
    v_mfma_f32_16x16x32_bf16 v[112:115], v[168:171], v[136:139], v[112:115]
    buffer_load_dwordx4 v225, s[72:75], s71 offen offset:1024 lds
    v_mfma_f32_16x16x32_bf16 v[116:119], v[168:171], v[140:143], v[116:119]
    buffer_load_dwordx4 v226, s[72:75], s71 offen offset:2048 lds
    v_mfma_f32_16x16x32_bf16 v[120:123], v[172:175], v[136:139], v[120:123]
    v_mfma_f32_16x16x32_bf16 v[124:127], v[172:175], v[140:143], v[124:127]
    buffer_load_dwordx4 v227, s[72:75], s71 offen offset:3072 lds
    s_add_u32 s71, s71, 128
    v_mfma_f32_16x16x32_bf16 v[128:131], v[176:179], v[136:139], v[128:131]
    v_mfma_f32_16x16x32_bf16 v[132:135], v[176:179], v[140:143], v[132:135]
    s_waitcnt vmcnt(18) lgkmcnt(0)
    s_barrier
    v_mfma_f32_16x16x32_bf16 v[64:67], v[188:191], v[180:183], v[64:67]
    ds_read_b128 v[136:139], v15 offset:0
    v_mfma_f32_16x16x32_bf16 v[68:71], v[188:191], v[184:187], v[68:71]
    ds_read_b128 v[140:143], v15 offset:2048
    v_mfma_f32_16x16x32_bf16 v[72:75], v[192:195], v[180:183], v[72:75]
    ds_read_b128 v[144:147], v11 offset:0
    v_mfma_f32_16x16x32_bf16 v[76:79], v[192:195], v[184:187], v[76:79]
    ds_read_b128 v[148:151], v11 offset:1024
    v_mfma_f32_16x16x32_bf16 v[80:83], v[196:199], v[180:183], v[80:83]
    ds_read_b128 v[152:155], v11 offset:2048
    v_mfma_f32_16x16x32_bf16 v[84:87], v[196:199], v[184:187], v[84:87]
    ds_read_b128 v[156:159], v11 offset:3072
    s_mov_b32 m0, s42
    v_mfma_f32_16x16x32_bf16 v[88:91], v[200:203], v[180:183], v[88:91]
    buffer_load_dwordx4 v3, s[16:19], s36 offen sc1 lds
    v_mfma_f32_16x16x32_bf16 v[92:95], v[200:203], v[184:187], v[92:95]
    ds_read_b128 v[160:163], v11 offset:4096
    v_mfma_f32_16x16x32_bf16 v[96:99], v[204:207], v[180:183], v[96:99]
    ds_read_b128 v[164:167], v11 offset:5120
    v_mfma_f32_16x16x32_bf16 v[100:103], v[204:207], v[184:187], v[100:103]
    ds_read_b128 v[168:171], v11 offset:6144
    v_mfma_f32_16x16x32_bf16 v[104:107], v[208:211], v[180:183], v[104:107]
    ds_read_b128 v[172:175], v11 offset:7168
    v_mfma_f32_16x16x32_bf16 v[108:111], v[208:211], v[184:187], v[108:111]
    ds_read_b128 v[176:179], v11 offset:8192
    v_mfma_f32_16x16x32_bf16 v[112:115], v[212:215], v[180:183], v[112:115]
    buffer_load_dwordx4 v3, s[16:19], s36 offen offset:1024 sc1 lds
    v_mfma_f32_16x16x32_bf16 v[116:119], v[212:215], v[184:187], v[116:119]
    buffer_load_dwordx4 v3, s[16:19], s36 offen offset:2048 sc1 lds
    v_mfma_f32_16x16x32_bf16 v[120:123], v[216:219], v[180:183], v[120:123]
    buffer_load_dwordx4 v3, s[16:19], s36 offen offset:3072 sc1 lds
    v_mfma_f32_16x16x32_bf16 v[124:127], v[216:219], v[184:187], v[124:127]
    s_add_u32 m0, s42, 0x1000
    v_mfma_f32_16x16x32_bf16 v[128:131], v[220:223], v[180:183], v[128:131]
    buffer_load_dwordx4 v4, s[16:19], s36 offen sc1 lds
    s_add_u32 s36, s36, 18432
    v_mfma_f32_16x16x32_bf16 v[132:135], v[220:223], v[184:187], v[132:135]
    s_waitcnt lgkmcnt(0)
    v_mfma_f32_16x16x32_bf16 v[64:67], v[144:147], v[136:139], v[64:67]
    ds_read_b128 v[180:183], v19 offset:0
    v_mfma_f32_16x16x32_bf16 v[68:71], v[144:147], v[140:143], v[68:71]
    ds_read_b128 v[184:187], v19 offset:2048
    v_mfma_f32_16x16x32_bf16 v[72:75], v[148:151], v[136:139], v[72:75]
    ds_read_b128 v[188:191], v11 offset:9216
    v_mfma_f32_16x16x32_bf16 v[76:79], v[148:151], v[140:143], v[76:79]
    ds_read_b128 v[192:195], v11 offset:10240
    v_mfma_f32_16x16x32_bf16 v[80:83], v[152:155], v[136:139], v[80:83]
    ds_read_b128 v[196:199], v11 offset:11264
    v_mfma_f32_16x16x32_bf16 v[84:87], v[152:155], v[140:143], v[84:87]
    ds_read_b128 v[200:203], v11 offset:12288
    s_mov_b32 m0, s94
    v_mfma_f32_16x16x32_bf16 v[88:91], v[156:159], v[136:139], v[88:91]
    buffer_load_dwordx4 v224, s[72:75], s71 offen lds
    v_mfma_f32_16x16x32_bf16 v[92:95], v[156:159], v[140:143], v[92:95]
    ds_read_b128 v[204:207], v11 offset:13312
    v_mfma_f32_16x16x32_bf16 v[96:99], v[160:163], v[136:139], v[96:99]
    ds_read_b128 v[208:211], v11 offset:14336
    v_mfma_f32_16x16x32_bf16 v[100:103], v[160:163], v[140:143], v[100:103]
    ds_read_b128 v[212:215], v11 offset:15360
    v_mfma_f32_16x16x32_bf16 v[104:107], v[164:167], v[136:139], v[104:107]
    ds_read_b128 v[216:219], v11 offset:16384
    v_mfma_f32_16x16x32_bf16 v[108:111], v[164:167], v[140:143], v[108:111]
    ds_read_b128 v[220:223], v11 offset:17408
    v_mfma_f32_16x16x32_bf16 v[112:115], v[168:171], v[136:139], v[112:115]
    buffer_load_dwordx4 v225, s[72:75], s71 offen offset:1024 lds
    v_mfma_f32_16x16x32_bf16 v[116:119], v[168:171], v[140:143], v[116:119]
    buffer_load_dwordx4 v226, s[72:75], s71 offen offset:2048 lds
    v_mfma_f32_16x16x32_bf16 v[120:123], v[172:175], v[136:139], v[120:123]
    v_mfma_f32_16x16x32_bf16 v[124:127], v[172:175], v[140:143], v[124:127]
    buffer_load_dwordx4 v227, s[72:75], s71 offen offset:3072 lds
    s_add_u32 s71, s71, 128
    v_mfma_f32_16x16x32_bf16 v[128:131], v[176:179], v[136:139], v[128:131]
    v_mfma_f32_16x16x32_bf16 v[132:135], v[176:179], v[140:143], v[132:135]
    s_waitcnt vmcnt(18) lgkmcnt(0)
    s_barrier
    v_mfma_f32_16x16x32_bf16 v[64:67], v[188:191], v[180:183], v[64:67]
    ds_read_b128 v[136:139], v12 offset:0
    v_mfma_f32_16x16x32_bf16 v[68:71], v[188:191], v[184:187], v[68:71]
    ds_read_b128 v[140:143], v12 offset:2048
    v_mfma_f32_16x16x32_bf16 v[72:75], v[192:195], v[180:183], v[72:75]
    ds_read_b128 v[144:147], v8 offset:0
    v_mfma_f32_16x16x32_bf16 v[76:79], v[192:195], v[184:187], v[76:79]
    ds_read_b128 v[148:151], v8 offset:1024
    v_mfma_f32_16x16x32_bf16 v[80:83], v[196:199], v[180:183], v[80:83]
    ds_read_b128 v[152:155], v8 offset:2048
    v_mfma_f32_16x16x32_bf16 v[84:87], v[196:199], v[184:187], v[84:87]
    ds_read_b128 v[156:159], v8 offset:3072
    s_mov_b32 m0, s43
    v_mfma_f32_16x16x32_bf16 v[88:91], v[200:203], v[180:183], v[88:91]
    buffer_load_dwordx4 v3, s[16:19], s36 offen sc1 lds
    v_mfma_f32_16x16x32_bf16 v[92:95], v[200:203], v[184:187], v[92:95]
    ds_read_b128 v[160:163], v8 offset:4096
    v_mfma_f32_16x16x32_bf16 v[96:99], v[204:207], v[180:183], v[96:99]
    ds_read_b128 v[164:167], v8 offset:5120
    v_mfma_f32_16x16x32_bf16 v[100:103], v[204:207], v[184:187], v[100:103]
    ds_read_b128 v[168:171], v8 offset:6144
    v_mfma_f32_16x16x32_bf16 v[104:107], v[208:211], v[180:183], v[104:107]
    ds_read_b128 v[172:175], v8 offset:7168
    v_mfma_f32_16x16x32_bf16 v[108:111], v[208:211], v[184:187], v[108:111]
    ds_read_b128 v[176:179], v8 offset:8192
    v_mfma_f32_16x16x32_bf16 v[112:115], v[212:215], v[180:183], v[112:115]
    buffer_load_dwordx4 v3, s[16:19], s36 offen offset:1024 sc1 lds
    v_mfma_f32_16x16x32_bf16 v[116:119], v[212:215], v[184:187], v[116:119]
    buffer_load_dwordx4 v3, s[16:19], s36 offen offset:2048 sc1 lds
    v_mfma_f32_16x16x32_bf16 v[120:123], v[216:219], v[180:183], v[120:123]
    buffer_load_dwordx4 v3, s[16:19], s36 offen offset:3072 sc1 lds
    v_mfma_f32_16x16x32_bf16 v[124:127], v[216:219], v[184:187], v[124:127]
    s_add_u32 m0, s43, 0x1000
    v_mfma_f32_16x16x32_bf16 v[128:131], v[220:223], v[180:183], v[128:131]
    buffer_load_dwordx4 v4, s[16:19], s36 offen sc1 lds
    s_add_u32 s36, s36, 18432
    v_mfma_f32_16x16x32_bf16 v[132:135], v[220:223], v[184:187], v[132:135]
    s_sub_u32 s37, s37, 1
    s_cmp_lg_u32 s37, 0
    s_cbranch_scc1 L_g2loop_46
    s_waitcnt lgkmcnt(0)
    v_mfma_f32_16x16x32_bf16 v[64:67], v[144:147], v[136:139], v[64:67]
    ds_read_b128 v[180:183], v16 offset:0
    v_mfma_f32_16x16x32_bf16 v[68:71], v[144:147], v[140:143], v[68:71]
    ds_read_b128 v[184:187], v16 offset:2048
    v_mfma_f32_16x16x32_bf16 v[72:75], v[148:151], v[136:139], v[72:75]
    ds_read_b128 v[188:191], v8 offset:9216
    v_mfma_f32_16x16x32_bf16 v[76:79], v[148:151], v[140:143], v[76:79]
    ds_read_b128 v[192:195], v8 offset:10240
    v_mfma_f32_16x16x32_bf16 v[80:83], v[152:155], v[136:139], v[80:83]
    ds_read_b128 v[196:199], v8 offset:11264
    v_mfma_f32_16x16x32_bf16 v[84:87], v[152:155], v[140:143], v[84:87]
    ds_read_b128 v[200:203], v8 offset:12288
    s_mov_b32 m0, s95
    v_mfma_f32_16x16x32_bf16 v[88:91], v[156:159], v[136:139], v[88:91]
    buffer_load_dwordx4 v224, s[72:75], s71 offen lds
    v_mfma_f32_16x16x32_bf16 v[92:95], v[156:159], v[140:143], v[92:95]
    ds_read_b128 v[204:207], v8 offset:13312
    v_mfma_f32_16x16x32_bf16 v[96:99], v[160:163], v[136:139], v[96:99]
    ds_read_b128 v[208:211], v8 offset:14336
    v_mfma_f32_16x16x32_bf16 v[100:103], v[160:163], v[140:143], v[100:103]
    ds_read_b128 v[212:215], v8 offset:15360
    v_mfma_f32_16x16x32_bf16 v[104:107], v[164:167], v[136:139], v[104:107]
    ds_read_b128 v[216:219], v8 offset:16384
    v_mfma_f32_16x16x32_bf16 v[108:111], v[164:167], v[140:143], v[108:111]
    ds_read_b128 v[220:223], v8 offset:17408
    v_mfma_f32_16x16x32_bf16 v[112:115], v[168:171], v[136:139], v[112:115]
    buffer_load_dwordx4 v225, s[72:75], s71 offen offset:1024 lds
    v_mfma_f32_16x16x32_bf16 v[116:119], v[168:171], v[140:143], v[116:119]
    buffer_load_dwordx4 v226, s[72:75], s71 offen offset:2048 lds
    v_mfma_f32_16x16x32_bf16 v[120:123], v[172:175], v[136:139], v[120:123]
    v_mfma_f32_16x16x32_bf16 v[124:127], v[172:175], v[140:143], v[124:127]
    buffer_load_dwordx4 v227, s[72:75], s71 offen offset:3072 lds
    s_add_u32 s71, s71, 128
    v_mfma_f32_16x16x32_bf16 v[128:131], v[176:179], v[136:139], v[128:131]
    v_mfma_f32_16x16x32_bf16 v[132:135], v[176:179], v[140:143], v[132:135]
    s_waitcnt vmcnt(18) lgkmcnt(0)
    s_barrier
    v_mfma_f32_16x16x32_bf16 v[64:67], v[188:191], v[180:183], v[64:67]
    ds_read_b128 v[136:139], v13 offset:0
    v_mfma_f32_16x16x32_bf16 v[68:71], v[188:191], v[184:187], v[68:71]
    ds_read_b128 v[140:143], v13 offset:2048
    v_mfma_f32_16x16x32_bf16 v[72:75], v[192:195], v[180:183], v[72:75]
    ds_read_b128 v[144:147], v9 offset:0
    v_mfma_f32_16x16x32_bf16 v[76:79], v[192:195], v[184:187], v[76:79]
    ds_read_b128 v[148:151], v9 offset:1024
    v_mfma_f32_16x16x32_bf16 v[80:83], v[196:199], v[180:183], v[80:83]
    ds_read_b128 v[152:155], v9 offset:2048
    v_mfma_f32_16x16x32_bf16 v[84:87], v[196:199], v[184:187], v[84:87]
    ds_read_b128 v[156:159], v9 offset:3072
    v_mfma_f32_16x16x32_bf16 v[88:91], v[200:203], v[180:183], v[88:91]
    s_getpc_b64 s[4:5]
    s_lshr_b32 s3, s2, 3
    s_lshl_b32 s3, s3, 2
    s_add_u32 s3, s3, s34
    s_mul_i32 s3, s3, 256
    v_min_u32 v1, 1, v2
    v_lshl_add_u32 v1, v1, 7, s3
    v_min_u32 v1, 0x37b0, v1
    global_load_dword v23, v1, s[4:5]
    v_mfma_f32_16x16x32_bf16 v[92:95], v[200:203], v[184:187], v[92:95]
    ds_read_b128 v[160:163], v9 offset:4096
    v_mfma_f32_16x16x32_bf16 v[96:99], v[204:207], v[180:183], v[96:99]
    ds_read_b128 v[164:167], v9 offset:5120
    v_mfma_f32_16x16x32_bf16 v[100:103], v[204:207], v[184:187], v[100:103]
    ds_read_b128 v[168:171], v9 offset:6144
    v_mfma_f32_16x16x32_bf16 v[104:107], v[208:211], v[180:183], v[104:107]
    ds_read_b128 v[172:175], v9 offset:7168
    v_mfma_f32_16x16x32_bf16 v[108:111], v[208:211], v[184:187], v[108:111]
    ds_read_b128 v[176:179], v9 offset:8192
    v_mfma_f32_16x16x32_bf16 v[112:115], v[212:215], v[180:183], v[112:115]
    v_add_u32 v1, s55, v3
    s_add_u32 s55, s55, 1024
    buffer_load_dwordx4 a[48:51], v1, s[76:79], s81 offen sc1
    v_mfma_f32_16x16x32_bf16 v[116:119], v[212:215], v[184:187], v[116:119]
    buffer_load_dwordx4 a[52:55], v1, s[76:79], s82 offen sc1
    v_mfma_f32_16x16x32_bf16 v[120:123], v[216:219], v[180:183], v[120:123]
    buffer_load_dwordx4 a[56:59], v1, s[76:79], s83 offen sc1
    v_mfma_f32_16x16x32_bf16 v[124:127], v[216:219], v[184:187], v[124:127]
    v_mfma_f32_16x16x32_bf16 v[128:131], v[220:223], v[180:183], v[128:131]
    buffer_load_dwordx4 a[60:63], v1, s[76:79], s84 offen sc1
    v_mfma_f32_16x16x32_bf16 v[132:135], v[220:223], v[184:187], v[132:135]
    s_waitcnt lgkmcnt(0)
    v_mfma_f32_16x16x32_bf16 v[64:67], v[144:147], v[136:139], v[64:67]
    ds_read_b128 v[180:183], v17 offset:0
    v_mfma_f32_16x16x32_bf16 v[68:71], v[144:147], v[140:143], v[68:71]
    ds_read_b128 v[184:187], v17 offset:2048
    v_mfma_f32_16x16x32_bf16 v[72:75], v[148:151], v[136:139], v[72:75]
    ds_read_b128 v[188:191], v9 offset:9216
    v_mfma_f32_16x16x32_bf16 v[76:79], v[148:151], v[140:143], v[76:79]
    ds_read_b128 v[192:195], v9 offset:10240
    v_mfma_f32_16x16x32_bf16 v[80:83], v[152:155], v[136:139], v[80:83]
    ds_read_b128 v[196:199], v9 offset:11264
    v_mfma_f32_16x16x32_bf16 v[84:87], v[152:155], v[140:143], v[84:87]
    ds_read_b128 v[200:203], v9 offset:12288
    v_mfma_f32_16x16x32_bf16 v[88:91], v[156:159], v[136:139], v[88:91]
    buffer_load_dwordx4 a[64:67], v1, s[76:79], s85 offen sc1
    v_mfma_f32_16x16x32_bf16 v[92:95], v[156:159], v[140:143], v[92:95]
    ds_read_b128 v[204:207], v9 offset:13312
    v_mfma_f32_16x16x32_bf16 v[96:99], v[160:163], v[136:139], v[96:99]
    ds_read_b128 v[208:211], v9 offset:14336
    v_mfma_f32_16x16x32_bf16 v[100:103], v[160:163], v[140:143], v[100:103]
    ds_read_b128 v[212:215], v9 offset:15360
    v_mfma_f32_16x16x32_bf16 v[104:107], v[164:167], v[136:139], v[104:107]
    ds_read_b128 v[216:219], v9 offset:16384
    v_mfma_f32_16x16x32_bf16 v[108:111], v[164:167], v[140:143], v[108:111]
    ds_read_b128 v[220:223], v9 offset:17408
    v_mfma_f32_16x16x32_bf16 v[112:115], v[168:171], v[136:139], v[112:115]
    v_add_u32 v1, s55, v3
    s_add_u32 s55, s55, 1024
    buffer_load_dwordx4 a[68:71], v1, s[76:79], s81 offen sc1
    v_mfma_f32_16x16x32_bf16 v[116:119], v[168:171], v[140:143], v[116:119]
    buffer_load_dwordx4 a[72:75], v1, s[76:79], s82 offen sc1
    v_mfma_f32_16x16x32_bf16 v[120:123], v[172:175], v[136:139], v[120:123]
    v_mfma_f32_16x16x32_bf16 v[124:127], v[172:175], v[140:143], v[124:127]
    buffer_load_dwordx4 a[76:79], v1, s[76:79], s83 offen sc1
    v_mfma_f32_16x16x32_bf16 v[128:131], v[176:179], v[136:139], v[128:131]
    v_mfma_f32_16x16x32_bf16 v[132:135], v[176:179], v[140:143], v[132:135]
    s_waitcnt vmcnt(18) lgkmcnt(0)
    s_barrier
    v_mfma_f32_16x16x32_bf16 v[64:67], v[188:191], v[180:183], v[64:67]
    ds_read_b128 v[136:139], v14 offset:0
    v_mfma_f32_16x16x32_bf16 v[68:71], v[188:191], v[184:187], v[68:71]
    ds_read_b128 v[140:143], v14 offset:2048
    v_mfma_f32_16x16x32_bf16 v[72:75], v[192:195], v[180:183], v[72:75]
    ds_read_b128 v[144:147], v10 offset:0
    v_mfma_f32_16x16x32_bf16 v[76:79], v[192:195], v[184:187], v[76:79]
    ds_read_b128 v[148:151], v10 offset:1024
    v_mfma_f32_16x16x32_bf16 v[80:83], v[196:199], v[180:183], v[80:83]
    ds_read_b128 v[152:155], v10 offset:2048
    v_mfma_f32_16x16x32_bf16 v[84:87], v[196:199], v[184:187], v[84:87]
    ds_read_b128 v[156:159], v10 offset:3072
    v_mfma_f32_16x16x32_bf16 v[88:91], v[200:203], v[180:183], v[88:91]
    buffer_load_dwordx4 a[80:83], v1, s[76:79], s84 offen sc1
    v_mfma_f32_16x16x32_bf16 v[92:95], v[200:203], v[184:187], v[92:95]
    ds_read_b128 v[160:163], v10 offset:4096
    v_mfma_f32_16x16x32_bf16 v[96:99], v[204:207], v[180:183], v[96:99]
    ds_read_b128 v[164:167], v10 offset:5120
    v_mfma_f32_16x16x32_bf16 v[100:103], v[204:207], v[184:187], v[100:103]
    ds_read_b128 v[168:171], v10 offset:6144
    v_mfma_f32_16x16x32_bf16 v[104:107], v[208:211], v[180:183], v[104:107]
    ds_read_b128 v[172:175], v10 offset:7168
    v_mfma_f32_16x16x32_bf16 v[108:111], v[208:211], v[184:187], v[108:111]
    ds_read_b128 v[176:179], v10 offset:8192
    v_mfma_f32_16x16x32_bf16 v[112:115], v[212:215], v[180:183], v[112:115]
    buffer_load_dwordx4 a[84:87], v1, s[76:79], s85 offen sc1
    v_mfma_f32_16x16x32_bf16 v[116:119], v[212:215], v[184:187], v[116:119]
    v_add_u32 v1, s55, v3
    s_add_u32 s55, s55, 1024
    buffer_load_dwordx4 a[88:91], v1, s[76:79], s81 offen sc1
    v_mfma_f32_16x16x32_bf16 v[120:123], v[216:219], v[180:183], v[120:123]
    v_mfma_f32_16x16x32_bf16 v[124:127], v[216:219], v[184:187], v[124:127]
    buffer_load_dwordx4 a[92:95], v1, s[76:79], s82 offen sc1
    v_mfma_f32_16x16x32_bf16 v[128:131], v[220:223], v[180:183], v[128:131]
    v_mfma_f32_16x16x32_bf16 v[132:135], v[220:223], v[184:187], v[132:135]
    s_waitcnt lgkmcnt(0)
    v_mfma_f32_16x16x32_bf16 v[64:67], v[144:147], v[136:139], v[64:67]
    ds_read_b128 v[180:183], v18 offset:0
    v_mfma_f32_16x16x32_bf16 v[68:71], v[144:147], v[140:143], v[68:71]
    ds_read_b128 v[184:187], v18 offset:2048
    v_mfma_f32_16x16x32_bf16 v[72:75], v[148:151], v[136:139], v[72:75]
    ds_read_b128 v[188:191], v10 offset:9216
    v_mfma_f32_16x16x32_bf16 v[76:79], v[148:151], v[140:143], v[76:79]
    ds_read_b128 v[192:195], v10 offset:10240
    v_mfma_f32_16x16x32_bf16 v[80:83], v[152:155], v[136:139], v[80:83]
    ds_read_b128 v[196:199], v10 offset:11264
    v_mfma_f32_16x16x32_bf16 v[84:87], v[152:155], v[140:143], v[84:87]
    ds_read_b128 v[200:203], v10 offset:12288
    v_mfma_f32_16x16x32_bf16 v[88:91], v[156:159], v[136:139], v[88:91]
    buffer_load_dwordx4 a[96:99], v1, s[76:79], s83 offen sc1
    v_mfma_f32_16x16x32_bf16 v[92:95], v[156:159], v[140:143], v[92:95]
    ds_read_b128 v[204:207], v10 offset:13312
    v_mfma_f32_16x16x32_bf16 v[96:99], v[160:163], v[136:139], v[96:99]
    ds_read_b128 v[208:211], v10 offset:14336
    v_mfma_f32_16x16x32_bf16 v[100:103], v[160:163], v[140:143], v[100:103]
    ds_read_b128 v[212:215], v10 offset:15360
    v_mfma_f32_16x16x32_bf16 v[104:107], v[164:167], v[136:139], v[104:107]
    ds_read_b128 v[216:219], v10 offset:16384
    v_mfma_f32_16x16x32_bf16 v[108:111], v[164:167], v[140:143], v[108:111]
    ds_read_b128 v[220:223], v10 offset:17408
    v_mfma_f32_16x16x32_bf16 v[112:115], v[168:171], v[136:139], v[112:115]
    buffer_load_dwordx4 a[100:103], v1, s[76:79], s84 offen sc1
    v_mfma_f32_16x16x32_bf16 v[116:119], v[168:171], v[140:143], v[116:119]
    buffer_load_dwordx4 a[104:107], v1, s[76:79], s85 offen sc1
    v_mfma_f32_16x16x32_bf16 v[120:123], v[172:175], v[136:139], v[120:123]
    v_add_u32 v1, s55, v3
    s_add_u32 s55, s55, 1024
    buffer_load_dwordx4 a[108:111], v1, s[76:79], s81 offen sc1
    v_mfma_f32_16x16x32_bf16 v[124:127], v[172:175], v[140:143], v[124:127]
    v_mfma_f32_16x16x32_bf16 v[128:131], v[176:179], v[136:139], v[128:131]
    buffer_load_dwordx4 a[112:115], v1, s[76:79], s82 offen sc1
    v_mfma_f32_16x16x32_bf16 v[132:135], v[176:179], v[140:143], v[132:135]
    s_waitcnt vmcnt(18) lgkmcnt(0)
    s_barrier
    v_mfma_f32_16x16x32_bf16 v[64:67], v[188:191], v[180:183], v[64:67]
    ds_read_b128 v[136:139], v15 offset:0
    v_mfma_f32_16x16x32_bf16 v[68:71], v[188:191], v[184:187], v[68:71]
    ds_read_b128 v[140:143], v15 offset:2048
    v_mfma_f32_16x16x32_bf16 v[72:75], v[192:195], v[180:183], v[72:75]
    ds_read_b128 v[144:147], v11 offset:0
    v_mfma_f32_16x16x32_bf16 v[76:79], v[192:195], v[184:187], v[76:79]
    ds_read_b128 v[148:151], v11 offset:1024
    v_mfma_f32_16x16x32_bf16 v[80:83], v[196:199], v[180:183], v[80:83]
    ds_read_b128 v[152:155], v11 offset:2048
    v_mfma_f32_16x16x32_bf16 v[84:87], v[196:199], v[184:187], v[84:87]
    ds_read_b128 v[156:159], v11 offset:3072
    v_mfma_f32_16x16x32_bf16 v[88:91], v[200:203], v[180:183], v[88:91]
    buffer_load_dwordx4 a[116:119], v1, s[76:79], s83 offen sc1
    v_mfma_f32_16x16x32_bf16 v[92:95], v[200:203], v[184:187], v[92:95]
    ds_read_b128 v[160:163], v11 offset:4096
    v_mfma_f32_16x16x32_bf16 v[96:99], v[204:207], v[180:183], v[96:99]
    ds_read_b128 v[164:167], v11 offset:5120
    v_mfma_f32_16x16x32_bf16 v[100:103], v[204:207], v[184:187], v[100:103]
    ds_read_b128 v[168:171], v11 offset:6144
    v_mfma_f32_16x16x32_bf16 v[104:107], v[208:211], v[180:183], v[104:107]
    ds_read_b128 v[172:175], v11 offset:7168
    v_mfma_f32_16x16x32_bf16 v[108:111], v[208:211], v[184:187], v[108:111]
    ds_read_b128 v[176:179], v11 offset:8192
    v_mfma_f32_16x16x32_bf16 v[112:115], v[212:215], v[180:183], v[112:115]
    buffer_load_dwordx4 a[120:123], v1, s[76:79], s84 offen sc1
    v_mfma_f32_16x16x32_bf16 v[116:119], v[212:215], v[184:187], v[116:119]
    buffer_load_dwordx4 a[124:127], v1, s[76:79], s85 offen sc1
    v_mfma_f32_16x16x32_bf16 v[120:123], v[216:219], v[180:183], v[120:123]
    v_mfma_f32_16x16x32_bf16 v[124:127], v[216:219], v[184:187], v[124:127]
    v_add_u32 v1, s55, v3
    s_add_u32 s55, s55, 1024
    buffer_load_dwordx4 a[128:131], v1, s[76:79], s81 offen sc1
    v_mfma_f32_16x16x32_bf16 v[128:131], v[220:223], v[180:183], v[128:131]
    v_mfma_f32_16x16x32_bf16 v[132:135], v[220:223], v[184:187], v[132:135]
    s_waitcnt lgkmcnt(0)
    v_mfma_f32_16x16x32_bf16 v[64:67], v[144:147], v[136:139], v[64:67]
    ds_read_b128 v[180:183], v19 offset:0
    v_mfma_f32_16x16x32_bf16 v[68:71], v[144:147], v[140:143], v[68:71]
    ds_read_b128 v[184:187], v19 offset:2048
    v_mfma_f32_16x16x32_bf16 v[72:75], v[148:151], v[136:139], v[72:75]
    ds_read_b128 v[188:191], v11 offset:9216
    v_mfma_f32_16x16x32_bf16 v[76:79], v[148:151], v[140:143], v[76:79]
    ds_read_b128 v[192:195], v11 offset:10240
    v_mfma_f32_16x16x32_bf16 v[80:83], v[152:155], v[136:139], v[80:83]
    ds_read_b128 v[196:199], v11 offset:11264
    v_mfma_f32_16x16x32_bf16 v[84:87], v[152:155], v[140:143], v[84:87]
    ds_read_b128 v[200:203], v11 offset:12288
    v_mfma_f32_16x16x32_bf16 v[88:91], v[156:159], v[136:139], v[88:91]
    buffer_load_dwordx4 a[132:135], v1, s[76:79], s82 offen sc1
    v_mfma_f32_16x16x32_bf16 v[92:95], v[156:159], v[140:143], v[92:95]
    ds_read_b128 v[204:207], v11 offset:13312
    v_mfma_f32_16x16x32_bf16 v[96:99], v[160:163], v[136:139], v[96:99]
    ds_read_b128 v[208:211], v11 offset:14336
    v_mfma_f32_16x16x32_bf16 v[100:103], v[160:163], v[140:143], v[100:103]
    ds_read_b128 v[212:215], v11 offset:15360
    v_mfma_f32_16x16x32_bf16 v[104:107], v[164:167], v[136:139], v[104:107]
    ds_read_b128 v[216:219], v11 offset:16384
    v_mfma_f32_16x16x32_bf16 v[108:111], v[164:167], v[140:143], v[108:111]
    ds_read_b128 v[220:223], v11 offset:17408
    v_mfma_f32_16x16x32_bf16 v[112:115], v[168:171], v[136:139], v[112:115]
    buffer_load_dwordx4 a[136:139], v1, s[76:79], s83 offen sc1
    v_mfma_f32_16x16x32_bf16 v[116:119], v[168:171], v[140:143], v[116:119]
    buffer_load_dwordx4 a[140:143], v1, s[76:79], s84 offen sc1
    v_mfma_f32_16x16x32_bf16 v[120:123], v[172:175], v[136:139], v[120:123]
    v_mfma_f32_16x16x32_bf16 v[124:127], v[172:175], v[140:143], v[124:127]
    buffer_load_dwordx4 v[228:231], v1, s[76:79], s85 offen sc1
    v_mfma_f32_16x16x32_bf16 v[128:131], v[176:179], v[136:139], v[128:131]
    v_mfma_f32_16x16x32_bf16 v[132:135], v[176:179], v[140:143], v[132:135]
    s_waitcnt lgkmcnt(0)
    v_mfma_f32_16x16x32_bf16 v[64:67], v[188:191], v[180:183], v[64:67]
    v_mfma_f32_16x16x32_bf16 v[68:71], v[188:191], v[184:187], v[68:71]
    v_add_u32 v1, s55, v3
    s_add_u32 s55, s55, 1024
    buffer_load_dwordx4 v[232:235], v1, s[76:79], s81 offen sc1
    v_mfma_f32_16x16x32_bf16 v[72:75], v[192:195], v[180:183], v[72:75]
    v_mfma_f32_16x16x32_bf16 v[76:79], v[192:195], v[184:187], v[76:79]
    v_mfma_f32_16x16x32_bf16 v[80:83], v[196:199], v[180:183], v[80:83]
    v_mfma_f32_16x16x32_bf16 v[84:87], v[196:199], v[184:187], v[84:87]
    buffer_load_dwordx4 v[236:239], v1, s[76:79], s82 offen sc1
    v_mfma_f32_16x16x32_bf16 v[88:91], v[200:203], v[180:183], v[88:91]
    v_mfma_f32_16x16x32_bf16 v[92:95], v[200:203], v[184:187], v[92:95]
    v_mfma_f32_16x16x32_bf16 v[96:99], v[204:207], v[180:183], v[96:99]
    buffer_load_dwordx4 v[240:243], v1, s[76:79], s83 offen sc1
    v_mfma_f32_16x16x32_bf16 v[100:103], v[204:207], v[184:187], v[100:103]
    v_mfma_f32_16x16x32_bf16 v[104:107], v[208:211], v[180:183], v[104:107]
    v_mfma_f32_16x16x32_bf16 v[108:111], v[208:211], v[184:187], v[108:111]
    v_mfma_f32_16x16x32_bf16 v[112:115], v[212:215], v[180:183], v[112:115]
    buffer_load_dwordx4 v[244:247], v1, s[76:79], s84 offen sc1
    v_mfma_f32_16x16x32_bf16 v[116:119], v[212:215], v[184:187], v[116:119]
    v_mfma_f32_16x16x32_bf16 v[120:123], v[216:219], v[180:183], v[120:123]
    v_mfma_f32_16x16x32_bf16 v[124:127], v[216:219], v[184:187], v[124:127]
    v_mfma_f32_16x16x32_bf16 v[128:131], v[220:223], v[180:183], v[128:131]
    buffer_load_dwordx4 v[248:251], v1, s[76:79], s85 offen sc1
    v_mfma_f32_16x16x32_bf16 v[132:135], v[220:223], v[184:187], v[132:135]
    s_branch L_g2epi_44
L_g2nz4_45:
    s_waitcnt vmcnt(8)
    s_barrier
    ds_read_b128 v[136:139], v12 offset:0
    ds_read_b128 v[140:143], v12 offset:2048
    ds_read_b128 v[144:147], v8 offset:0
    ds_read_b128 v[148:151], v8 offset:1024
    ds_read_b128 v[152:155], v8 offset:2048
    ds_read_b128 v[156:159], v8 offset:3072
    ds_read_b128 v[160:163], v8 offset:4096
    ds_read_b128 v[164:167], v8 offset:5120
    ds_read_b128 v[168:171], v8 offset:6144
    ds_read_b128 v[172:175], v8 offset:7168
    ds_read_b128 v[176:179], v8 offset:8192
    s_mov_b32 s37, 7
.p2align 3
L_g2loop_47:
    s_waitcnt lgkmcnt(0)
    v_mfma_f32_16x16x32_bf16 v[64:67], v[144:147], v[136:139], v[64:67]
    ds_read_b128 v[180:183], v16 offset:0
    v_mfma_f32_16x16x32_bf16 v[68:71], v[144:147], v[140:143], v[68:71]
    ds_read_b128 v[184:187], v16 offset:2048
    v_mfma_f32_16x16x32_bf16 v[72:75], v[148:151], v[136:139], v[72:75]
    ds_read_b128 v[188:191], v8 offset:9216
    v_mfma_f32_16x16x32_bf16 v[76:79], v[148:151], v[140:143], v[76:79]
    ds_read_b128 v[192:195], v8 offset:10240
    v_mfma_f32_16x16x32_bf16 v[80:83], v[152:155], v[136:139], v[80:83]
    ds_read_b128 v[196:199], v8 offset:11264
    v_mfma_f32_16x16x32_bf16 v[84:87], v[152:155], v[140:143], v[84:87]
    ds_read_b128 v[200:203], v8 offset:12288
    s_mov_b32 m0, s95
    v_mfma_f32_16x16x32_bf16 v[88:91], v[156:159], v[136:139], v[88:91]
    buffer_load_dwordx4 v224, s[72:75], s71 offen lds
    v_mfma_f32_16x16x32_bf16 v[92:95], v[156:159], v[140:143], v[92:95]
    ds_read_b128 v[204:207], v8 offset:13312
    v_mfma_f32_16x16x32_bf16 v[96:99], v[160:163], v[136:139], v[96:99]
    ds_read_b128 v[208:211], v8 offset:14336
    v_mfma_f32_16x16x32_bf16 v[100:103], v[160:163], v[140:143], v[100:103]
    ds_read_b128 v[212:215], v8 offset:15360
    v_mfma_f32_16x16x32_bf16 v[104:107], v[164:167], v[136:139], v[104:107]
    ds_read_b128 v[216:219], v8 offset:16384
    v_mfma_f32_16x16x32_bf16 v[108:111], v[164:167], v[140:143], v[108:111]
    ds_read_b128 v[220:223], v8 offset:17408
    v_mfma_f32_16x16x32_bf16 v[112:115], v[168:171], v[136:139], v[112:115]
    buffer_load_dwordx4 v225, s[72:75], s71 offen offset:1024 lds
    v_mfma_f32_16x16x32_bf16 v[116:119], v[168:171], v[140:143], v[116:119]
    buffer_load_dwordx4 v226, s[72:75], s71 offen offset:2048 lds
    v_mfma_f32_16x16x32_bf16 v[120:123], v[172:175], v[136:139], v[120:123]
    v_mfma_f32_16x16x32_bf16 v[124:127], v[172:175], v[140:143], v[124:127]
    buffer_load_dwordx4 v227, s[72:75], s71 offen offset:3072 lds
    s_add_u32 s71, s71, 128
    v_mfma_f32_16x16x32_bf16 v[128:131], v[176:179], v[136:139], v[128:131]
    v_mfma_f32_16x16x32_bf16 v[132:135], v[176:179], v[140:143], v[132:135]
    s_waitcnt vmcnt(16) lgkmcnt(0)
    s_barrier
    v_mfma_f32_16x16x32_bf16 v[64:67], v[188:191], v[180:183], v[64:67]
    ds_read_b128 v[136:139], v13 offset:0
    v_mfma_f32_16x16x32_bf16 v[68:71], v[188:191], v[184:187], v[68:71]
    ds_read_b128 v[140:143], v13 offset:2048
    v_mfma_f32_16x16x32_bf16 v[72:75], v[192:195], v[180:183], v[72:75]
    ds_read_b128 v[144:147], v9 offset:0
    v_mfma_f32_16x16x32_bf16 v[76:79], v[192:195], v[184:187], v[76:79]
    ds_read_b128 v[148:151], v9 offset:1024
    v_mfma_f32_16x16x32_bf16 v[80:83], v[196:199], v[180:183], v[80:83]
    ds_read_b128 v[152:155], v9 offset:2048
    v_mfma_f32_16x16x32_bf16 v[84:87], v[196:199], v[184:187], v[84:87]
    ds_read_b128 v[156:159], v9 offset:3072
    s_mov_b32 m0, s40
    v_mfma_f32_16x16x32_bf16 v[88:91], v[200:203], v[180:183], v[88:91]
    buffer_load_dwordx4 v3, s[16:19], s36 offen sc1 lds
    v_mfma_f32_16x16x32_bf16 v[92:95], v[200:203], v[184:187], v[92:95]
    ds_read_b128 v[160:163], v9 offset:4096
    v_mfma_f32_16x16x32_bf16 v[96:99], v[204:207], v[180:183], v[96:99]
    ds_read_b128 v[164:167], v9 offset:5120
    v_mfma_f32_16x16x32_bf16 v[100:103], v[204:207], v[184:187], v[100:103]
    ds_read_b128 v[168:171], v9 offset:6144
    v_mfma_f32_16x16x32_bf16 v[104:107], v[208:211], v[180:183], v[104:107]
    ds_read_b128 v[172:175], v9 offset:7168
    v_mfma_f32_16x16x32_bf16 v[108:111], v[208:211], v[184:187], v[108:111]
    ds_read_b128 v[176:179], v9 offset:8192
    v_mfma_f32_16x16x32_bf16 v[112:115], v[212:215], v[180:183], v[112:115]
    buffer_load_dwordx4 v3, s[16:19], s36 offen offset:1024 sc1 lds
    v_mfma_f32_16x16x32_bf16 v[116:119], v[212:215], v[184:187], v[116:119]
    buffer_load_dwordx4 v3, s[16:19], s36 offen offset:2048 sc1 lds
    v_mfma_f32_16x16x32_bf16 v[120:123], v[216:219], v[180:183], v[120:123]
    v_mfma_f32_16x16x32_bf16 v[124:127], v[216:219], v[184:187], v[124:127]
    buffer_load_dwordx4 v3, s[16:19], s36 offen offset:3072 sc1 lds
    s_add_u32 s36, s36, 18432
    v_mfma_f32_16x16x32_bf16 v[128:131], v[220:223], v[180:183], v[128:131]
    v_mfma_f32_16x16x32_bf16 v[132:135], v[220:223], v[184:187], v[132:135]
    s_waitcnt lgkmcnt(0)
    v_mfma_f32_16x16x32_bf16 v[64:67], v[144:147], v[136:139], v[64:67]
    ds_read_b128 v[180:183], v17 offset:0
    v_mfma_f32_16x16x32_bf16 v[68:71], v[144:147], v[140:143], v[68:71]
    ds_read_b128 v[184:187], v17 offset:2048
    v_mfma_f32_16x16x32_bf16 v[72:75], v[148:151], v[136:139], v[72:75]
    ds_read_b128 v[188:191], v9 offset:9216
    v_mfma_f32_16x16x32_bf16 v[76:79], v[148:151], v[140:143], v[76:79]
    ds_read_b128 v[192:195], v9 offset:10240
    v_mfma_f32_16x16x32_bf16 v[80:83], v[152:155], v[136:139], v[80:83]
    ds_read_b128 v[196:199], v9 offset:11264
    v_mfma_f32_16x16x32_bf16 v[84:87], v[152:155], v[140:143], v[84:87]
    ds_read_b128 v[200:203], v9 offset:12288
    s_mov_b32 m0, s92
    v_mfma_f32_16x16x32_bf16 v[88:91], v[156:159], v[136:139], v[88:91]
    buffer_load_dwordx4 v224, s[72:75], s71 offen lds
    v_mfma_f32_16x16x32_bf16 v[92:95], v[156:159], v[140:143], v[92:95]
    ds_read_b128 v[204:207], v9 offset:13312
    v_mfma_f32_16x16x32_bf16 v[96:99], v[160:163], v[136:139], v[96:99]
    ds_read_b128 v[208:211], v9 offset:14336
    v_mfma_f32_16x16x32_bf16 v[100:103], v[160:163], v[140:143], v[100:103]
    ds_read_b128 v[212:215], v9 offset:15360
    v_mfma_f32_16x16x32_bf16 v[104:107], v[164:167], v[136:139], v[104:107]
    ds_read_b128 v[216:219], v9 offset:16384
    v_mfma_f32_16x16x32_bf16 v[108:111], v[164:167], v[140:143], v[108:111]
    ds_read_b128 v[220:223], v9 offset:17408
    v_mfma_f32_16x16x32_bf16 v[112:115], v[168:171], v[136:139], v[112:115]
    buffer_load_dwordx4 v225, s[72:75], s71 offen offset:1024 lds
    v_mfma_f32_16x16x32_bf16 v[116:119], v[168:171], v[140:143], v[116:119]
    buffer_load_dwordx4 v226, s[72:75], s71 offen offset:2048 lds
    v_mfma_f32_16x16x32_bf16 v[120:123], v[172:175], v[136:139], v[120:123]
    v_mfma_f32_16x16x32_bf16 v[124:127], v[172:175], v[140:143], v[124:127]
    buffer_load_dwordx4 v227, s[72:75], s71 offen offset:3072 lds
    s_add_u32 s71, s71, 128
    v_mfma_f32_16x16x32_bf16 v[128:131], v[176:179], v[136:139], v[128:131]
    v_mfma_f32_16x16x32_bf16 v[132:135], v[176:179], v[140:143], v[132:135]
    s_waitcnt vmcnt(16) lgkmcnt(0)
    s_barrier
    v_mfma_f32_16x16x32_bf16 v[64:67], v[188:191], v[180:183], v[64:67]
    ds_read_b128 v[136:139], v14 offset:0
    v_mfma_f32_16x16x32_bf16 v[68:71], v[188:191], v[184:187], v[68:71]
    ds_read_b128 v[140:143], v14 offset:2048
    v_mfma_f32_16x16x32_bf16 v[72:75], v[192:195], v[180:183], v[72:75]
    ds_read_b128 v[144:147], v10 offset:0
    v_mfma_f32_16x16x32_bf16 v[76:79], v[192:195], v[184:187], v[76:79]
    ds_read_b128 v[148:151], v10 offset:1024
    v_mfma_f32_16x16x32_bf16 v[80:83], v[196:199], v[180:183], v[80:83]
    ds_read_b128 v[152:155], v10 offset:2048
    v_mfma_f32_16x16x32_bf16 v[84:87], v[196:199], v[184:187], v[84:87]
    ds_read_b128 v[156:159], v10 offset:3072
    s_mov_b32 m0, s41
    v_mfma_f32_16x16x32_bf16 v[88:91], v[200:203], v[180:183], v[88:91]
    buffer_load_dwordx4 v3, s[16:19], s36 offen sc1 lds
    v_mfma_f32_16x16x32_bf16 v[92:95], v[200:203], v[184:187], v[92:95]
    ds_read_b128 v[160:163], v10 offset:4096
    v_mfma_f32_16x16x32_bf16 v[96:99], v[204:207], v[180:183], v[96:99]
    ds_read_b128 v[164:167], v10 offset:5120
    v_mfma_f32_16x16x32_bf16 v[100:103], v[204:207], v[184:187], v[100:103]
    ds_read_b128 v[168:171], v10 offset:6144
    v_mfma_f32_16x16x32_bf16 v[104:107], v[208:211], v[180:183], v[104:107]
    ds_read_b128 v[172:175], v10 offset:7168
    v_mfma_f32_16x16x32_bf16 v[108:111], v[208:211], v[184:187], v[108:111]
    ds_read_b128 v[176:179], v10 offset:8192
    v_mfma_f32_16x16x32_bf16 v[112:115], v[212:215], v[180:183], v[112:115]
    buffer_load_dwordx4 v3, s[16:19], s36 offen offset:1024 sc1 lds
    v_mfma_f32_16x16x32_bf16 v[116:119], v[212:215], v[184:187], v[116:119]
    buffer_load_dwordx4 v3, s[16:19], s36 offen offset:2048 sc1 lds
    v_mfma_f32_16x16x32_bf16 v[120:123], v[216:219], v[180:183], v[120:123]
    v_mfma_f32_16x16x32_bf16 v[124:127], v[216:219], v[184:187], v[124:127]
    buffer_load_dwordx4 v3, s[16:19], s36 offen offset:3072 sc1 lds
    s_add_u32 s36, s36, 18432
    v_mfma_f32_16x16x32_bf16 v[128:131], v[220:223], v[180:183], v[128:131]
    v_mfma_f32_16x16x32_bf16 v[132:135], v[220:223], v[184:187], v[132:135]
    s_waitcnt lgkmcnt(0)
    v_mfma_f32_16x16x32_bf16 v[64:67], v[144:147], v[136:139], v[64:67]
    ds_read_b128 v[180:183], v18 offset:0
    v_mfma_f32_16x16x32_bf16 v[68:71], v[144:147], v[140:143], v[68:71]
    ds_read_b128 v[184:187], v18 offset:2048
    v_mfma_f32_16x16x32_bf16 v[72:75], v[148:151], v[136:139], v[72:75]
    ds_read_b128 v[188:191], v10 offset:9216
    v_mfma_f32_16x16x32_bf16 v[76:79], v[148:151], v[140:143], v[76:79]
    ds_read_b128 v[192:195], v10 offset:10240
    v_mfma_f32_16x16x32_bf16 v[80:83], v[152:155], v[136:139], v[80:83]
    ds_read_b128 v[196:199], v10 offset:11264
    v_mfma_f32_16x16x32_bf16 v[84:87], v[152:155], v[140:143], v[84:87]
    ds_read_b128 v[200:203], v10 offset:12288
    s_mov_b32 m0, s93
    v_mfma_f32_16x16x32_bf16 v[88:91], v[156:159], v[136:139], v[88:91]
    buffer_load_dwordx4 v224, s[72:75], s71 offen lds
    v_mfma_f32_16x16x32_bf16 v[92:95], v[156:159], v[140:143], v[92:95]
    ds_read_b128 v[204:207], v10 offset:13312
    v_mfma_f32_16x16x32_bf16 v[96:99], v[160:163], v[136:139], v[96:99]
    ds_read_b128 v[208:211], v10 offset:14336
    v_mfma_f32_16x16x32_bf16 v[100:103], v[160:163], v[140:143], v[100:103]
    ds_read_b128 v[212:215], v10 offset:15360
    v_mfma_f32_16x16x32_bf16 v[104:107], v[164:167], v[136:139], v[104:107]
    ds_read_b128 v[216:219], v10 offset:16384
    v_mfma_f32_16x16x32_bf16 v[108:111], v[164:167], v[140:143], v[108:111]
    ds_read_b128 v[220:223], v10 offset:17408
    v_mfma_f32_16x16x32_bf16 v[112:115], v[168:171], v[136:139], v[112:115]
    buffer_load_dwordx4 v225, s[72:75], s71 offen offset:1024 lds
    v_mfma_f32_16x16x32_bf16 v[116:119], v[168:171], v[140:143], v[116:119]
    buffer_load_dwordx4 v226, s[72:75], s71 offen offset:2048 lds
    v_mfma_f32_16x16x32_bf16 v[120:123], v[172:175], v[136:139], v[120:123]
    v_mfma_f32_16x16x32_bf16 v[124:127], v[172:175], v[140:143], v[124:127]
    buffer_load_dwordx4 v227, s[72:75], s71 offen offset:3072 lds
    s_add_u32 s71, s71, 128
    v_mfma_f32_16x16x32_bf16 v[128:131], v[176:179], v[136:139], v[128:131]
    v_mfma_f32_16x16x32_bf16 v[132:135], v[176:179], v[140:143], v[132:135]
    s_waitcnt vmcnt(16) lgkmcnt(0)
    s_barrier
    v_mfma_f32_16x16x32_bf16 v[64:67], v[188:191], v[180:183], v[64:67]
    ds_read_b128 v[136:139], v15 offset:0
    v_mfma_f32_16x16x32_bf16 v[68:71], v[188:191], v[184:187], v[68:71]
    ds_read_b128 v[140:143], v15 offset:2048
    v_mfma_f32_16x16x32_bf16 v[72:75], v[192:195], v[180:183], v[72:75]
    ds_read_b128 v[144:147], v11 offset:0
    v_mfma_f32_16x16x32_bf16 v[76:79], v[192:195], v[184:187], v[76:79]
    ds_read_b128 v[148:151], v11 offset:1024
    v_mfma_f32_16x16x32_bf16 v[80:83], v[196:199], v[180:183], v[80:83]
    ds_read_b128 v[152:155], v11 offset:2048
    v_mfma_f32_16x16x32_bf16 v[84:87], v[196:199], v[184:187], v[84:87]
    ds_read_b128 v[156:159], v11 offset:3072
    s_mov_b32 m0, s42
    v_mfma_f32_16x16x32_bf16 v[88:91], v[200:203], v[180:183], v[88:91]
    buffer_load_dwordx4 v3, s[16:19], s36 offen sc1 lds
    v_mfma_f32_16x16x32_bf16 v[92:95], v[200:203], v[184:187], v[92:95]
    ds_read_b128 v[160:163], v11 offset:4096
    v_mfma_f32_16x16x32_bf16 v[96:99], v[204:207], v[180:183], v[96:99]
    ds_read_b128 v[164:167], v11 offset:5120
    v_mfma_f32_16x16x32_bf16 v[100:103], v[204:207], v[184:187], v[100:103]
    ds_read_b128 v[168:171], v11 offset:6144
    v_mfma_f32_16x16x32_bf16 v[104:107], v[208:211], v[180:183], v[104:107]
    ds_read_b128 v[172:175], v11 offset:7168
    v_mfma_f32_16x16x32_bf16 v[108:111], v[208:211], v[184:187], v[108:111]
    ds_read_b128 v[176:179], v11 offset:8192
    v_mfma_f32_16x16x32_bf16 v[112:115], v[212:215], v[180:183], v[112:115]
    buffer_load_dwordx4 v3, s[16:19], s36 offen offset:1024 sc1 lds
    v_mfma_f32_16x16x32_bf16 v[116:119], v[212:215], v[184:187], v[116:119]
    buffer_load_dwordx4 v3, s[16:19], s36 offen offset:2048 sc1 lds
    v_mfma_f32_16x16x32_bf16 v[120:123], v[216:219], v[180:183], v[120:123]
    v_mfma_f32_16x16x32_bf16 v[124:127], v[216:219], v[184:187], v[124:127]
    buffer_load_dwordx4 v3, s[16:19], s36 offen offset:3072 sc1 lds
    s_add_u32 s36, s36, 18432
    v_mfma_f32_16x16x32_bf16 v[128:131], v[220:223], v[180:183], v[128:131]
    v_mfma_f32_16x16x32_bf16 v[132:135], v[220:223], v[184:187], v[132:135]
    s_waitcnt lgkmcnt(0)
    v_mfma_f32_16x16x32_bf16 v[64:67], v[144:147], v[136:139], v[64:67]
    ds_read_b128 v[180:183], v19 offset:0
    v_mfma_f32_16x16x32_bf16 v[68:71], v[144:147], v[140:143], v[68:71]
    ds_read_b128 v[184:187], v19 offset:2048
    v_mfma_f32_16x16x32_bf16 v[72:75], v[148:151], v[136:139], v[72:75]
    ds_read_b128 v[188:191], v11 offset:9216
    v_mfma_f32_16x16x32_bf16 v[76:79], v[148:151], v[140:143], v[76:79]
    ds_read_b128 v[192:195], v11 offset:10240
    v_mfma_f32_16x16x32_bf16 v[80:83], v[152:155], v[136:139], v[80:83]
    ds_read_b128 v[196:199], v11 offset:11264
    v_mfma_f32_16x16x32_bf16 v[84:87], v[152:155], v[140:143], v[84:87]
    ds_read_b128 v[200:203], v11 offset:12288
    s_mov_b32 m0, s94
    v_mfma_f32_16x16x32_bf16 v[88:91], v[156:159], v[136:139], v[88:91]
    buffer_load_dwordx4 v224, s[72:75], s71 offen lds
    v_mfma_f32_16x16x32_bf16 v[92:95], v[156:159], v[140:143], v[92:95]
    ds_read_b128 v[204:207], v11 offset:13312
    v_mfma_f32_16x16x32_bf16 v[96:99], v[160:163], v[136:139], v[96:99]
    ds_read_b128 v[208:211], v11 offset:14336
    v_mfma_f32_16x16x32_bf16 v[100:103], v[160:163], v[140:143], v[100:103]
    ds_read_b128 v[212:215], v11 offset:15360
    v_mfma_f32_16x16x32_bf16 v[104:107], v[164:167], v[136:139], v[104:107]
    ds_read_b128 v[216:219], v11 offset:16384
    v_mfma_f32_16x16x32_bf16 v[108:111], v[164:167], v[140:143], v[108:111]
    ds_read_b128 v[220:223], v11 offset:17408
    v_mfma_f32_16x16x32_bf16 v[112:115], v[168:171], v[136:139], v[112:115]
    buffer_load_dwordx4 v225, s[72:75], s71 offen offset:1024 lds
    v_mfma_f32_16x16x32_bf16 v[116:119], v[168:171], v[140:143], v[116:119]
    buffer_load_dwordx4 v226, s[72:75], s71 offen offset:2048 lds
    v_mfma_f32_16x16x32_bf16 v[120:123], v[172:175], v[136:139], v[120:123]
    v_mfma_f32_16x16x32_bf16 v[124:127], v[172:175], v[140:143], v[124:127]
    buffer_load_dwordx4 v227, s[72:75], s71 offen offset:3072 lds
    s_add_u32 s71, s71, 128
    v_mfma_f32_16x16x32_bf16 v[128:131], v[176:179], v[136:139], v[128:131]
    v_mfma_f32_16x16x32_bf16 v[132:135], v[176:179], v[140:143], v[132:135]
    s_waitcnt vmcnt(16) lgkmcnt(0)
    s_barrier
    v_mfma_f32_16x16x32_bf16 v[64:67], v[188:191], v[180:183], v[64:67]
    ds_read_b128 v[136:139], v12 offset:0
    v_mfma_f32_16x16x32_bf16 v[68:71], v[188:191], v[184:187], v[68:71]
    ds_read_b128 v[140:143], v12 offset:2048
    v_mfma_f32_16x16x32_bf16 v[72:75], v[192:195], v[180:183], v[72:75]
    ds_read_b128 v[144:147], v8 offset:0
    v_mfma_f32_16x16x32_bf16 v[76:79], v[192:195], v[184:187], v[76:79]
    ds_read_b128 v[148:151], v8 offset:1024
    v_mfma_f32_16x16x32_bf16 v[80:83], v[196:199], v[180:183], v[80:83]
    ds_read_b128 v[152:155], v8 offset:2048
    v_mfma_f32_16x16x32_bf16 v[84:87], v[196:199], v[184:187], v[84:87]
    ds_read_b128 v[156:159], v8 offset:3072
    s_mov_b32 m0, s43
    v_mfma_f32_16x16x32_bf16 v[88:91], v[200:203], v[180:183], v[88:91]
    buffer_load_dwordx4 v3, s[16:19], s36 offen sc1 lds
    v_mfma_f32_16x16x32_bf16 v[92:95], v[200:203], v[184:187], v[92:95]
    ds_read_b128 v[160:163], v8 offset:4096
    v_mfma_f32_16x16x32_bf16 v[96:99], v[204:207], v[180:183], v[96:99]
    ds_read_b128 v[164:167], v8 offset:5120
    v_mfma_f32_16x16x32_bf16 v[100:103], v[204:207], v[184:187], v[100:103]
    ds_read_b128 v[168:171], v8 offset:6144
    v_mfma_f32_16x16x32_bf16 v[104:107], v[208:211], v[180:183], v[104:107]
    ds_read_b128 v[172:175], v8 offset:7168
    v_mfma_f32_16x16x32_bf16 v[108:111], v[208:211], v[184:187], v[108:111]
    ds_read_b128 v[176:179], v8 offset:8192
    v_mfma_f32_16x16x32_bf16 v[112:115], v[212:215], v[180:183], v[112:115]
    buffer_load_dwordx4 v3, s[16:19], s36 offen offset:1024 sc1 lds
    v_mfma_f32_16x16x32_bf16 v[116:119], v[212:215], v[184:187], v[116:119]
    buffer_load_dwordx4 v3, s[16:19], s36 offen offset:2048 sc1 lds
    v_mfma_f32_16x16x32_bf16 v[120:123], v[216:219], v[180:183], v[120:123]
    v_mfma_f32_16x16x32_bf16 v[124:127], v[216:219], v[184:187], v[124:127]
    buffer_load_dwordx4 v3, s[16:19], s36 offen offset:3072 sc1 lds
    s_add_u32 s36, s36, 18432
    v_mfma_f32_16x16x32_bf16 v[128:131], v[220:223], v[180:183], v[128:131]
    v_mfma_f32_16x16x32_bf16 v[132:135], v[220:223], v[184:187], v[132:135]
    s_sub_u32 s37, s37, 1
    s_cmp_lg_u32 s37, 0
    s_cbranch_scc1 L_g2loop_47
    s_waitcnt lgkmcnt(0)
    v_mfma_f32_16x16x32_bf16 v[64:67], v[144:147], v[136:139], v[64:67]
    ds_read_b128 v[180:183], v16 offset:0
    v_mfma_f32_16x16x32_bf16 v[68:71], v[144:147], v[140:143], v[68:71]
    ds_read_b128 v[184:187], v16 offset:2048
    v_mfma_f32_16x16x32_bf16 v[72:75], v[148:151], v[136:139], v[72:75]
    ds_read_b128 v[188:191], v8 offset:9216
    v_mfma_f32_16x16x32_bf16 v[76:79], v[148:151], v[140:143], v[76:79]
    ds_read_b128 v[192:195], v8 offset:10240
    v_mfma_f32_16x16x32_bf16 v[80:83], v[152:155], v[136:139], v[80:83]
    ds_read_b128 v[196:199], v8 offset:11264
    v_mfma_f32_16x16x32_bf16 v[84:87], v[152:155], v[140:143], v[84:87]
    ds_read_b128 v[200:203], v8 offset:12288
    s_mov_b32 m0, s95
    v_mfma_f32_16x16x32_bf16 v[88:91], v[156:159], v[136:139], v[88:91]
    buffer_load_dwordx4 v224, s[72:75], s71 offen lds
    v_mfma_f32_16x16x32_bf16 v[92:95], v[156:159], v[140:143], v[92:95]
    ds_read_b128 v[204:207], v8 offset:13312
    v_mfma_f32_16x16x32_bf16 v[96:99], v[160:163], v[136:139], v[96:99]
    ds_read_b128 v[208:211], v8 offset:14336
    v_mfma_f32_16x16x32_bf16 v[100:103], v[160:163], v[140:143], v[100:103]
    ds_read_b128 v[212:215], v8 offset:15360
    v_mfma_f32_16x16x32_bf16 v[104:107], v[164:167], v[136:139], v[104:107]
    ds_read_b128 v[216:219], v8 offset:16384
    v_mfma_f32_16x16x32_bf16 v[108:111], v[164:167], v[140:143], v[108:111]
    ds_read_b128 v[220:223], v8 offset:17408
    v_mfma_f32_16x16x32_bf16 v[112:115], v[168:171], v[136:139], v[112:115]
    buffer_load_dwordx4 v225, s[72:75], s71 offen offset:1024 lds
    v_mfma_f32_16x16x32_bf16 v[116:119], v[168:171], v[140:143], v[116:119]
    buffer_load_dwordx4 v226, s[72:75], s71 offen offset:2048 lds
    v_mfma_f32_16x16x32_bf16 v[120:123], v[172:175], v[136:139], v[120:123]
    v_mfma_f32_16x16x32_bf16 v[124:127], v[172:175], v[140:143], v[124:127]
    buffer_load_dwordx4 v227, s[72:75], s71 offen offset:3072 lds
    s_add_u32 s71, s71, 128
    v_mfma_f32_16x16x32_bf16 v[128:131], v[176:179], v[136:139], v[128:131]
    v_mfma_f32_16x16x32_bf16 v[132:135], v[176:179], v[140:143], v[132:135]
    s_waitcnt vmcnt(16) lgkmcnt(0)
    s_barrier
    v_mfma_f32_16x16x32_bf16 v[64:67], v[188:191], v[180:183], v[64:67]
    ds_read_b128 v[136:139], v13 offset:0
    v_mfma_f32_16x16x32_bf16 v[68:71], v[188:191], v[184:187], v[68:71]
    ds_read_b128 v[140:143], v13 offset:2048
    v_mfma_f32_16x16x32_bf16 v[72:75], v[192:195], v[180:183], v[72:75]
    ds_read_b128 v[144:147], v9 offset:0
    v_mfma_f32_16x16x32_bf16 v[76:79], v[192:195], v[184:187], v[76:79]
    ds_read_b128 v[148:151], v9 offset:1024
    v_mfma_f32_16x16x32_bf16 v[80:83], v[196:199], v[180:183], v[80:83]
    ds_read_b128 v[152:155], v9 offset:2048
    v_mfma_f32_16x16x32_bf16 v[84:87], v[196:199], v[184:187], v[84:87]
    ds_read_b128 v[156:159], v9 offset:3072
    v_mfma_f32_16x16x32_bf16 v[88:91], v[200:203], v[180:183], v[88:91]
    s_getpc_b64 s[4:5]
    s_lshr_b32 s3, s2, 3
    s_lshl_b32 s3, s3, 2
    s_add_u32 s3, s3, s34
    s_mul_i32 s3, s3, 256
    v_min_u32 v1, 1, v2
    v_lshl_add_u32 v1, v1, 7, s3
    v_min_u32 v1, 0x25c0, v1
    global_load_dword v23, v1, s[4:5]
    v_mfma_f32_16x16x32_bf16 v[92:95], v[200:203], v[184:187], v[92:95]
    ds_read_b128 v[160:163], v9 offset:4096
    v_mfma_f32_16x16x32_bf16 v[96:99], v[204:207], v[180:183], v[96:99]
    ds_read_b128 v[164:167], v9 offset:5120
    v_mfma_f32_16x16x32_bf16 v[100:103], v[204:207], v[184:187], v[100:103]
    ds_read_b128 v[168:171], v9 offset:6144
    v_mfma_f32_16x16x32_bf16 v[104:107], v[208:211], v[180:183], v[104:107]
    ds_read_b128 v[172:175], v9 offset:7168
    v_mfma_f32_16x16x32_bf16 v[108:111], v[208:211], v[184:187], v[108:111]
    ds_read_b128 v[176:179], v9 offset:8192
    v_mfma_f32_16x16x32_bf16 v[112:115], v[212:215], v[180:183], v[112:115]
    v_add_u32 v1, s55, v3
    s_add_u32 s55, s55, 1024
    buffer_load_dwordx4 a[48:51], v1, s[76:79], s81 offen sc1
    v_mfma_f32_16x16x32_bf16 v[116:119], v[212:215], v[184:187], v[116:119]
    buffer_load_dwordx4 a[52:55], v1, s[76:79], s82 offen sc1
    v_mfma_f32_16x16x32_bf16 v[120:123], v[216:219], v[180:183], v[120:123]
    buffer_load_dwordx4 a[56:59], v1, s[76:79], s83 offen sc1
    v_mfma_f32_16x16x32_bf16 v[124:127], v[216:219], v[184:187], v[124:127]
    v_mfma_f32_16x16x32_bf16 v[128:131], v[220:223], v[180:183], v[128:131]
    buffer_load_dwordx4 a[60:63], v1, s[76:79], s84 offen sc1
    v_mfma_f32_16x16x32_bf16 v[132:135], v[220:223], v[184:187], v[132:135]
    s_waitcnt lgkmcnt(0)
    v_mfma_f32_16x16x32_bf16 v[64:67], v[144:147], v[136:139], v[64:67]
    ds_read_b128 v[180:183], v17 offset:0
    v_mfma_f32_16x16x32_bf16 v[68:71], v[144:147], v[140:143], v[68:71]
    ds_read_b128 v[184:187], v17 offset:2048
    v_mfma_f32_16x16x32_bf16 v[72:75], v[148:151], v[136:139], v[72:75]
    ds_read_b128 v[188:191], v9 offset:9216
    v_mfma_f32_16x16x32_bf16 v[76:79], v[148:151], v[140:143], v[76:79]
    ds_read_b128 v[192:195], v9 offset:10240
    v_mfma_f32_16x16x32_bf16 v[80:83], v[152:155], v[136:139], v[80:83]
    ds_read_b128 v[196:199], v9 offset:11264
    v_mfma_f32_16x16x32_bf16 v[84:87], v[152:155], v[140:143], v[84:87]
    ds_read_b128 v[200:203], v9 offset:12288
    v_mfma_f32_16x16x32_bf16 v[88:91], v[156:159], v[136:139], v[88:91]
    buffer_load_dwordx4 a[64:67], v1, s[76:79], s85 offen sc1
    v_mfma_f32_16x16x32_bf16 v[92:95], v[156:159], v[140:143], v[92:95]
    ds_read_b128 v[204:207], v9 offset:13312
    v_mfma_f32_16x16x32_bf16 v[96:99], v[160:163], v[136:139], v[96:99]
    ds_read_b128 v[208:211], v9 offset:14336
    v_mfma_f32_16x16x32_bf16 v[100:103], v[160:163], v[140:143], v[100:103]
    ds_read_b128 v[212:215], v9 offset:15360
    v_mfma_f32_16x16x32_bf16 v[104:107], v[164:167], v[136:139], v[104:107]
    ds_read_b128 v[216:219], v9 offset:16384
    v_mfma_f32_16x16x32_bf16 v[108:111], v[164:167], v[140:143], v[108:111]
    ds_read_b128 v[220:223], v9 offset:17408
    v_mfma_f32_16x16x32_bf16 v[112:115], v[168:171], v[136:139], v[112:115]
    v_add_u32 v1, s55, v3
    s_add_u32 s55, s55, 1024
    buffer_load_dwordx4 a[68:71], v1, s[76:79], s81 offen sc1
    v_mfma_f32_16x16x32_bf16 v[116:119], v[168:171], v[140:143], v[116:119]
    buffer_load_dwordx4 a[72:75], v1, s[76:79], s82 offen sc1
    v_mfma_f32_16x16x32_bf16 v[120:123], v[172:175], v[136:139], v[120:123]
    v_mfma_f32_16x16x32_bf16 v[124:127], v[172:175], v[140:143], v[124:127]
    buffer_load_dwordx4 a[76:79], v1, s[76:79], s83 offen sc1
    v_mfma_f32_16x16x32_bf16 v[128:131], v[176:179], v[136:139], v[128:131]
    v_mfma_f32_16x16x32_bf16 v[132:135], v[176:179], v[140:143], v[132:135]
    s_waitcnt vmcnt(17) lgkmcnt(0)
    s_barrier
    v_mfma_f32_16x16x32_bf16 v[64:67], v[188:191], v[180:183], v[64:67]
    ds_read_b128 v[136:139], v14 offset:0
    v_mfma_f32_16x16x32_bf16 v[68:71], v[188:191], v[184:187], v[68:71]
    ds_read_b128 v[140:143], v14 offset:2048
    v_mfma_f32_16x16x32_bf16 v[72:75], v[192:195], v[180:183], v[72:75]
    ds_read_b128 v[144:147], v10 offset:0
    v_mfma_f32_16x16x32_bf16 v[76:79], v[192:195], v[184:187], v[76:79]
    ds_read_b128 v[148:151], v10 offset:1024
    v_mfma_f32_16x16x32_bf16 v[80:83], v[196:199], v[180:183], v[80:83]
    ds_read_b128 v[152:155], v10 offset:2048
    v_mfma_f32_16x16x32_bf16 v[84:87], v[196:199], v[184:187], v[84:87]
    ds_read_b128 v[156:159], v10 offset:3072
    v_mfma_f32_16x16x32_bf16 v[88:91], v[200:203], v[180:183], v[88:91]
    buffer_load_dwordx4 a[80:83], v1, s[76:79], s84 offen sc1
    v_mfma_f32_16x16x32_bf16 v[92:95], v[200:203], v[184:187], v[92:95]
    ds_read_b128 v[160:163], v10 offset:4096
    v_mfma_f32_16x16x32_bf16 v[96:99], v[204:207], v[180:183], v[96:99]
    ds_read_b128 v[164:167], v10 offset:5120
    v_mfma_f32_16x16x32_bf16 v[100:103], v[204:207], v[184:187], v[100:103]
    ds_read_b128 v[168:171], v10 offset:6144
    v_mfma_f32_16x16x32_bf16 v[104:107], v[208:211], v[180:183], v[104:107]
    ds_read_b128 v[172:175], v10 offset:7168
    v_mfma_f32_16x16x32_bf16 v[108:111], v[208:211], v[184:187], v[108:111]
    ds_read_b128 v[176:179], v10 offset:8192
    v_mfma_f32_16x16x32_bf16 v[112:115], v[212:215], v[180:183], v[112:115]
    buffer_load_dwordx4 a[84:87], v1, s[76:79], s85 offen sc1
    v_mfma_f32_16x16x32_bf16 v[116:119], v[212:215], v[184:187], v[116:119]
    v_add_u32 v1, s55, v3
    s_add_u32 s55, s55, 1024
    buffer_load_dwordx4 a[88:91], v1, s[76:79], s81 offen sc1
    v_mfma_f32_16x16x32_bf16 v[120:123], v[216:219], v[180:183], v[120:123]
    v_mfma_f32_16x16x32_bf16 v[124:127], v[216:219], v[184:187], v[124:127]
    buffer_load_dwordx4 a[92:95], v1, s[76:79], s82 offen sc1
    v_mfma_f32_16x16x32_bf16 v[128:131], v[220:223], v[180:183], v[128:131]
    v_mfma_f32_16x16x32_bf16 v[132:135], v[220:223], v[184:187], v[132:135]
    s_waitcnt lgkmcnt(0)
    v_mfma_f32_16x16x32_bf16 v[64:67], v[144:147], v[136:139], v[64:67]
    ds_read_b128 v[180:183], v18 offset:0
    v_mfma_f32_16x16x32_bf16 v[68:71], v[144:147], v[140:143], v[68:71]
    ds_read_b128 v[184:187], v18 offset:2048
    v_mfma_f32_16x16x32_bf16 v[72:75], v[148:151], v[136:139], v[72:75]
    ds_read_b128 v[188:191], v10 offset:9216
    v_mfma_f32_16x16x32_bf16 v[76:79], v[148:151], v[140:143], v[76:79]
    ds_read_b128 v[192:195], v10 offset:10240
    v_mfma_f32_16x16x32_bf16 v[80:83], v[152:155], v[136:139], v[80:83]
    ds_read_b128 v[196:199], v10 offset:11264
    v_mfma_f32_16x16x32_bf16 v[84:87], v[152:155], v[140:143], v[84:87]
    ds_read_b128 v[200:203], v10 offset:12288
    v_mfma_f32_16x16x32_bf16 v[88:91], v[156:159], v[136:139], v[88:91]
    buffer_load_dwordx4 a[96:99], v1, s[76:79], s83 offen sc1
    v_mfma_f32_16x16x32_bf16 v[92:95], v[156:159], v[140:143], v[92:95]
    ds_read_b128 v[204:207], v10 offset:13312
    v_mfma_f32_16x16x32_bf16 v[96:99], v[160:163], v[136:139], v[96:99]
    ds_read_b128 v[208:211], v10 offset:14336
    v_mfma_f32_16x16x32_bf16 v[100:103], v[160:163], v[140:143], v[100:103]
    ds_read_b128 v[212:215], v10 offset:15360
    v_mfma_f32_16x16x32_bf16 v[104:107], v[164:167], v[136:139], v[104:107]
    ds_read_b128 v[216:219], v10 offset:16384
    v_mfma_f32_16x16x32_bf16 v[108:111], v[164:167], v[140:143], v[108:111]
    ds_read_b128 v[220:223], v10 offset:17408
    v_mfma_f32_16x16x32_bf16 v[112:115], v[168:171], v[136:139], v[112:115]
    buffer_load_dwordx4 a[100:103], v1, s[76:79], s84 offen sc1
    v_mfma_f32_16x16x32_bf16 v[116:119], v[168:171], v[140:143], v[116:119]
    buffer_load_dwordx4 a[104:107], v1, s[76:79], s85 offen sc1
    v_mfma_f32_16x16x32_bf16 v[120:123], v[172:175], v[136:139], v[120:123]
    v_add_u32 v1, s55, v3
    s_add_u32 s55, s55, 1024
    buffer_load_dwordx4 a[108:111], v1, s[76:79], s81 offen sc1
    v_mfma_f32_16x16x32_bf16 v[124:127], v[172:175], v[140:143], v[124:127]
    v_mfma_f32_16x16x32_bf16 v[128:131], v[176:179], v[136:139], v[128:131]
    buffer_load_dwordx4 a[112:115], v1, s[76:79], s82 offen sc1
    v_mfma_f32_16x16x32_bf16 v[132:135], v[176:179], v[140:143], v[132:135]
    s_waitcnt vmcnt(18) lgkmcnt(0)
    s_barrier
    v_mfma_f32_16x16x32_bf16 v[64:67], v[188:191], v[180:183], v[64:67]
    ds_read_b128 v[136:139], v15 offset:0
    v_mfma_f32_16x16x32_bf16 v[68:71], v[188:191], v[184:187], v[68:71]
    ds_read_b128 v[140:143], v15 offset:2048
    v_mfma_f32_16x16x32_bf16 v[72:75], v[192:195], v[180:183], v[72:75]
    ds_read_b128 v[144:147], v11 offset:0
    v_mfma_f32_16x16x32_bf16 v[76:79], v[192:195], v[184:187], v[76:79]
    ds_read_b128 v[148:151], v11 offset:1024
    v_mfma_f32_16x16x32_bf16 v[80:83], v[196:199], v[180:183], v[80:83]
    ds_read_b128 v[152:155], v11 offset:2048
    v_mfma_f32_16x16x32_bf16 v[84:87], v[196:199], v[184:187], v[84:87]
    ds_read_b128 v[156:159], v11 offset:3072
    v_mfma_f32_16x16x32_bf16 v[88:91], v[200:203], v[180:183], v[88:91]
    buffer_load_dwordx4 a[116:119], v1, s[76:79], s83 offen sc1
    v_mfma_f32_16x16x32_bf16 v[92:95], v[200:203], v[184:187], v[92:95]
    ds_read_b128 v[160:163], v11 offset:4096
    v_mfma_f32_16x16x32_bf16 v[96:99], v[204:207], v[180:183], v[96:99]
    ds_read_b128 v[164:167], v11 offset:5120
    v_mfma_f32_16x16x32_bf16 v[100:103], v[204:207], v[184:187], v[100:103]
    ds_read_b128 v[168:171], v11 offset:6144
    v_mfma_f32_16x16x32_bf16 v[104:107], v[208:211], v[180:183], v[104:107]
    ds_read_b128 v[172:175], v11 offset:7168
    v_mfma_f32_16x16x32_bf16 v[108:111], v[208:211], v[184:187], v[108:111]
    ds_read_b128 v[176:179], v11 offset:8192
    v_mfma_f32_16x16x32_bf16 v[112:115], v[212:215], v[180:183], v[112:115]
    buffer_load_dwordx4 a[120:123], v1, s[76:79], s84 offen sc1
    v_mfma_f32_16x16x32_bf16 v[116:119], v[212:215], v[184:187], v[116:119]
    buffer_load_dwordx4 a[124:127], v1, s[76:79], s85 offen sc1
    v_mfma_f32_16x16x32_bf16 v[120:123], v[216:219], v[180:183], v[120:123]
    v_mfma_f32_16x16x32_bf16 v[124:127], v[216:219], v[184:187], v[124:127]
    v_add_u32 v1, s55, v3
    s_add_u32 s55, s55, 1024
    buffer_load_dwordx4 a[128:131], v1, s[76:79], s81 offen sc1
    v_mfma_f32_16x16x32_bf16 v[128:131], v[220:223], v[180:183], v[128:131]
    v_mfma_f32_16x16x32_bf16 v[132:135], v[220:223], v[184:187], v[132:135]
    s_waitcnt lgkmcnt(0)
    v_mfma_f32_16x16x32_bf16 v[64:67], v[144:147], v[136:139], v[64:67]
    ds_read_b128 v[180:183], v19 offset:0
    v_mfma_f32_16x16x32_bf16 v[68:71], v[144:147], v[140:143], v[68:71]
    ds_read_b128 v[184:187], v19 offset:2048
    v_mfma_f32_16x16x32_bf16 v[72:75], v[148:151], v[136:139], v[72:75]
    ds_read_b128 v[188:191], v11 offset:9216
    v_mfma_f32_16x16x32_bf16 v[76:79], v[148:151], v[140:143], v[76:79]
    ds_read_b128 v[192:195], v11 offset:10240
    v_mfma_f32_16x16x32_bf16 v[80:83], v[152:155], v[136:139], v[80:83]
    ds_read_b128 v[196:199], v11 offset:11264
    v_mfma_f32_16x16x32_bf16 v[84:87], v[152:155], v[140:143], v[84:87]
    ds_read_b128 v[200:203], v11 offset:12288
    v_mfma_f32_16x16x32_bf16 v[88:91], v[156:159], v[136:139], v[88:91]
    buffer_load_dwordx4 a[132:135], v1, s[76:79], s82 offen sc1
    v_mfma_f32_16x16x32_bf16 v[92:95], v[156:159], v[140:143], v[92:95]
    ds_read_b128 v[204:207], v11 offset:13312
    v_mfma_f32_16x16x32_bf16 v[96:99], v[160:163], v[136:139], v[96:99]
    ds_read_b128 v[208:211], v11 offset:14336
    v_mfma_f32_16x16x32_bf16 v[100:103], v[160:163], v[140:143], v[100:103]
    ds_read_b128 v[212:215], v11 offset:15360
    v_mfma_f32_16x16x32_bf16 v[104:107], v[164:167], v[136:139], v[104:107]
    ds_read_b128 v[216:219], v11 offset:16384
    v_mfma_f32_16x16x32_bf16 v[108:111], v[164:167], v[140:143], v[108:111]
    ds_read_b128 v[220:223], v11 offset:17408
    v_mfma_f32_16x16x32_bf16 v[112:115], v[168:171], v[136:139], v[112:115]
    buffer_load_dwordx4 a[136:139], v1, s[76:79], s83 offen sc1
    v_mfma_f32_16x16x32_bf16 v[116:119], v[168:171], v[140:143], v[116:119]
    buffer_load_dwordx4 a[140:143], v1, s[76:79], s84 offen sc1
    v_mfma_f32_16x16x32_bf16 v[120:123], v[172:175], v[136:139], v[120:123]
    v_mfma_f32_16x16x32_bf16 v[124:127], v[172:175], v[140:143], v[124:127]
    buffer_load_dwordx4 v[228:231], v1, s[76:79], s85 offen sc1
    v_mfma_f32_16x16x32_bf16 v[128:131], v[176:179], v[136:139], v[128:131]
    v_mfma_f32_16x16x32_bf16 v[132:135], v[176:179], v[140:143], v[132:135]
    s_waitcnt lgkmcnt(0)
    v_mfma_f32_16x16x32_bf16 v[64:67], v[188:191], v[180:183], v[64:67]
    v_mfma_f32_16x16x32_bf16 v[68:71], v[188:191], v[184:187], v[68:71]
    v_add_u32 v1, s55, v3
    s_add_u32 s55, s55, 1024
    buffer_load_dwordx4 v[232:235], v1, s[76:79], s81 offen sc1
    v_mfma_f32_16x16x32_bf16 v[72:75], v[192:195], v[180:183], v[72:75]
    v_mfma_f32_16x16x32_bf16 v[76:79], v[192:195], v[184:187], v[76:79]
    v_mfma_f32_16x16x32_bf16 v[80:83], v[196:199], v[180:183], v[80:83]
    v_mfma_f32_16x16x32_bf16 v[84:87], v[196:199], v[184:187], v[84:87]
    buffer_load_dwordx4 v[236:239], v1, s[76:79], s82 offen sc1
    v_mfma_f32_16x16x32_bf16 v[88:91], v[200:203], v[180:183], v[88:91]
    v_mfma_f32_16x16x32_bf16 v[92:95], v[200:203], v[184:187], v[92:95]
    v_mfma_f32_16x16x32_bf16 v[96:99], v[204:207], v[180:183], v[96:99]
    buffer_load_dwordx4 v[240:243], v1, s[76:79], s83 offen sc1
    v_mfma_f32_16x16x32_bf16 v[100:103], v[204:207], v[184:187], v[100:103]
    v_mfma_f32_16x16x32_bf16 v[104:107], v[208:211], v[180:183], v[104:107]
    v_mfma_f32_16x16x32_bf16 v[108:111], v[208:211], v[184:187], v[108:111]
    v_mfma_f32_16x16x32_bf16 v[112:115], v[212:215], v[180:183], v[112:115]
    buffer_load_dwordx4 v[244:247], v1, s[76:79], s84 offen sc1
    v_mfma_f32_16x16x32_bf16 v[116:119], v[212:215], v[184:187], v[116:119]
    v_mfma_f32_16x16x32_bf16 v[120:123], v[216:219], v[180:183], v[120:123]
    v_mfma_f32_16x16x32_bf16 v[124:127], v[216:219], v[184:187], v[124:127]
    v_mfma_f32_16x16x32_bf16 v[128:131], v[220:223], v[180:183], v[128:131]
    buffer_load_dwordx4 v[248:251], v1, s[76:79], s85 offen sc1
    v_mfma_f32_16x16x32_bf16 v[132:135], v[220:223], v[184:187], v[132:135]
L_g2epi_44:
    s_lshl_b32 s3, s32, 2
    s_add_u32 s3, s3, s34
    s_mul_i32 s3, s3, 72
    s_lshr_b32 s10, s33, 1
    s_mul_i32 s10, s10, 9
    s_add_u32 s3, s3, s10
    s_lshl_b32 s3, s3, 11
    v_lshlrev_b32 v19, 3, v2
    s_bitcmp1_b32 s33, 0
    s_cbranch_scc1 L_g2odd_48
    v_lshlrev_b32 v8, 16, v28
    v_and_b32 v9, 0xffff0000, v28
    v_lshlrev_b32 v10, 16, v29
    v_and_b32 v11, 0xffff0000, v29
    v_pk_mul_f32 v[64:65], v[64:65], v[8:9]
    v_pk_mul_f32 v[66:67], v[66:67], v[10:11]
    v_cvt_pk_bf16_f32 v136, v64, v65
    v_cvt_pk_bf16_f32 v137, v66, v67
    v_lshlrev_b32 v12, 16, v30
    v_and_b32 v13, 0xffff0000, v30
    v_lshlrev_b32 v14, 16, v31
    v_and_b32 v15, 0xffff0000, v31
    v_pk_mul_f32 v[68:69], v[68:69], v[12:13]
    v_pk_mul_f32 v[70:71], v[70:71], v[14:15]
    v_cvt_pk_bf16_f32 v160, v68, v69
    v_cvt_pk_bf16_f32 v161, v70, v71
    v_lshlrev_b32 v8, 16, v32
    v_and_b32 v9, 0xffff0000, v32
    v_lshlrev_b32 v10, 16, v33
    v_and_b32 v11, 0xffff0000, v33
    v_pk_mul_f32 v[72:73], v[72:73], v[8:9]
    v_pk_mul_f32 v[74:75], v[74:75], v[10:11]
    v_cvt_pk_bf16_f32 v138, v72, v73
    v_cvt_pk_bf16_f32 v139, v74, v75
    buffer_store_dwordx4 v[136:139], v3, s[24:27], s3 offen offset:0 sc1
    v_lshlrev_b32 v12, 16, v34
    v_and_b32 v13, 0xffff0000, v34
    v_lshlrev_b32 v14, 16, v35
    v_and_b32 v15, 0xffff0000, v35
    v_pk_mul_f32 v[76:77], v[76:77], v[12:13]
    v_pk_mul_f32 v[78:79], v[78:79], v[14:15]
    v_cvt_pk_bf16_f32 v162, v76, v77
    v_cvt_pk_bf16_f32 v163, v78, v79
    buffer_store_dwordx4 v[160:163], v3, s[24:27], s3 offen offset:1024 sc1
    s_add_u32 s3, s3, 2048
    v_lshlrev_b32 v8, 16, v36
    v_and_b32 v9, 0xffff0000, v36
    v_lshlrev_b32 v10, 16, v37
    v_and_b32 v11, 0xffff0000, v37
    v_pk_mul_f32 v[80:81], v[80:81], v[8:9]
    v_pk_mul_f32 v[82:83], v[82:83], v[10:11]
    v_cvt_pk_bf16_f32 v140, v80, v81
    v_cvt_pk_bf16_f32 v141, v82, v83
    v_lshlrev_b32 v12, 16, v38
    v_and_b32 v13, 0xffff0000, v38
    v_lshlrev_b32 v14, 16, v39
    v_and_b32 v15, 0xffff0000, v39
    v_pk_mul_f32 v[84:85], v[84:85], v[12:13]
    v_pk_mul_f32 v[86:87], v[86:87], v[14:15]
    v_cvt_pk_bf16_f32 v164, v84, v85
    v_cvt_pk_bf16_f32 v165, v86, v87
    v_lshlrev_b32 v8, 16, v40
    v_and_b32 v9, 0xffff0000, v40
    v_lshlrev_b32 v10, 16, v41
    v_and_b32 v11, 0xffff0000, v41
    v_pk_mul_f32 v[88:89], v[88:89], v[8:9]
    v_pk_mul_f32 v[90:91], v[90:91], v[10:11]
    v_cvt_pk_bf16_f32 v142, v88, v89
    v_cvt_pk_bf16_f32 v143, v90, v91
    buffer_store_dwordx4 v[140:143], v3, s[24:27], s3 offen offset:0 sc1
    v_lshlrev_b32 v12, 16, v42
    v_and_b32 v13, 0xffff0000, v42
    v_lshlrev_b32 v14, 16, v43
    v_and_b32 v15, 0xffff0000, v43
    v_pk_mul_f32 v[92:93], v[92:93], v[12:13]
    v_pk_mul_f32 v[94:95], v[94:95], v[14:15]
    v_cvt_pk_bf16_f32 v166, v92, v93
    v_cvt_pk_bf16_f32 v167, v94, v95
    buffer_store_dwordx4 v[164:167], v3, s[24:27], s3 offen offset:1024 sc1
    s_add_u32 s3, s3, 2048
    v_lshlrev_b32 v8, 16, v44
    v_and_b32 v9, 0xffff0000, v44
    v_lshlrev_b32 v10, 16, v45
    v_and_b32 v11, 0xffff0000, v45
    v_pk_mul_f32 v[96:97], v[96:97], v[8:9]
    v_pk_mul_f32 v[98:99], v[98:99], v[10:11]
    v_cvt_pk_bf16_f32 v144, v96, v97
    v_cvt_pk_bf16_f32 v145, v98, v99
    v_lshlrev_b32 v12, 16, v46
    v_and_b32 v13, 0xffff0000, v46
    v_lshlrev_b32 v14, 16, v47
    v_and_b32 v15, 0xffff0000, v47
    v_pk_mul_f32 v[100:101], v[100:101], v[12:13]
    v_pk_mul_f32 v[102:103], v[102:103], v[14:15]
    v_cvt_pk_bf16_f32 v168, v100, v101
    v_cvt_pk_bf16_f32 v169, v102, v103
    v_lshlrev_b32 v8, 16, v48
    v_and_b32 v9, 0xffff0000, v48
    v_lshlrev_b32 v10, 16, v49
    v_and_b32 v11, 0xffff0000, v49
    v_pk_mul_f32 v[104:105], v[104:105], v[8:9]
    v_pk_mul_f32 v[106:107], v[106:107], v[10:11]
    v_cvt_pk_bf16_f32 v146, v104, v105
    v_cvt_pk_bf16_f32 v147, v106, v107
    buffer_store_dwordx4 v[144:147], v3, s[24:27], s3 offen offset:0 sc1
    v_lshlrev_b32 v12, 16, v50
    v_and_b32 v13, 0xffff0000, v50
    v_lshlrev_b32 v14, 16, v51
    v_and_b32 v15, 0xffff0000, v51
    v_pk_mul_f32 v[108:109], v[108:109], v[12:13]
    v_pk_mul_f32 v[110:111], v[110:111], v[14:15]
    v_cvt_pk_bf16_f32 v170, v108, v109
    v_cvt_pk_bf16_f32 v171, v110, v111
    buffer_store_dwordx4 v[168:171], v3, s[24:27], s3 offen offset:1024 sc1
    s_add_u32 s3, s3, 2048
    v_lshlrev_b32 v8, 16, v52
    v_and_b32 v9, 0xffff0000, v52
    v_lshlrev_b32 v10, 16, v53
    v_and_b32 v11, 0xffff0000, v53
    v_pk_mul_f32 v[112:113], v[112:113], v[8:9]
    v_pk_mul_f32 v[114:115], v[114:115], v[10:11]
    v_cvt_pk_bf16_f32 v148, v112, v113
    v_cvt_pk_bf16_f32 v149, v114, v115
    v_lshlrev_b32 v12, 16, v54
    v_and_b32 v13, 0xffff0000, v54
    v_lshlrev_b32 v14, 16, v55
    v_and_b32 v15, 0xffff0000, v55
    v_pk_mul_f32 v[116:117], v[116:117], v[12:13]
    v_pk_mul_f32 v[118:119], v[118:119], v[14:15]
    v_cvt_pk_bf16_f32 v172, v116, v117
    v_cvt_pk_bf16_f32 v173, v118, v119
    v_lshlrev_b32 v8, 16, v56
    v_and_b32 v9, 0xffff0000, v56
    v_lshlrev_b32 v10, 16, v57
    v_and_b32 v11, 0xffff0000, v57
    v_pk_mul_f32 v[120:121], v[120:121], v[8:9]
    v_pk_mul_f32 v[122:123], v[122:123], v[10:11]
    v_cvt_pk_bf16_f32 v150, v120, v121
    v_cvt_pk_bf16_f32 v151, v122, v123
    buffer_store_dwordx4 v[148:151], v3, s[24:27], s3 offen offset:0 sc1
    v_lshlrev_b32 v12, 16, v58
    v_and_b32 v13, 0xffff0000, v58
    v_lshlrev_b32 v14, 16, v59
    v_and_b32 v15, 0xffff0000, v59
    v_pk_mul_f32 v[124:125], v[124:125], v[12:13]
    v_pk_mul_f32 v[126:127], v[126:127], v[14:15]
    v_cvt_pk_bf16_f32 v174, v124, v125
    v_cvt_pk_bf16_f32 v175, v126, v127
    buffer_store_dwordx4 v[172:175], v3, s[24:27], s3 offen offset:1024 sc1
    s_add_u32 s3, s3, 2048
    v_lshlrev_b32 v8, 16, v60
    v_and_b32 v9, 0xffff0000, v60
    v_lshlrev_b32 v10, 16, v61
    v_and_b32 v11, 0xffff0000, v61
    v_pk_mul_f32 v[128:129], v[128:129], v[8:9]
    v_pk_mul_f32 v[130:131], v[130:131], v[10:11]
    v_cvt_pk_bf16_f32 v152, v128, v129
    v_cvt_pk_bf16_f32 v153, v130, v131
    buffer_store_dwordx2 v[152:153], v19, s[24:27], s3 offen offset:0 sc1
    v_lshlrev_b32 v12, 16, v62
    v_and_b32 v13, 0xffff0000, v62
    v_lshlrev_b32 v14, 16, v63
    v_and_b32 v15, 0xffff0000, v63
    v_pk_mul_f32 v[132:133], v[132:133], v[12:13]
    v_pk_mul_f32 v[134:135], v[134:135], v[14:15]
    v_cvt_pk_bf16_f32 v176, v132, v133
    v_cvt_pk_bf16_f32 v177, v134, v135
    buffer_store_dwordx2 v[176:177], v19, s[24:27], s3 offen offset:1024 sc1
    s_branch L_g2fin_49
L_g2odd_48:
    s_add_u32 s3, s3, 8192
    v_lshlrev_b32 v8, 16, v28
    v_and_b32 v9, 0xffff0000, v28
    v_lshlrev_b32 v10, 16, v29
    v_and_b32 v11, 0xffff0000, v29
    v_pk_mul_f32 v[64:65], v[64:65], v[8:9]
    v_pk_mul_f32 v[66:67], v[66:67], v[10:11]
    v_cvt_pk_bf16_f32 v136, v64, v65
    v_cvt_pk_bf16_f32 v137, v66, v67
    buffer_store_dwordx2 v[136:137], v19, s[24:27], s3 offen offset:512 sc1
    v_lshlrev_b32 v12, 16, v30
    v_and_b32 v13, 0xffff0000, v30
    v_lshlrev_b32 v14, 16, v31
    v_and_b32 v15, 0xffff0000, v31
    v_pk_mul_f32 v[68:69], v[68:69], v[12:13]
    v_pk_mul_f32 v[70:71], v[70:71], v[14:15]
    v_cvt_pk_bf16_f32 v160, v68, v69
    v_cvt_pk_bf16_f32 v161, v70, v71
    buffer_store_dwordx2 v[160:161], v19, s[24:27], s3 offen offset:1536 sc1
    s_add_u32 s3, s3, 2048
    v_lshlrev_b32 v8, 16, v32
    v_and_b32 v9, 0xffff0000, v32
    v_lshlrev_b32 v10, 16, v33
    v_and_b32 v11, 0xffff0000, v33
    v_pk_mul_f32 v[72:73], v[72:73], v[8:9]
    v_pk_mul_f32 v[74:75], v[74:75], v[10:11]
    v_cvt_pk_bf16_f32 v138, v72, v73
    v_cvt_pk_bf16_f32 v139, v74, v75
    v_lshlrev_b32 v12, 16, v34
    v_and_b32 v13, 0xffff0000, v34
    v_lshlrev_b32 v14, 16, v35
    v_and_b32 v15, 0xffff0000, v35
    v_pk_mul_f32 v[76:77], v[76:77], v[12:13]
    v_pk_mul_f32 v[78:79], v[78:79], v[14:15]
    v_cvt_pk_bf16_f32 v162, v76, v77
    v_cvt_pk_bf16_f32 v163, v78, v79
    v_lshlrev_b32 v8, 16, v36
    v_and_b32 v9, 0xffff0000, v36
    v_lshlrev_b32 v10, 16, v37
    v_and_b32 v11, 0xffff0000, v37
    v_pk_mul_f32 v[80:81], v[80:81], v[8:9]
    v_pk_mul_f32 v[82:83], v[82:83], v[10:11]
    v_cvt_pk_bf16_f32 v140, v80, v81
    v_cvt_pk_bf16_f32 v141, v82, v83
    buffer_store_dwordx4 v[138:141], v3, s[24:27], s3 offen offset:0 sc1
    v_lshlrev_b32 v12, 16, v38
    v_and_b32 v13, 0xffff0000, v38
    v_lshlrev_b32 v14, 16, v39
    v_and_b32 v15, 0xffff0000, v39
    v_pk_mul_f32 v[84:85], v[84:85], v[12:13]
    v_pk_mul_f32 v[86:87], v[86:87], v[14:15]
    v_cvt_pk_bf16_f32 v164, v84, v85
    v_cvt_pk_bf16_f32 v165, v86, v87
    buffer_store_dwordx4 v[162:165], v3, s[24:27], s3 offen offset:1024 sc1
    s_add_u32 s3, s3, 2048
    v_lshlrev_b32 v8, 16, v40
    v_and_b32 v9, 0xffff0000, v40
    v_lshlrev_b32 v10, 16, v41
    v_and_b32 v11, 0xffff0000, v41
    v_pk_mul_f32 v[88:89], v[88:89], v[8:9]
    v_pk_mul_f32 v[90:91], v[90:91], v[10:11]
    v_cvt_pk_bf16_f32 v142, v88, v89
    v_cvt_pk_bf16_f32 v143, v90, v91
    v_lshlrev_b32 v12, 16, v42
    v_and_b32 v13, 0xffff0000, v42
    v_lshlrev_b32 v14, 16, v43
    v_and_b32 v15, 0xffff0000, v43
    v_pk_mul_f32 v[92:93], v[92:93], v[12:13]
    v_pk_mul_f32 v[94:95], v[94:95], v[14:15]
    v_cvt_pk_bf16_f32 v166, v92, v93
    v_cvt_pk_bf16_f32 v167, v94, v95
    v_lshlrev_b32 v8, 16, v44
    v_and_b32 v9, 0xffff0000, v44
    v_lshlrev_b32 v10, 16, v45
    v_and_b32 v11, 0xffff0000, v45
    v_pk_mul_f32 v[96:97], v[96:97], v[8:9]
    v_pk_mul_f32 v[98:99], v[98:99], v[10:11]
    v_cvt_pk_bf16_f32 v144, v96, v97
    v_cvt_pk_bf16_f32 v145, v98, v99
    buffer_store_dwordx4 v[142:145], v3, s[24:27], s3 offen offset:0 sc1
    v_lshlrev_b32 v12, 16, v46
    v_and_b32 v13, 0xffff0000, v46
    v_lshlrev_b32 v14, 16, v47
    v_and_b32 v15, 0xffff0000, v47
    v_pk_mul_f32 v[100:101], v[100:101], v[12:13]
    v_pk_mul_f32 v[102:103], v[102:103], v[14:15]
    v_cvt_pk_bf16_f32 v168, v100, v101
    v_cvt_pk_bf16_f32 v169, v102, v103
    buffer_store_dwordx4 v[166:169], v3, s[24:27], s3 offen offset:1024 sc1
    s_add_u32 s3, s3, 2048
    v_lshlrev_b32 v8, 16, v48
    v_and_b32 v9, 0xffff0000, v48
    v_lshlrev_b32 v10, 16, v49
    v_and_b32 v11, 0xffff0000, v49
    v_pk_mul_f32 v[104:105], v[104:105], v[8:9]
    v_pk_mul_f32 v[106:107], v[106:107], v[10:11]
    v_cvt_pk_bf16_f32 v146, v104, v105
    v_cvt_pk_bf16_f32 v147, v106, v107
    v_lshlrev_b32 v12, 16, v50
    v_and_b32 v13, 0xffff0000, v50
    v_lshlrev_b32 v14, 16, v51
    v_and_b32 v15, 0xffff0000, v51
    v_pk_mul_f32 v[108:109], v[108:109], v[12:13]
    v_pk_mul_f32 v[110:111], v[110:111], v[14:15]
    v_cvt_pk_bf16_f32 v170, v108, v109
    v_cvt_pk_bf16_f32 v171, v110, v111
    v_lshlrev_b32 v8, 16, v52
    v_and_b32 v9, 0xffff0000, v52
    v_lshlrev_b32 v10, 16, v53
    v_and_b32 v11, 0xffff0000, v53
    v_pk_mul_f32 v[112:113], v[112:113], v[8:9]
    v_pk_mul_f32 v[114:115], v[114:115], v[10:11]
    v_cvt_pk_bf16_f32 v148, v112, v113
    v_cvt_pk_bf16_f32 v149, v114, v115
    buffer_store_dwordx4 v[146:149], v3, s[24:27], s3 offen offset:0 sc1
    v_lshlrev_b32 v12, 16, v54
    v_and_b32 v13, 0xffff0000, v54
    v_lshlrev_b32 v14, 16, v55
    v_and_b32 v15, 0xffff0000, v55
    v_pk_mul_f32 v[116:117], v[116:117], v[12:13]
    v_pk_mul_f32 v[118:119], v[118:119], v[14:15]
    v_cvt_pk_bf16_f32 v172, v116, v117
    v_cvt_pk_bf16_f32 v173, v118, v119
    buffer_store_dwordx4 v[170:173], v3, s[24:27], s3 offen offset:1024 sc1
    s_add_u32 s3, s3, 2048
    v_lshlrev_b32 v8, 16, v56
    v_and_b32 v9, 0xffff0000, v56
    v_lshlrev_b32 v10, 16, v57
    v_and_b32 v11, 0xffff0000, v57
    v_pk_mul_f32 v[120:121], v[120:121], v[8:9]
    v_pk_mul_f32 v[122:123], v[122:123], v[10:11]
    v_cvt_pk_bf16_f32 v150, v120, v121
    v_cvt_pk_bf16_f32 v151, v122, v123
    v_lshlrev_b32 v12, 16, v58
    v_and_b32 v13, 0xffff0000, v58
    v_lshlrev_b32 v14, 16, v59
    v_and_b32 v15, 0xffff0000, v59
    v_pk_mul_f32 v[124:125], v[124:125], v[12:13]
    v_pk_mul_f32 v[126:127], v[126:127], v[14:15]
    v_cvt_pk_bf16_f32 v174, v124, v125
    v_cvt_pk_bf16_f32 v175, v126, v127
    v_lshlrev_b32 v8, 16, v60
    v_and_b32 v9, 0xffff0000, v60
    v_lshlrev_b32 v10, 16, v61
    v_and_b32 v11, 0xffff0000, v61
    v_pk_mul_f32 v[128:129], v[128:129], v[8:9]
    v_pk_mul_f32 v[130:131], v[130:131], v[10:11]
    v_cvt_pk_bf16_f32 v152, v128, v129
    v_cvt_pk_bf16_f32 v153, v130, v131
    buffer_store_dwordx4 v[150:153], v3, s[24:27], s3 offen offset:0 sc1
    v_lshlrev_b32 v12, 16, v62
    v_and_b32 v13, 0xffff0000, v62
    v_lshlrev_b32 v14, 16, v63
    v_and_b32 v15, 0xffff0000, v63
    v_pk_mul_f32 v[132:133], v[132:133], v[12:13]
    v_pk_mul_f32 v[134:135], v[134:135], v[14:15]
    v_cvt_pk_bf16_f32 v176, v132, v133
    v_cvt_pk_bf16_f32 v177, v134, v135
    buffer_store_dwordx4 v[174:177], v3, s[24:27], s3 offen offset:1024 sc1
    s_add_u32 s3, s3, 2048
L_g2fin_49:
    v_add_u32 v1, s55, v3
    s_add_u32 s55, s55, 1024
    buffer_load_dwordx4 v[252:255], v1, s[76:79], s81 offen sc1
    buffer_load_dwordx4 v[160:163], v1, s[76:79], s82 offen sc1
    buffer_load_dwordx4 v[164:167], v1, s[76:79], s83 offen sc1
    buffer_load_dwordx4 v[168:171], v1, s[76:79], s84 offen sc1
    buffer_load_dwordx4 v[172:175], v1, s[76:79], s85 offen sc1
    s_add_u32 s16, s8, 0x1620000
    s_addc_u32 s17, s9, 0
    s_mov_b32 s18, 0x900000
    s_mov_b32 s19, 0x00020000
    s_add_u32 s20, s8, 0x100000
    s_addc_u32 s21, s9, 0
    s_mov_b32 s22, 0x240000
    s_mov_b32 s23, 0x00020000
    s_mov_b32 s24, s6
    s_mov_b32 s25, s7
    s_mov_b32 s26, 0x240000
    s_mov_b32 s27, 0x00020000
    s_mov_b32 s28, s8
    s_mov_b32 s29, s9
    s_mov_b32 s30, 0x6c00
    s_mov_b32 s31, 0x00020000
    s_lshl_b32 s35, s32, 2
    s_lshr_b32 s3, s33, 3
    s_lshl_b32 s3, s3, 1
    s_add_u32 s35, s35, s3
    s_mul_i32 s36, s35, 72
    s_mul_i32 s3, s34, 18
    s_add_u32 s36, s36, s3
    s_lshl_b32 s36, s36, 11
    s_add_u32 s3, s36, 147456
    s_bitcmp1_b32 s33, 0
    s_cselect_b32 s37, s36, s3
    s_cselect_b32 s36, s3, s36
    s_lshr_b32 s3, s34, 1
    s_xor_b32 s3, s3, s33
    s_and_b32 s3, s3, 1
    s_add_u32 s35, s35, s3
    s_and_b32 s38, s34, 1
    v_and_b32 v6, 15, v2
    v_lshrrev_b32 v7, 4, v2
    v_lshlrev_b32 v4, 4, v2
    s_mul_i32 s39, s35, 36864
    s_lshl_b32 s3, s38, 3
    s_add_u32 s39, s39, s3
    s_lshl_b32 s3, s80, 10
    s_add_u32 s48, s39, s3
    s_add_u32 s49, s48, 1024
    s_add_u32 s50, s48, 2048
    s_add_u32 s51, s48, 3072
    s_add_u32 s52, s48, 4096
    v_lshlrev_b32 v5, 4, v7
    s_lshl_b32 s41, s80, 6
    s_add_u32 s41, s41, 11520
    s_add_u32 s42, s41, 13824
    v_lshrrev_b32 v0, 2, v6
    v_lshlrev_b32 v0, 3, v0
    v_and_b32 v6, 3, v6
    v_add_u32 v0, v0, v6
    v_mul_u32_u24 v0, 1152, v0
    v_lshl_add_u32 v0, v7, 3, v0
    s_mul_i32 s40, s35, 36864
    s_mul_i32 s3, s38, 4608
    s_add_u32 s40, s40, s3
    s_lshl_b32 s3, s80, 5
    s_add_u32 s40, s40, s3
    s_bitcmp1_b32 s33, 0
    s_cselect_b32 s3, -1, 4
    s_lshl_b32 s10, s3, 10
    s_add_u32 s52, s48, s10
    s_lshl_b32 s10, s3, 5
    s_add_u32 s43, s40, s10
    s_lshl_b32 s10, s3, 6
    s_add_u32 s53, s41, s10
    s_add_u32 s71, s42, s10
    s_waitcnt vmcnt(5)
    s_barrier
    s_cmp_lg_u32 s34, 0
    s_cbranch_scc1 L_tf_50
    s_lshl_b32 s3, s32, 11
    s_lshl_b32 s10, s33, 7
    s_add_u32 s10, s10, s3
    s_add_u32 s10, s10, 163840
    v_lshlrev_b32 v1, 2, v2
    v_mov_b32 v6, s87
    s_mov_b32 exec_hi, 0
    buffer_store_dword v6, v1, s[44:47], s10 offen sc1
    s_mov_b64 exec, -1
L_tf_50:
    v_add_u32 v1, s55, v3
    s_add_u32 s55, s55, 1024
    buffer_load_dwordx4 v[176:179], v1, s[76:79], s81 offen sc1
    buffer_load_dwordx4 v[180:183], v1, s[76:79], s82 offen sc1
    buffer_load_dwordx4 v[184:187], v1, s[76:79], s83 offen sc1
    buffer_load_dwordx4 v[188:191], v1, s[76:79], s84 offen sc1
    buffer_load_dwordx4 v[192:195], v1, s[76:79], s85 offen sc1
    v_add_u32 v1, s55, v3
    s_add_u32 s55, s55, 1024
    buffer_load_dwordx4 v[196:199], v1, s[76:79], s81 offen sc1
    buffer_load_dwordx4 v[200:203], v1, s[76:79], s82 offen sc1
    buffer_load_dwordx4 v[204:207], v1, s[76:79], s83 offen sc1
    buffer_load_dwordx4 v[208:211], v1, s[76:79], s84 offen sc1
    buffer_load_dwordx4 v[212:215], v1, s[76:79], s85 offen sc1
    v_add_u32 v1, s55, v3
    s_add_u32 s55, s55, 1024
    buffer_load_dwordx4 v[216:219], v1, s[76:79], s81 offen sc1
    buffer_load_dwordx4 v[220:223], v1, s[76:79], s82 offen sc1
    buffer_load_dwordx4 v[224:227], v1, s[76:79], s83 offen sc1
    buffer_load_dwordx4 v[8:11], v1, s[76:79], s84 offen sc1
    buffer_load_dwordx4 v[12:15], v1, s[76:79], s85 offen sc1
    v_and_b32 v7, 3, v2
    v_lshlrev_b32 v7, 7, v7
    s_lshl_b32 s3, s32, 11
    s_lshl_b32 s10, s34, 9
    s_add_u32 s3, s3, s10
    s_add_u32 s3, s3, 163840
    s_mov_b32 s70, 0x20000
L_poll_51:
    buffer_load_dword v6, v7, s[44:47], s3 offen sc1
    s_waitcnt vmcnt(0)
    v_cmp_ne_u32 vcc, s87, v6
    s_cbranch_vccz L_pollok_52
    s_mov_b64 exec, vcc
    s_sub_u32 s70, s70, 1
    s_cmp_eq_u32 s70, 0
    s_cbranch_scc1 L_pollok_52
    s_branch L_poll_51
L_pollok_52:
    s_mov_b64 exec, -1
    v_add_u32 v7, s54, v3
    s_add_u32 s54, s54, 2048
    buffer_load_dwordx4 v[96:99], v7, s[16:19], s36 offen offset:0 sc1
    buffer_load_dwordx4 v[100:103], v7, s[16:19], s36 offen offset:1024 sc1
    buffer_load_dwordx4 v[104:107], v7, s[16:19], s37 offen offset:0 sc1
    buffer_load_dwordx4 v[108:111], v7, s[16:19], s37 offen offset:1024 sc1
    v_add_u32 v7, s54, v3
    s_add_u32 s54, s54, 2048
    buffer_load_dwordx4 v[112:115], v7, s[16:19], s36 offen offset:0 sc1
    buffer_load_dwordx4 v[116:119], v7, s[16:19], s36 offen offset:1024 sc1
    buffer_load_dwordx4 v[120:123], v7, s[16:19], s37 offen offset:0 sc1
    buffer_load_dwordx4 v[124:127], v7, s[16:19], s37 offen offset:1024 sc1
    v_add_u32 v7, s54, v3
    s_add_u32 s54, s54, 2048
    buffer_load_dwordx4 v[128:131], v7, s[16:19], s36 offen offset:0 sc1
    buffer_load_dwordx4 v[132:135], v7, s[16:19], s36 offen offset:1024 sc1
    buffer_load_dwordx4 v[136:139], v7, s[16:19], s37 offen offset:0 sc1
    buffer_load_dwordx4 v[140:143], v7, s[16:19], s37 offen offset:1024 sc1
    v_add_u32 v7, s54, v3
    s_add_u32 s54, s54, 2048
    buffer_load_dwordx4 v[144:147], v7, s[16:19], s36 offen offset:0 sc1
    buffer_load_dwordx4 v[148:151], v7, s[16:19], s36 offen offset:1024 sc1
    buffer_load_dwordx4 v[152:155], v7, s[16:19], s37 offen offset:0 sc1
    buffer_load_dwordx4 v[156:159], v7, s[16:19], s37 offen offset:1024 sc1
    s_waitcnt vmcnt(12)
    v_mfma_f32_16x16x32_bf16 v[16:19], a[144:147], v[96:99], 0
    v_mfma_f32_16x16x32_bf16 v[20:23], a[144:147], v[100:103], 0
    v_mfma_f32_16x16x32_bf16 v[24:27], a[144:147], v[104:107], 0
    v_mfma_f32_16x16x32_bf16 v[28:31], a[144:147], v[108:111], 0
    v_mfma_f32_16x16x32_bf16 v[32:35], a[148:151], v[96:99], 0
    v_mfma_f32_16x16x32_bf16 v[36:39], a[148:151], v[100:103], 0
    v_mfma_f32_16x16x32_bf16 v[40:43], a[148:151], v[104:107], 0
    v_mfma_f32_16x16x32_bf16 v[44:47], a[148:151], v[108:111], 0
    v_mfma_f32_16x16x32_bf16 v[48:51], a[152:155], v[96:99], 0
    v_mfma_f32_16x16x32_bf16 v[52:55], a[152:155], v[100:103], 0
    v_mfma_f32_16x16x32_bf16 v[56:59], a[152:155], v[104:107], 0
    v_mfma_f32_16x16x32_bf16 v[60:63], a[152:155], v[108:111], 0
    v_mfma_f32_16x16x32_bf16 v[64:67], a[156:159], v[96:99], 0
    v_mfma_f32_16x16x32_bf16 v[68:71], a[156:159], v[100:103], 0
    v_mfma_f32_16x16x32_bf16 v[72:75], a[156:159], v[104:107], 0
    v_mfma_f32_16x16x32_bf16 v[76:79], a[156:159], v[108:111], 0
    v_mfma_f32_16x16x32_bf16 v[80:83], a[160:163], v[96:99], 0
    v_mfma_f32_16x16x32_bf16 v[84:87], a[160:163], v[100:103], 0
    s_waitcnt vmcnt(8)
    v_mfma_f32_16x16x32_bf16 v[16:19], a[164:167], v[112:115], v[16:19]
    v_lshl_add_u32 v7, v2, 3, s54
    s_add_u32 s54, s54, 2048
    buffer_load_dwordx2 v[96:97], v7, s[16:19], s36 offen offset:0 sc1
    v_mfma_f32_16x16x32_bf16 v[20:23], a[164:167], v[116:119], v[20:23]
    v_mfma_f32_16x16x32_bf16 v[24:27], a[164:167], v[120:123], v[24:27]
    buffer_load_dwordx2 v[98:99], v7, s[16:19], s36 offen offset:512 sc1
    v_mfma_f32_16x16x32_bf16 v[28:31], a[164:167], v[124:127], v[28:31]
    buffer_load_dwordx2 v[100:101], v7, s[16:19], s36 offen offset:1024 sc1
    v_mfma_f32_16x16x32_bf16 v[32:35], a[168:171], v[112:115], v[32:35]
    v_mfma_f32_16x16x32_bf16 v[36:39], a[168:171], v[116:119], v[36:39]
    buffer_load_dwordx2 v[102:103], v7, s[16:19], s36 offen offset:1536 sc1
    v_mfma_f32_16x16x32_bf16 v[40:43], a[168:171], v[120:123], v[40:43]
    buffer_load_dwordx2 v[104:105], v7, s[16:19], s37 offen offset:0 sc1
    v_mfma_f32_16x16x32_bf16 v[44:47], a[168:171], v[124:127], v[44:47]
    v_mfma_f32_16x16x32_bf16 v[48:51], a[172:175], v[112:115], v[48:51]
    buffer_load_dwordx2 v[106:107], v7, s[16:19], s37 offen offset:512 sc1
    v_mfma_f32_16x16x32_bf16 v[52:55], a[172:175], v[116:119], v[52:55]
    buffer_load_dwordx2 v[108:109], v7, s[16:19], s37 offen offset:1024 sc1
    v_mfma_f32_16x16x32_bf16 v[56:59], a[172:175], v[120:123], v[56:59]
    v_mfma_f32_16x16x32_bf16 v[60:63], a[172:175], v[124:127], v[60:63]
    buffer_load_dwordx2 v[110:111], v7, s[16:19], s37 offen offset:1536 sc1
    v_mfma_f32_16x16x32_bf16 v[64:67], a[176:179], v[112:115], v[64:67]
    v_add_u32 v7, s54, v3
    s_add_u32 s54, s54, 2048
    buffer_load_dwordx4 a[144:147], v7, s[16:19], s36 offen offset:0 sc1
    v_mfma_f32_16x16x32_bf16 v[68:71], a[176:179], v[116:119], v[68:71]
    v_mfma_f32_16x16x32_bf16 v[72:75], a[176:179], v[120:123], v[72:75]
    buffer_load_dwordx4 a[148:151], v7, s[16:19], s36 offen offset:1024 sc1
    v_mfma_f32_16x16x32_bf16 v[76:79], a[176:179], v[124:127], v[76:79]
    buffer_load_dwordx4 a[152:155], v7, s[16:19], s37 offen offset:0 sc1
    v_mfma_f32_16x16x32_bf16 v[80:83], a[180:183], v[112:115], v[80:83]
    v_mfma_f32_16x16x32_bf16 v[84:87], a[180:183], v[116:119], v[84:87]
    buffer_load_dwordx4 a[156:159], v7, s[16:19], s37 offen offset:1024 sc1
    s_waitcnt vmcnt(16)
    v_mfma_f32_16x16x32_bf16 v[16:19], a[184:187], v[128:131], v[16:19]
    v_mfma_f32_16x16x32_bf16 v[20:23], a[184:187], v[132:135], v[20:23]
    v_mfma_f32_16x16x32_bf16 v[24:27], a[184:187], v[136:139], v[24:27]
    v_add_u32 v7, s54, v3
    s_add_u32 s54, s54, 2048
    buffer_load_dwordx4 a[160:163], v7, s[16:19], s36 offen offset:0 sc1
    v_mfma_f32_16x16x32_bf16 v[28:31], a[184:187], v[140:143], v[28:31]
    v_mfma_f32_16x16x32_bf16 v[32:35], a[188:191], v[128:131], v[32:35]
    v_mfma_f32_16x16x32_bf16 v[36:39], a[188:191], v[132:135], v[36:39]
    v_mfma_f32_16x16x32_bf16 v[40:43], a[188:191], v[136:139], v[40:43]
    buffer_load_dwordx4 v[112:115], v7, s[16:19], s36 offen offset:1024 sc1
    v_mfma_f32_16x16x32_bf16 v[44:47], a[188:191], v[140:143], v[44:47]
    v_mfma_f32_16x16x32_bf16 v[48:51], a[192:195], v[128:131], v[48:51]
    v_mfma_f32_16x16x32_bf16 v[52:55], a[192:195], v[132:135], v[52:55]
    v_mfma_f32_16x16x32_bf16 v[56:59], a[192:195], v[136:139], v[56:59]
    v_mfma_f32_16x16x32_bf16 v[60:63], a[192:195], v[140:143], v[60:63]
    buffer_load_dwordx4 v[116:119], v7, s[16:19], s37 offen offset:0 sc1
    v_mfma_f32_16x16x32_bf16 v[64:67], a[196:199], v[128:131], v[64:67]
    v_mfma_f32_16x16x32_bf16 v[68:71], a[196:199], v[132:135], v[68:71]
    v_mfma_f32_16x16x32_bf16 v[72:75], a[196:199], v[136:139], v[72:75]
    v_mfma_f32_16x16x32_bf16 v[76:79], a[196:199], v[140:143], v[76:79]
    buffer_load_dwordx4 v[120:123], v7, s[16:19], s37 offen offset:1024 sc1
    v_mfma_f32_16x16x32_bf16 v[80:83], a[200:203], v[128:131], v[80:83]
    v_mfma_f32_16x16x32_bf16 v[84:87], a[200:203], v[132:135], v[84:87]
    s_waitcnt vmcnt(16)
    v_mfma_f32_16x16x32_bf16 v[16:19], a[204:207], v[144:147], v[16:19]
    v_mfma_f32_16x16x32_bf16 v[20:23], a[204:207], v[148:151], v[20:23]
    v_mfma_f32_16x16x32_bf16 v[24:27], a[204:207], v[152:155], v[24:27]
    v_add_u32 v7, s54, v3
    s_add_u32 s54, s54, 2048
    buffer_load_dwordx4 v[124:127], v7, s[16:19], s36 offen offset:0 sc1
    v_mfma_f32_16x16x32_bf16 v[28:31], a[204:207], v[156:159], v[28:31]
    v_mfma_f32_16x16x32_bf16 v[32:35], a[208:211], v[144:147], v[32:35]
    v_mfma_f32_16x16x32_bf16 v[36:39], a[208:211], v[148:151], v[36:39]
    v_mfma_f32_16x16x32_bf16 v[40:43], a[208:211], v[152:155], v[40:43]
    buffer_load_dwordx4 a[164:167], v7, s[16:19], s36 offen offset:1024 sc1
    v_mfma_f32_16x16x32_bf16 v[44:47], a[208:211], v[156:159], v[44:47]
    v_mfma_f32_16x16x32_bf16 v[48:51], a[212:215], v[144:147], v[48:51]
    v_mfma_f32_16x16x32_bf16 v[52:55], a[212:215], v[148:151], v[52:55]
    v_mfma_f32_16x16x32_bf16 v[56:59], a[212:215], v[152:155], v[56:59]
    v_mfma_f32_16x16x32_bf16 v[60:63], a[212:215], v[156:159], v[60:63]
    buffer_load_dwordx4 a[168:171], v7, s[16:19], s37 offen offset:0 sc1
    v_mfma_f32_16x16x32_bf16 v[64:67], a[216:219], v[144:147], v[64:67]
    v_mfma_f32_16x16x32_bf16 v[68:71], a[216:219], v[148:151], v[68:71]
    v_mfma_f32_16x16x32_bf16 v[72:75], a[216:219], v[152:155], v[72:75]
    v_mfma_f32_16x16x32_bf16 v[76:79], a[216:219], v[156:159], v[76:79]
    buffer_load_dwordx4 a[172:175], v7, s[16:19], s37 offen offset:1024 sc1
    v_mfma_f32_16x16x32_bf16 v[80:83], a[220:223], v[144:147], v[80:83]
    v_mfma_f32_16x16x32_bf16 v[84:87], a[220:223], v[148:151], v[84:87]
    s_waitcnt vmcnt(12)
    v_mfma_f32_16x16x32_bf16 v[16:19], a[224:227], v[96:99], v[16:19]
    v_mfma_f32_16x16x32_bf16 v[20:23], a[224:227], v[100:103], v[20:23]
    v_mfma_f32_16x16x32_bf16 v[24:27], a[224:227], v[104:107], v[24:27]
    v_add_u32 v7, s54, v3
    s_add_u32 s54, s54, 2048
    buffer_load_dwordx4 a[176:179], v7, s[16:19], s36 offen offset:0 sc1
    v_mfma_f32_16x16x32_bf16 v[28:31], a[224:227], v[108:111], v[28:31]
    v_mfma_f32_16x16x32_bf16 v[32:35], a[228:231], v[96:99], v[32:35]
    v_mfma_f32_16x16x32_bf16 v[36:39], a[228:231], v[100:103], v[36:39]
    v_mfma_f32_16x16x32_bf16 v[40:43], a[228:231], v[104:107], v[40:43]
    buffer_load_dwordx4 a[180:183], v7, s[16:19], s36 offen offset:1024 sc1
    v_mfma_f32_16x16x32_bf16 v[44:47], a[228:231], v[108:111], v[44:47]
    v_mfma_f32_16x16x32_bf16 v[48:51], a[232:235], v[96:99], v[48:51]
    v_mfma_f32_16x16x32_bf16 v[52:55], a[232:235], v[100:103], v[52:55]
    v_mfma_f32_16x16x32_bf16 v[56:59], a[232:235], v[104:107], v[56:59]
    v_mfma_f32_16x16x32_bf16 v[60:63], a[232:235], v[108:111], v[60:63]
    buffer_load_dwordx4 v[128:131], v7, s[16:19], s37 offen offset:0 sc1
    v_mfma_f32_16x16x32_bf16 v[64:67], a[236:239], v[96:99], v[64:67]
    v_mfma_f32_16x16x32_bf16 v[68:71], a[236:239], v[100:103], v[68:71]
    v_mfma_f32_16x16x32_bf16 v[72:75], a[236:239], v[104:107], v[72:75]
    v_mfma_f32_16x16x32_bf16 v[76:79], a[236:239], v[108:111], v[76:79]
    buffer_load_dwordx4 v[132:135], v7, s[16:19], s37 offen offset:1024 sc1
    v_mfma_f32_16x16x32_bf16 v[80:83], a[240:243], v[96:99], v[80:83]
    v_mfma_f32_16x16x32_bf16 v[84:87], a[240:243], v[100:103], v[84:87]
    s_waitcnt vmcnt(12)
    v_mfma_f32_16x16x32_bf16 v[16:19], a[244:247], a[144:147], v[16:19]
    v_mfma_f32_16x16x32_bf16 v[20:23], a[244:247], a[148:151], v[20:23]
    v_mfma_f32_16x16x32_bf16 v[24:27], a[244:247], a[152:155], v[24:27]
    v_add_u32 v7, s54, v3
    s_add_u32 s54, s54, 2048
    buffer_load_dwordx4 v[136:139], v7, s[16:19], s36 offen offset:0 sc1
    v_mfma_f32_16x16x32_bf16 v[28:31], a[244:247], a[156:159], v[28:31]
    v_mfma_f32_16x16x32_bf16 v[32:35], a[248:251], a[144:147], v[32:35]
    v_mfma_f32_16x16x32_bf16 v[36:39], a[248:251], a[148:151], v[36:39]
    v_mfma_f32_16x16x32_bf16 v[40:43], a[248:251], a[152:155], v[40:43]
    buffer_load_dwordx4 v[140:143], v7, s[16:19], s36 offen offset:1024 sc1
    v_mfma_f32_16x16x32_bf16 v[44:47], a[248:251], a[156:159], v[44:47]
    v_mfma_f32_16x16x32_bf16 v[48:51], a[252:255], a[144:147], v[48:51]
    v_mfma_f32_16x16x32_bf16 v[52:55], a[252:255], a[148:151], v[52:55]
    v_mfma_f32_16x16x32_bf16 v[56:59], a[252:255], a[152:155], v[56:59]
    v_mfma_f32_16x16x32_bf16 v[60:63], a[252:255], a[156:159], v[60:63]
    buffer_load_dwordx4 a[184:187], v7, s[16:19], s37 offen offset:0 sc1
    v_mfma_f32_16x16x32_bf16 v[64:67], a[0:3], a[144:147], v[64:67]
    v_mfma_f32_16x16x32_bf16 v[68:71], a[0:3], a[148:151], v[68:71]
    v_mfma_f32_16x16x32_bf16 v[72:75], a[0:3], a[152:155], v[72:75]
    v_mfma_f32_16x16x32_bf16 v[76:79], a[0:3], a[156:159], v[76:79]
    buffer_load_dwordx4 a[188:191], v7, s[16:19], s37 offen offset:1024 sc1
    v_mfma_f32_16x16x32_bf16 v[80:83], a[4:7], a[144:147], v[80:83]
    v_mfma_f32_16x16x32_bf16 v[84:87], a[4:7], a[148:151], v[84:87]
    s_waitcnt vmcnt(12)
    v_mfma_f32_16x16x32_bf16 v[16:19], a[8:11], a[160:163], v[16:19]
    v_mfma_f32_16x16x32_bf16 v[20:23], a[8:11], v[112:115], v[20:23]
    v_mfma_f32_16x16x32_bf16 v[24:27], a[8:11], v[116:119], v[24:27]
    v_add_u32 v7, s54, v3
    s_add_u32 s54, s54, 2048
    buffer_load_dwordx4 a[192:195], v7, s[16:19], s36 offen offset:0 sc1
    v_mfma_f32_16x16x32_bf16 v[28:31], a[8:11], v[120:123], v[28:31]
    v_mfma_f32_16x16x32_bf16 v[32:35], a[12:15], a[160:163], v[32:35]
    v_mfma_f32_16x16x32_bf16 v[36:39], a[12:15], v[112:115], v[36:39]
    v_mfma_f32_16x16x32_bf16 v[40:43], a[12:15], v[116:119], v[40:43]
    buffer_load_dwordx4 a[196:199], v7, s[16:19], s36 offen offset:1024 sc1
    v_mfma_f32_16x16x32_bf16 v[44:47], a[12:15], v[120:123], v[44:47]
    v_mfma_f32_16x16x32_bf16 v[48:51], a[16:19], a[160:163], v[48:51]
    v_mfma_f32_16x16x32_bf16 v[52:55], a[16:19], v[112:115], v[52:55]
    v_mfma_f32_16x16x32_bf16 v[56:59], a[16:19], v[116:119], v[56:59]
    v_mfma_f32_16x16x32_bf16 v[60:63], a[16:19], v[120:123], v[60:63]
    buffer_load_dwordx4 a[200:203], v7, s[16:19], s37 offen offset:0 sc1
    v_mfma_f32_16x16x32_bf16 v[64:67], a[20:23], a[160:163], v[64:67]
    v_mfma_f32_16x16x32_bf16 v[68:71], a[20:23], v[112:115], v[68:71]
    v_mfma_f32_16x16x32_bf16 v[72:75], a[20:23], v[116:119], v[72:75]
    v_mfma_f32_16x16x32_bf16 v[76:79], a[20:23], v[120:123], v[76:79]
    buffer_load_dwordx4 v[144:147], v7, s[16:19], s37 offen offset:1024 sc1
    v_mfma_f32_16x16x32_bf16 v[80:83], a[24:27], a[160:163], v[80:83]
    v_mfma_f32_16x16x32_bf16 v[84:87], a[24:27], v[112:115], v[84:87]
    s_waitcnt vmcnt(12)
    v_mfma_f32_16x16x32_bf16 v[16:19], a[28:31], v[124:127], v[16:19]
    v_mfma_f32_16x16x32_bf16 v[20:23], a[28:31], a[164:167], v[20:23]
    v_mfma_f32_16x16x32_bf16 v[24:27], a[28:31], a[168:171], v[24:27]
    v_add_u32 v7, s54, v3
    s_add_u32 s54, s54, 2048
    buffer_load_dwordx4 v[148:151], v7, s[16:19], s36 offen offset:0 sc1
    v_mfma_f32_16x16x32_bf16 v[28:31], a[28:31], a[172:175], v[28:31]
    v_mfma_f32_16x16x32_bf16 v[32:35], a[32:35], v[124:127], v[32:35]
    v_mfma_f32_16x16x32_bf16 v[36:39], a[32:35], a[164:167], v[36:39]
    v_mfma_f32_16x16x32_bf16 v[40:43], a[32:35], a[168:171], v[40:43]
    buffer_load_dwordx4 v[152:155], v7, s[16:19], s36 offen offset:1024 sc1
    v_mfma_f32_16x16x32_bf16 v[44:47], a[32:35], a[172:175], v[44:47]
    v_mfma_f32_16x16x32_bf16 v[48:51], a[36:39], v[124:127], v[48:51]
    v_mfma_f32_16x16x32_bf16 v[52:55], a[36:39], a[164:167], v[52:55]
    v_mfma_f32_16x16x32_bf16 v[56:59], a[36:39], a[168:171], v[56:59]
    v_mfma_f32_16x16x32_bf16 v[60:63], a[36:39], a[172:175], v[60:63]
    buffer_load_dwordx4 v[156:159], v7, s[16:19], s37 offen offset:0 sc1
    v_mfma_f32_16x16x32_bf16 v[64:67], a[40:43], v[124:127], v[64:67]
    v_mfma_f32_16x16x32_bf16 v[68:71], a[40:43], a[164:167], v[68:71]
    v_mfma_f32_16x16x32_bf16 v[72:75], a[40:43], a[168:171], v[72:75]
    v_mfma_f32_16x16x32_bf16 v[76:79], a[40:43], a[172:175], v[76:79]
    buffer_load_dwordx4 a[204:207], v7, s[16:19], s37 offen offset:1024 sc1
    v_mfma_f32_16x16x32_bf16 v[80:83], a[44:47], v[124:127], v[80:83]
    v_mfma_f32_16x16x32_bf16 v[84:87], a[44:47], a[164:167], v[84:87]
    s_waitcnt vmcnt(12)
    v_mfma_f32_16x16x32_bf16 v[16:19], a[48:51], a[176:179], v[16:19]
    v_mfma_f32_16x16x32_bf16 v[20:23], a[48:51], a[180:183], v[20:23]
    v_mfma_f32_16x16x32_bf16 v[24:27], a[48:51], v[128:131], v[24:27]
    v_add_u32 v7, s54, v3
    s_add_u32 s54, s54, 2048
    buffer_load_dwordx4 a[208:211], v7, s[16:19], s36 offen offset:0 sc1
    v_mfma_f32_16x16x32_bf16 v[28:31], a[48:51], v[132:135], v[28:31]
    v_mfma_f32_16x16x32_bf16 v[32:35], a[52:55], a[176:179], v[32:35]
    v_mfma_f32_16x16x32_bf16 v[36:39], a[52:55], a[180:183], v[36:39]
    v_mfma_f32_16x16x32_bf16 v[40:43], a[52:55], v[128:131], v[40:43]
    buffer_load_dwordx4 a[212:215], v7, s[16:19], s36 offen offset:1024 sc1
    v_mfma_f32_16x16x32_bf16 v[44:47], a[52:55], v[132:135], v[44:47]
    v_mfma_f32_16x16x32_bf16 v[48:51], a[56:59], a[176:179], v[48:51]
    v_mfma_f32_16x16x32_bf16 v[52:55], a[56:59], a[180:183], v[52:55]
    v_mfma_f32_16x16x32_bf16 v[56:59], a[56:59], v[128:131], v[56:59]
    v_mfma_f32_16x16x32_bf16 v[60:63], a[56:59], v[132:135], v[60:63]
    buffer_load_dwordx4 a[216:219], v7, s[16:19], s37 offen offset:0 sc1
    v_mfma_f32_16x16x32_bf16 v[64:67], a[60:63], a[176:179], v[64:67]
    v_mfma_f32_16x16x32_bf16 v[68:71], a[60:63], a[180:183], v[68:71]
    v_mfma_f32_16x16x32_bf16 v[72:75], a[60:63], v[128:131], v[72:75]
    v_mfma_f32_16x16x32_bf16 v[76:79], a[60:63], v[132:135], v[76:79]
    buffer_load_dwordx4 a[220:223], v7, s[16:19], s37 offen offset:1024 sc1
    v_mfma_f32_16x16x32_bf16 v[80:83], a[64:67], a[176:179], v[80:83]
    v_mfma_f32_16x16x32_bf16 v[84:87], a[64:67], a[180:183], v[84:87]
    s_waitcnt vmcnt(12)
    v_mfma_f32_16x16x32_bf16 v[16:19], a[68:71], v[136:139], v[16:19]
    v_mfma_f32_16x16x32_bf16 v[20:23], a[68:71], v[140:143], v[20:23]
    v_lshl_add_u32 v7, v2, 3, s54
    s_add_u32 s54, s54, 2048
    buffer_load_dwordx2 v[96:97], v7, s[16:19], s36 offen offset:0 sc1
    v_mfma_f32_16x16x32_bf16 v[24:27], a[68:71], a[184:187], v[24:27]
    v_mfma_f32_16x16x32_bf16 v[28:31], a[68:71], a[188:191], v[28:31]
    buffer_load_dwordx2 v[98:99], v7, s[16:19], s36 offen offset:512 sc1
    v_mfma_f32_16x16x32_bf16 v[32:35], a[72:75], v[136:139], v[32:35]
    v_mfma_f32_16x16x32_bf16 v[36:39], a[72:75], v[140:143], v[36:39]
    buffer_load_dwordx2 v[100:101], v7, s[16:19], s36 offen offset:1024 sc1
    v_mfma_f32_16x16x32_bf16 v[40:43], a[72:75], a[184:187], v[40:43]
    v_mfma_f32_16x16x32_bf16 v[44:47], a[72:75], a[188:191], v[44:47]
    buffer_load_dwordx2 v[102:103], v7, s[16:19], s36 offen offset:1536 sc1
    v_mfma_f32_16x16x32_bf16 v[48:51], a[76:79], v[136:139], v[48:51]
    v_mfma_f32_16x16x32_bf16 v[52:55], a[76:79], v[140:143], v[52:55]
    v_mfma_f32_16x16x32_bf16 v[56:59], a[76:79], a[184:187], v[56:59]
    buffer_load_dwordx2 v[104:105], v7, s[16:19], s37 offen offset:0 sc1
    v_mfma_f32_16x16x32_bf16 v[60:63], a[76:79], a[188:191], v[60:63]
    v_mfma_f32_16x16x32_bf16 v[64:67], a[80:83], v[136:139], v[64:67]
    buffer_load_dwordx2 v[106:107], v7, s[16:19], s37 offen offset:512 sc1
    v_mfma_f32_16x16x32_bf16 v[68:71], a[80:83], v[140:143], v[68:71]
    v_mfma_f32_16x16x32_bf16 v[72:75], a[80:83], a[184:187], v[72:75]
    buffer_load_dwordx2 v[108:109], v7, s[16:19], s37 offen offset:1024 sc1
    v_mfma_f32_16x16x32_bf16 v[76:79], a[80:83], a[188:191], v[76:79]
    v_mfma_f32_16x16x32_bf16 v[80:83], a[84:87], v[136:139], v[80:83]
    buffer_load_dwordx2 v[110:111], v7, s[16:19], s37 offen offset:1536 sc1
    v_mfma_f32_16x16x32_bf16 v[84:87], a[84:87], v[140:143], v[84:87]
    s_waitcnt vmcnt(16)
    v_mfma_f32_16x16x32_bf16 v[16:19], a[88:91], a[192:195], v[16:19]
    v_mfma_f32_16x16x32_bf16 v[20:23], a[88:91], a[196:199], v[20:23]
    v_mfma_f32_16x16x32_bf16 v[24:27], a[88:91], a[200:203], v[24:27]
    v_add_u32 v7, s54, v3
    s_add_u32 s54, s54, 2048
    buffer_load_dwordx4 a[224:227], v7, s[16:19], s36 offen offset:0 sc1
    v_mfma_f32_16x16x32_bf16 v[28:31], a[88:91], v[144:147], v[28:31]
    v_mfma_f32_16x16x32_bf16 v[32:35], a[92:95], a[192:195], v[32:35]
    v_mfma_f32_16x16x32_bf16 v[36:39], a[92:95], a[196:199], v[36:39]
    v_mfma_f32_16x16x32_bf16 v[40:43], a[92:95], a[200:203], v[40:43]
    buffer_load_dwordx4 a[228:231], v7, s[16:19], s36 offen offset:1024 sc1
    v_mfma_f32_16x16x32_bf16 v[44:47], a[92:95], v[144:147], v[44:47]
    v_mfma_f32_16x16x32_bf16 v[48:51], a[96:99], a[192:195], v[48:51]
    v_mfma_f32_16x16x32_bf16 v[52:55], a[96:99], a[196:199], v[52:55]
    v_mfma_f32_16x16x32_bf16 v[56:59], a[96:99], a[200:203], v[56:59]
    v_mfma_f32_16x16x32_bf16 v[60:63], a[96:99], v[144:147], v[60:63]
    buffer_load_dwordx4 a[232:235], v7, s[16:19], s37 offen offset:0 sc1
    v_mfma_f32_16x16x32_bf16 v[64:67], a[100:103], a[192:195], v[64:67]
    v_mfma_f32_16x16x32_bf16 v[68:71], a[100:103], a[196:199], v[68:71]
    v_mfma_f32_16x16x32_bf16 v[72:75], a[100:103], a[200:203], v[72:75]
    v_mfma_f32_16x16x32_bf16 v[76:79], a[100:103], v[144:147], v[76:79]
    buffer_load_dwordx4 a[236:239], v7, s[16:19], s37 offen offset:1024 sc1
    v_mfma_f32_16x16x32_bf16 v[80:83], a[104:107], a[192:195], v[80:83]
    v_mfma_f32_16x16x32_bf16 v[84:87], a[104:107], a[196:199], v[84:87]
    s_waitcnt vmcnt(16)
    v_mfma_f32_16x16x32_bf16 v[16:19], a[108:111], v[148:151], v[16:19]
    v_mfma_f32_16x16x32_bf16 v[20:23], a[108:111], v[152:155], v[20:23]
    v_mfma_f32_16x16x32_bf16 v[24:27], a[108:111], v[156:159], v[24:27]
    v_add_u32 v7, s54, v3
    s_add_u32 s54, s54, 2048
    buffer_load_dwordx4 a[240:243], v7, s[16:19], s36 offen offset:0 sc1
    v_mfma_f32_16x16x32_bf16 v[28:31], a[108:111], a[204:207], v[28:31]
    v_mfma_f32_16x16x32_bf16 v[32:35], a[112:115], v[148:151], v[32:35]
    v_mfma_f32_16x16x32_bf16 v[36:39], a[112:115], v[152:155], v[36:39]
    v_mfma_f32_16x16x32_bf16 v[40:43], a[112:115], v[156:159], v[40:43]
    buffer_load_dwordx4 a[144:147], v7, s[16:19], s36 offen offset:1024 sc1
    v_mfma_f32_16x16x32_bf16 v[44:47], a[112:115], a[204:207], v[44:47]
    v_mfma_f32_16x16x32_bf16 v[48:51], a[116:119], v[148:151], v[48:51]
    v_mfma_f32_16x16x32_bf16 v[52:55], a[116:119], v[152:155], v[52:55]
    v_mfma_f32_16x16x32_bf16 v[56:59], a[116:119], v[156:159], v[56:59]
    v_mfma_f32_16x16x32_bf16 v[60:63], a[116:119], a[204:207], v[60:63]
    buffer_load_dwordx4 a[148:151], v7, s[16:19], s37 offen offset:0 sc1
    v_mfma_f32_16x16x32_bf16 v[64:67], a[120:123], v[148:151], v[64:67]
    v_mfma_f32_16x16x32_bf16 v[68:71], a[120:123], v[152:155], v[68:71]
    v_mfma_f32_16x16x32_bf16 v[72:75], a[120:123], v[156:159], v[72:75]
    v_mfma_f32_16x16x32_bf16 v[76:79], a[120:123], a[204:207], v[76:79]
    buffer_load_dwordx4 a[152:155], v7, s[16:19], s37 offen offset:1024 sc1
    v_mfma_f32_16x16x32_bf16 v[80:83], a[124:127], v[148:151], v[80:83]
    v_mfma_f32_16x16x32_bf16 v[84:87], a[124:127], v[152:155], v[84:87]
    s_waitcnt vmcnt(16)
    v_mfma_f32_16x16x32_bf16 v[16:19], a[128:131], a[208:211], v[16:19]
    v_mfma_f32_16x16x32_bf16 v[20:23], a[128:131], a[212:215], v[20:23]
    v_mfma_f32_16x16x32_bf16 v[24:27], a[128:131], a[216:219], v[24:27]
    v_add_u32 v7, s54, v3
    s_add_u32 s54, s54, 2048
    buffer_load_dwordx4 a[156:159], v7, s[16:19], s36 offen offset:0 sc1
    v_mfma_f32_16x16x32_bf16 v[28:31], a[128:131], a[220:223], v[28:31]
    v_mfma_f32_16x16x32_bf16 v[32:35], a[132:135], a[208:211], v[32:35]
    v_mfma_f32_16x16x32_bf16 v[36:39], a[132:135], a[212:215], v[36:39]
    v_mfma_f32_16x16x32_bf16 v[40:43], a[132:135], a[216:219], v[40:43]
    buffer_load_dwordx4 a[244:247], v7, s[16:19], s36 offen offset:1024 sc1
    v_mfma_f32_16x16x32_bf16 v[44:47], a[132:135], a[220:223], v[44:47]
    v_mfma_f32_16x16x32_bf16 v[48:51], a[136:139], a[208:211], v[48:51]
    v_mfma_f32_16x16x32_bf16 v[52:55], a[136:139], a[212:215], v[52:55]
    v_mfma_f32_16x16x32_bf16 v[56:59], a[136:139], a[216:219], v[56:59]
    v_mfma_f32_16x16x32_bf16 v[60:63], a[136:139], a[220:223], v[60:63]
    buffer_load_dwordx4 a[248:251], v7, s[16:19], s37 offen offset:0 sc1
    v_mfma_f32_16x16x32_bf16 v[64:67], a[140:143], a[208:211], v[64:67]
    v_mfma_f32_16x16x32_bf16 v[68:71], a[140:143], a[212:215], v[68:71]
    v_mfma_f32_16x16x32_bf16 v[72:75], a[140:143], a[216:219], v[72:75]
    v_mfma_f32_16x16x32_bf16 v[76:79], a[140:143], a[220:223], v[76:79]
    buffer_load_dwordx4 a[252:255], v7, s[16:19], s37 offen offset:1024 sc1
    v_mfma_f32_16x16x32_bf16 v[80:83], v[228:231], a[208:211], v[80:83]
    v_mfma_f32_16x16x32_bf16 v[84:87], v[228:231], a[212:215], v[84:87]
    s_waitcnt vmcnt(12)
    v_mfma_f32_16x16x32_bf16 v[16:19], v[232:235], v[96:99], v[16:19]
    v_mfma_f32_16x16x32_bf16 v[20:23], v[232:235], v[100:103], v[20:23]
    v_mfma_f32_16x16x32_bf16 v[24:27], v[232:235], v[104:107], v[24:27]
    v_add_u32 v7, s54, v3
    s_add_u32 s54, s54, 2048
    buffer_load_dwordx4 a[0:3], v7, s[16:19], s36 offen offset:0 sc1
    v_mfma_f32_16x16x32_bf16 v[28:31], v[232:235], v[108:111], v[28:31]
    v_mfma_f32_16x16x32_bf16 v[32:35], v[236:239], v[96:99], v[32:35]
    v_mfma_f32_16x16x32_bf16 v[36:39], v[236:239], v[100:103], v[36:39]
    v_mfma_f32_16x16x32_bf16 v[40:43], v[236:239], v[104:107], v[40:43]
    buffer_load_dwordx4 a[4:7], v7, s[16:19], s36 offen offset:1024 sc1
    v_mfma_f32_16x16x32_bf16 v[44:47], v[236:239], v[108:111], v[44:47]
    v_mfma_f32_16x16x32_bf16 v[48:51], v[240:243], v[96:99], v[48:51]
    v_mfma_f32_16x16x32_bf16 v[52:55], v[240:243], v[100:103], v[52:55]
    v_mfma_f32_16x16x32_bf16 v[56:59], v[240:243], v[104:107], v[56:59]
    v_mfma_f32_16x16x32_bf16 v[60:63], v[240:243], v[108:111], v[60:63]
    buffer_load_dwordx4 a[160:163], v7, s[16:19], s37 offen offset:0 sc1
    v_mfma_f32_16x16x32_bf16 v[64:67], v[244:247], v[96:99], v[64:67]
    v_mfma_f32_16x16x32_bf16 v[68:71], v[244:247], v[100:103], v[68:71]
    v_mfma_f32_16x16x32_bf16 v[72:75], v[244:247], v[104:107], v[72:75]
    v_mfma_f32_16x16x32_bf16 v[76:79], v[244:247], v[108:111], v[76:79]
    buffer_load_dwordx4 v[112:115], v7, s[16:19], s37 offen offset:1024 sc1
    v_mfma_f32_16x16x32_bf16 v[80:83], v[248:251], v[96:99], v[80:83]
    v_mfma_f32_16x16x32_bf16 v[84:87], v[248:251], v[100:103], v[84:87]
    s_waitcnt vmcnt(12)
    v_mfma_f32_16x16x32_bf16 v[16:19], v[252:255], a[224:227], v[16:19]
    v_mfma_f32_16x16x32_bf16 v[20:23], v[252:255], a[228:231], v[20:23]
    v_mfma_f32_16x16x32_bf16 v[24:27], v[252:255], a[232:235], v[24:27]
    v_mfma_f32_16x16x32_bf16 v[28:31], v[252:255], a[236:239], v[28:31]
    v_mfma_f32_16x16x32_bf16 v[32:35], v[160:163], a[224:227], v[32:35]
    v_mfma_f32_16x16x32_bf16 v[36:39], v[160:163], a[228:231], v[36:39]
    v_mfma_f32_16x16x32_bf16 v[40:43], v[160:163], a[232:235], v[40:43]
    v_mfma_f32_16x16x32_bf16 v[44:47], v[160:163], a[236:239], v[44:47]
    v_mfma_f32_16x16x32_bf16 v[48:51], v[164:167], a[224:227], v[48:51]
    v_mfma_f32_16x16x32_bf16 v[52:55], v[164:167], a[228:231], v[52:55]
    v_mfma_f32_16x16x32_bf16 v[56:59], v[164:167], a[232:235], v[56:59]
    v_mfma_f32_16x16x32_bf16 v[60:63], v[164:167], a[236:239], v[60:63]
    v_mfma_f32_16x16x32_bf16 v[64:67], v[168:171], a[224:227], v[64:67]
    v_mfma_f32_16x16x32_bf16 v[68:71], v[168:171], a[228:231], v[68:71]
    v_mfma_f32_16x16x32_bf16 v[72:75], v[168:171], a[232:235], v[72:75]
    v_mfma_f32_16x16x32_bf16 v[76:79], v[168:171], a[236:239], v[76:79]
    v_mfma_f32_16x16x32_bf16 v[80:83], v[172:175], a[224:227], v[80:83]
    v_mfma_f32_16x16x32_bf16 v[84:87], v[172:175], a[228:231], v[84:87]
    s_waitcnt vmcnt(8)
    v_mfma_f32_16x16x32_bf16 v[16:19], v[176:179], a[240:243], v[16:19]
    v_mfma_f32_16x16x32_bf16 v[20:23], v[176:179], a[144:147], v[20:23]
    v_mfma_f32_16x16x32_bf16 v[24:27], v[176:179], a[148:151], v[24:27]
    v_mfma_f32_16x16x32_bf16 v[28:31], v[176:179], a[152:155], v[28:31]
    v_mfma_f32_16x16x32_bf16 v[32:35], v[180:183], a[240:243], v[32:35]
    v_mfma_f32_16x16x32_bf16 v[36:39], v[180:183], a[144:147], v[36:39]
    v_mfma_f32_16x16x32_bf16 v[40:43], v[180:183], a[148:151], v[40:43]
    v_mfma_f32_16x16x32_bf16 v[44:47], v[180:183], a[152:155], v[44:47]
    v_mfma_f32_16x16x32_bf16 v[48:51], v[184:187], a[240:243], v[48:51]
    v_mfma_f32_16x16x32_bf16 v[52:55], v[184:187], a[144:147], v[52:55]
    v_mfma_f32_16x16x32_bf16 v[56:59], v[184:187], a[148:151], v[56:59]
    v_mfma_f32_16x16x32_bf16 v[60:63], v[184:187], a[152:155], v[60:63]
    v_mfma_f32_16x16x32_bf16 v[64:67], v[188:191], a[240:243], v[64:67]
    v_mfma_f32_16x16x32_bf16 v[68:71], v[188:191], a[144:147], v[68:71]
    v_mfma_f32_16x16x32_bf16 v[72:75], v[188:191], a[148:151], v[72:75]
    v_mfma_f32_16x16x32_bf16 v[76:79], v[188:191], a[152:155], v[76:79]
    v_mfma_f32_16x16x32_bf16 v[80:83], v[192:195], a[240:243], v[80:83]
    v_mfma_f32_16x16x32_bf16 v[84:87], v[192:195], a[144:147], v[84:87]
    s_mul_i32 s3, s34, 20480
    v_add_u32 v6, s3, v3
    s_mul_i32 s3, s34, 5120
    v_add_u32 v7, s3, v3
    s_waitcnt vmcnt(0)
    v_mfma_f32_16x16x32_bf16 v[80:83], v[212:215], a[156:159], v[80:83]
    v_mfma_f32_16x16x32_bf16 v[84:87], v[212:215], a[244:247], v[84:87]
    v_mfma_f32_16x16x32_bf16 v[80:83], v[12:15], a[0:3], v[80:83]
    v_mfma_f32_16x16x32_bf16 v[84:87], v[12:15], a[4:7], v[84:87]
    v_mfma_f32_16x16x32_bf16 v[16:19], v[196:199], a[156:159], v[16:19]
    buffer_load_dwordx2 v[180:181], v4, s[20:23], s48 offen sc1
    v_mfma_f32_16x16x32_bf16 v[20:23], v[196:199], a[244:247], v[20:23]
    buffer_load_dwordx2 v[182:183], v4, s[20:23], s49 offen sc1
    v_mfma_f32_16x16x32_bf16 v[24:27], v[196:199], a[248:251], v[24:27]
    buffer_load_dwordx2 v[184:185], v4, s[20:23], s50 offen sc1
    v_mfma_f32_16x16x32_bf16 v[28:31], v[196:199], a[252:255], v[28:31]
    buffer_load_dwordx2 v[186:187], v4, s[20:23], s51 offen sc1
    v_mfma_f32_16x16x32_bf16 v[16:19], v[216:219], a[0:3], v[16:19]
    buffer_load_dwordx2 v[188:189], v4, s[20:23], s52 offen sc1
    v_mfma_f32_16x16x32_bf16 v[20:23], v[216:219], a[4:7], v[20:23]
    buffer_load_dwordx4 v[160:163], v5, s[28:31], s41 offen offset:0 sc1
    v_mfma_f32_16x16x32_bf16 v[24:27], v[216:219], a[160:163], v[24:27]
    buffer_load_dwordx4 v[228:231], v5, s[28:31], s42 offen offset:0 sc1
    v_mfma_f32_16x16x32_bf16 v[28:31], v[216:219], v[112:115], v[28:31]
    buffer_load_dwordx4 v[164:167], v5, s[28:31], s41 offen offset:64 sc1
    ds_write_b128 v6, v[80:83] offset:4096
    ds_write_b128 v6, v[84:87] offset:9216
    v_mfma_f32_16x16x32_bf16 v[32:35], v[200:203], a[156:159], v[32:35]
    buffer_load_dwordx4 v[232:235], v5, s[28:31], s42 offen offset:64 sc1
    v_mfma_f32_16x16x32_bf16 v[36:39], v[200:203], a[244:247], v[36:39]
    buffer_load_dwordx4 v[168:171], v5, s[28:31], s41 offen offset:128 sc1
    v_mfma_f32_16x16x32_bf16 v[40:43], v[200:203], a[248:251], v[40:43]
    buffer_load_dwordx4 v[236:239], v5, s[28:31], s42 offen offset:128 sc1
    v_mfma_f32_16x16x32_bf16 v[44:47], v[200:203], a[252:255], v[44:47]
    buffer_load_dwordx4 v[172:175], v5, s[28:31], s41 offen offset:192 sc1
    v_mfma_f32_16x16x32_bf16 v[32:35], v[220:223], a[0:3], v[32:35]
    ds_write_b128 v6, v[16:19] offset:0
    v_mfma_f32_16x16x32_bf16 v[36:39], v[220:223], a[4:7], v[36:39]
    ds_write_b128 v6, v[20:23] offset:5120
    v_mfma_f32_16x16x32_bf16 v[40:43], v[220:223], a[160:163], v[40:43]
    ds_write_b128 v6, v[24:27] offset:10240
    v_mfma_f32_16x16x32_bf16 v[44:47], v[220:223], v[112:115], v[44:47]
    ds_write_b128 v6, v[28:31] offset:15360
    v_mfma_f32_16x16x32_bf16 v[48:51], v[204:207], a[156:159], v[48:51]
    buffer_load_dwordx4 v[240:243], v5, s[28:31], s42 offen offset:192 sc1
    v_mfma_f32_16x16x32_bf16 v[52:55], v[204:207], a[244:247], v[52:55]
    buffer_load_dwordx4 v[176:179], v5, s[28:31], s53 offen offset:0 sc1
    v_mfma_f32_16x16x32_bf16 v[56:59], v[204:207], a[248:251], v[56:59]
    buffer_load_dwordx4 v[244:247], v5, s[28:31], s71 offen offset:0 sc1
    v_mfma_f32_16x16x32_bf16 v[60:63], v[204:207], a[252:255], v[60:63]
    v_mfma_f32_16x16x32_bf16 v[48:51], v[224:227], a[0:3], v[48:51]
    ds_write_b128 v6, v[32:35] offset:1024
    v_mfma_f32_16x16x32_bf16 v[52:55], v[224:227], a[4:7], v[52:55]
    ds_write_b128 v6, v[36:39] offset:6144
    v_mfma_f32_16x16x32_bf16 v[56:59], v[224:227], a[160:163], v[56:59]
    ds_write_b128 v6, v[40:43] offset:11264
    v_mfma_f32_16x16x32_bf16 v[60:63], v[224:227], v[112:115], v[60:63]
    ds_write_b128 v6, v[44:47] offset:16384
    v_mfma_f32_16x16x32_bf16 v[64:67], v[208:211], a[156:159], v[64:67]
    v_mfma_f32_16x16x32_bf16 v[68:71], v[208:211], a[244:247], v[68:71]
    v_mfma_f32_16x16x32_bf16 v[72:75], v[208:211], a[248:251], v[72:75]
    v_mfma_f32_16x16x32_bf16 v[76:79], v[208:211], a[252:255], v[76:79]
    v_mfma_f32_16x16x32_bf16 v[64:67], v[8:11], a[0:3], v[64:67]
    ds_write_b128 v6, v[48:51] offset:2048
    v_mfma_f32_16x16x32_bf16 v[68:71], v[8:11], a[4:7], v[68:71]
    ds_write_b128 v6, v[52:55] offset:7168
    v_mfma_f32_16x16x32_bf16 v[72:75], v[8:11], a[160:163], v[72:75]
    ds_write_b128 v6, v[56:59] offset:12288
    v_mfma_f32_16x16x32_bf16 v[76:79], v[8:11], v[112:115], v[76:79]
    ds_write_b128 v6, v[60:63] offset:17408
    s_nop 4
    ds_write_b128 v6, v[64:67] offset:3072
    ds_write_b128 v6, v[68:71] offset:8192
    ds_write_b128 v6, v[72:75] offset:13312
    ds_write_b128 v6, v[76:79] offset:18432
    s_waitcnt vmcnt(0)
    v_pk_add_f32 v[160:161], v[160:161], v[228:229]
    v_cvt_pk_bf16_f32 v161, v160, v161
    v_lshlrev_b32 v160, 16, v161
    v_and_b32 v161, 0xffff0000, v161
    v_pk_add_f32 v[162:163], v[162:163], v[230:231]
    v_cvt_pk_bf16_f32 v163, v162, v163
    v_lshlrev_b32 v162, 16, v163
    v_and_b32 v163, 0xffff0000, v163
    v_pk_add_f32 v[164:165], v[164:165], v[232:233]
    v_cvt_pk_bf16_f32 v165, v164, v165
    v_lshlrev_b32 v164, 16, v165
    v_and_b32 v165, 0xffff0000, v165
    v_pk_add_f32 v[166:167], v[166:167], v[234:235]
    v_cvt_pk_bf16_f32 v167, v166, v167
    v_lshlrev_b32 v166, 16, v167
    v_and_b32 v167, 0xffff0000, v167
    v_pk_add_f32 v[168:169], v[168:169], v[236:237]
    v_cvt_pk_bf16_f32 v169, v168, v169
    v_lshlrev_b32 v168, 16, v169
    v_and_b32 v169, 0xffff0000, v169
    v_pk_add_f32 v[170:171], v[170:171], v[238:239]
    v_cvt_pk_bf16_f32 v171, v170, v171
    v_lshlrev_b32 v170, 16, v171
    v_and_b32 v171, 0xffff0000, v171
    v_pk_add_f32 v[172:173], v[172:173], v[240:241]
    v_cvt_pk_bf16_f32 v173, v172, v173
    v_lshlrev_b32 v172, 16, v173
    v_and_b32 v173, 0xffff0000, v173
    v_pk_add_f32 v[174:175], v[174:175], v[242:243]
    v_cvt_pk_bf16_f32 v175, v174, v175
    v_lshlrev_b32 v174, 16, v175
    v_and_b32 v175, 0xffff0000, v175
    v_pk_add_f32 v[176:177], v[176:177], v[244:245]
    v_cvt_pk_bf16_f32 v177, v176, v177
    v_lshlrev_b32 v176, 16, v177
    v_and_b32 v177, 0xffff0000, v177
    v_pk_add_f32 v[178:179], v[178:179], v[246:247]
    v_cvt_pk_bf16_f32 v179, v178, v179
    v_lshlrev_b32 v178, 16, v179
    v_and_b32 v179, 0xffff0000, v179
    v_add_u32 v1, 0x1000, v7
    s_waitcnt lgkmcnt(0)
    s_barrier
    ds_read_b128 v[16:19], v7 offset:0
    ds_read_b128 v[20:23], v7 offset:20480
    ds_read_b128 v[24:27], v7 offset:40960
    ds_read_b128 v[28:31], v7 offset:61440
    ds_read_b128 v[32:35], v7 offset:1024
    ds_read_b128 v[36:39], v7 offset:21504
    ds_read_b128 v[40:43], v7 offset:41984
    ds_read_b128 v[44:47], v7 offset:62464
    ds_read_b128 v[48:51], v7 offset:2048
    ds_read_b128 v[52:55], v7 offset:22528
    ds_read_b128 v[56:59], v7 offset:43008
    ds_read_b128 v[60:63], v7 offset:63488
    ds_read_b128 v[64:67], v7 offset:3072
    ds_read_b128 v[68:71], v7 offset:23552
    ds_read_b128 v[72:75], v7 offset:44032
    ds_read_b128 v[76:79], v7 offset:64512
    ds_read_b128 v[80:83], v7 offset:4096
    ds_read_b128 v[84:87], v7 offset:24576
    ds_read_b128 v[88:91], v7 offset:45056
    ds_read_b128 v[92:95], v1 offset:61440
    s_waitcnt lgkmcnt(15)
    v_pk_add_f32 v[16:17], v[16:17], v[20:21]
    v_pk_add_f32 v[18:19], v[18:19], v[22:23]
    v_pk_add_f32 v[24:25], v[24:25], v[28:29]
    v_pk_add_f32 v[26:27], v[26:27], v[30:31]
    v_pk_add_f32 v[16:17], v[16:17], v[24:25]
    v_pk_add_f32 v[18:19], v[18:19], v[26:27]
    v_lshlrev_b32 v20, 16, v180
    v_and_b32 v21, 0xffff0000, v180
    v_lshlrev_b32 v22, 16, v181
    v_and_b32 v23, 0xffff0000, v181
    v_pk_fma_f32 v[16:17], v[16:17], v[160:161], v[20:21]
    v_pk_fma_f32 v[18:19], v[18:19], v[162:163], v[22:23]
    v_cvt_pk_bf16_f32 v24, v16, v17
    v_cvt_pk_bf16_f32 v25, v18, v19
    buffer_store_dwordx2 v[24:25], v0, s[24:27], s40 offen offset:0
    s_waitcnt lgkmcnt(12)
    v_pk_add_f32 v[32:33], v[32:33], v[36:37]
    v_pk_add_f32 v[34:35], v[34:35], v[38:39]
    v_pk_add_f32 v[40:41], v[40:41], v[44:45]
    v_pk_add_f32 v[42:43], v[42:43], v[46:47]
    v_pk_add_f32 v[32:33], v[32:33], v[40:41]
    v_pk_add_f32 v[34:35], v[34:35], v[42:43]
    v_lshlrev_b32 v36, 16, v182
    v_and_b32 v37, 0xffff0000, v182
    v_lshlrev_b32 v38, 16, v183
    v_and_b32 v39, 0xffff0000, v183
    v_pk_fma_f32 v[32:33], v[32:33], v[164:165], v[36:37]
    v_pk_fma_f32 v[34:35], v[34:35], v[166:167], v[38:39]
    v_cvt_pk_bf16_f32 v40, v32, v33
    v_cvt_pk_bf16_f32 v41, v34, v35
    buffer_store_dwordx2 v[40:41], v0, s[24:27], s40 offen offset:32
    s_waitcnt lgkmcnt(8)
    v_pk_add_f32 v[48:49], v[48:49], v[52:53]
    v_pk_add_f32 v[50:51], v[50:51], v[54:55]
    v_pk_add_f32 v[56:57], v[56:57], v[60:61]
    v_pk_add_f32 v[58:59], v[58:59], v[62:63]
    v_pk_add_f32 v[48:49], v[48:49], v[56:57]
    v_pk_add_f32 v[50:51], v[50:51], v[58:59]
    v_lshlrev_b32 v52, 16, v184
    v_and_b32 v53, 0xffff0000, v184
    v_lshlrev_b32 v54, 16, v185
    v_and_b32 v55, 0xffff0000, v185
    v_pk_fma_f32 v[48:49], v[48:49], v[168:169], v[52:53]
    v_pk_fma_f32 v[50:51], v[50:51], v[170:171], v[54:55]
    v_cvt_pk_bf16_f32 v56, v48, v49
    v_cvt_pk_bf16_f32 v57, v50, v51
    buffer_store_dwordx2 v[56:57], v0, s[24:27], s40 offen offset:64
    s_waitcnt lgkmcnt(4)
    v_pk_add_f32 v[64:65], v[64:65], v[68:69]
    v_pk_add_f32 v[66:67], v[66:67], v[70:71]
    v_pk_add_f32 v[72:73], v[72:73], v[76:77]
    v_pk_add_f32 v[74:75], v[74:75], v[78:79]
    v_pk_add_f32 v[64:65], v[64:65], v[72:73]
    v_pk_add_f32 v[66:67], v[66:67], v[74:75]
    v_lshlrev_b32 v68, 16, v186
    v_and_b32 v69, 0xffff0000, v186
    v_lshlrev_b32 v70, 16, v187
    v_and_b32 v71, 0xffff0000, v187
    v_pk_fma_f32 v[64:65], v[64:65], v[172:173], v[68:69]
    v_pk_fma_f32 v[66:67], v[66:67], v[174:175], v[70:71]
    v_cvt_pk_bf16_f32 v72, v64, v65
    v_cvt_pk_bf16_f32 v73, v66, v67
    buffer_store_dwordx2 v[72:73], v0, s[24:27], s40 offen offset:96
    s_cmp_ge_u32 s34, 2
    s_cbranch_scc1 L_g3s_53
    s_waitcnt lgkmcnt(0)
    v_pk_add_f32 v[80:81], v[80:81], v[84:85]
    v_pk_add_f32 v[82:83], v[82:83], v[86:87]
    v_pk_add_f32 v[88:89], v[88:89], v[92:93]
    v_pk_add_f32 v[90:91], v[90:91], v[94:95]
    v_pk_add_f32 v[80:81], v[80:81], v[88:89]
    v_pk_add_f32 v[82:83], v[82:83], v[90:91]
    v_lshlrev_b32 v84, 16, v188
    v_and_b32 v85, 0xffff0000, v188
    v_lshlrev_b32 v86, 16, v189
    v_and_b32 v87, 0xffff0000, v189
    v_pk_fma_f32 v[80:81], v[80:81], v[176:177], v[84:85]
    v_pk_fma_f32 v[82:83], v[82:83], v[178:179], v[86:87]
    v_cvt_pk_bf16_f32 v88, v80, v81
    v_cvt_pk_bf16_f32 v89, v82, v83
    buffer_store_dwordx2 v[88:89], v0, s[24:27], s43 offen offset:0
L_g3s_53:
L_mdone_1:
    s_endpgm
L_g1slow_34:
    s_mov_b32 s70, 0x20000
L_g1slow_34_l:
    buffer_load_dwordx4 v[12:15], v3, s[28:31], s43 offen offset:0 sc1
    buffer_load_dwordx4 v[16:19], v3, s[28:31], s43 offen offset:1024 sc1
    buffer_load_dwordx4 v[248:251], v3, s[28:31], s43 offen offset:2048 sc1
    buffer_load_dwordx4 v[252:255], v3, s[28:31], s43 offen offset:3072 sc1
    s_waitcnt vmcnt(0)
    v_max_u32 v20, v12, v13
    v_max3_u32 v20, v14, v15, v20
    v_max3_u32 v20, v16, v17, v20
    v_max3_u32 v20, v18, v19, v20
    v_max3_u32 v20, v248, v249, v20
    v_max3_u32 v20, v250, v251, v20
    v_max3_u32 v20, v252, v253, v20
    v_max3_u32 v20, v254, v255, v20
    v_cmp_eq_u32 vcc, -1, v20
    s_cbranch_vccz L_g1back_35
    s_sub_u32 s70, s70, 1
    s_cmp_eq_u32 s70, 0
    s_cbranch_scc1 L_g1back_35
    s_branch L_g1slow_34_l
.section .rodata,"a"
.p2align 6
.amdhsa_kernel adaLN_cond__ssm_conv_h3__mixer_gmlp__prompt_kernel
  .amdhsa_next_free_vgpr 512
  .amdhsa_next_free_sgpr 102
  .amdhsa_accum_offset 256
  .amdhsa_group_segment_fixed_size 0
  .amdhsa_kernarg_size 128
  .amdhsa_user_sgpr_count 2
  .amdhsa_user_sgpr_kernarg_segment_ptr 1
  .amdhsa_system_sgpr_workgroup_id_x 1
  .amdhsa_float_denorm_mode_32 3
  .amdhsa_float_denorm_mode_16_64 3
.end_amdhsa_kernel
```
